```python
import torch

def _softmax(x, axis=-1):
    return torch.softmax(x, dim=axis)
def _gelu(x):
    return torch.nn.functional.gelu(x, approximate="tanh")
def _silu(x):
    return torch.nn.functional.silu(x)
def _sigmoid(x):
    return torch.sigmoid(x)
def _layernorm(x, axis=-1, eps=1e-5):
    m = x.mean(dim=axis, keepdim=True)
    v = x.var(dim=axis, keepdim=True, unbiased=False)
    return (x - m) / torch.sqrt(v + eps)
def _scatter_add(tgt, idx, src, axis=0):
    return tgt.clone().index_add_(axis, idx, src)
def _segment_sum(src, seg, n):
    out = torch.zeros((n,) + src.shape[1:], dtype=src.dtype)
    return out.index_add_(0, seg, src)
def _pad(x, pw):
    flat = tuple(v for pair in reversed(pw) for v in pair)
    return torch.nn.functional.pad(x, flat)

kernel_name = 'sequential_preLN__mha_block__dense_activation_gelu__prompt'

def setup_inputs():

    _w = (lambda a: (lambda t: t.to(torch.bfloat16) if t.is_floating_point() else t)(torch.as_tensor(a)))
    def _A_setup():
        B, S, D, H = 1, 2048, 448, 16
        return {
            "x": _w((lambda *s: torch.randn(*s, dtype=torch.bfloat16) * 0.05)(B, S, D)),
            "wqkv": _w((lambda *s: torch.randn(*s, dtype=torch.bfloat16) * 0.05)(D, 3 * D)),
            "wo": _w((lambda *s: torch.randn(*s, dtype=torch.bfloat16) * 0.05)(D, D)),
        }
    _A_in = _A_setup()

    def _B_setup():
        B, S, D, F = 1, 2048, 448, 1792
        return {
            "x": _w((lambda *s: torch.randn(*s, dtype=torch.bfloat16) * 0.05)(B, S, D)),
            "w1": _w((lambda *s: torch.randn(*s, dtype=torch.bfloat16) * 0.8)(D, F) * (D ** -0.5)),
            "b1": _w((lambda *s: torch.randn(*s, dtype=torch.bfloat16) * 12.8)(F) * 0.01),
            "w2": _w((lambda *s: torch.randn(*s, dtype=torch.bfloat16) * 0.8)(F, D) * (F ** -0.5)),
            "b2": _w((lambda *s: torch.randn(*s, dtype=torch.bfloat16) * 12.8)(D) * 0.01),
        }
    _B_in = _B_setup()

    return {
        "A_x": _A_in["x"],
        "A_wqkv": _A_in["wqkv"],
        "A_wo": _A_in["wo"],
        "B_x": _B_in["x"],
        "B_w1": _B_in["w1"],
        "B_b1": _B_in["b1"],
        "B_w2": _B_in["w2"],
        "B_b2": _B_in["b2"],
    }

def reference(A_x, A_wqkv, A_wo, B_x, B_w1, B_b1, B_w2, B_b2):
    def _A_ref(x, wqkv, wo):
        B, S, D = x.shape
        H = 16
        Dh = D // H
        qkv = (lambda x, *d: x.permute(*d))((x @ wqkv).reshape(B, S, 3, H, Dh), 2, 0, 3, 1, 4)
        q, k, v = qkv[0], qkv[1], qkv[2]
        scores = torch.einsum("bhqd,bhkd->bhqk", q, k) * (Dh ** -0.5)
        p = _softmax(scores, axis=-1)
        o = torch.einsum("bhqk,bhkd->bhqd", p, v)
        return (lambda x, *d: x.permute(*d))(o, 0, 2, 1, 3).reshape(B, S, D) @ wo

    def _B_ref(x, w1, b1, w2, b2):
        h = torch.einsum("bsd,df->bsf", x, w1) + b1
        h = _gelu(h)
        return torch.einsum("bsf,fd->bsd", h, w2) + b2

    x = A_x
    h = x + _A_ref(_layernorm(x, axis=-1), A_wqkv, A_wo)
    h2 = h + _B_ref(_layernorm(h, axis=-1), B_w1, B_b1, B_w2, B_b2)
    return h2
```

```asm
; @launch kernel=k1_qkv_kernel grid=(256,1,1) block=(256,1,1) lds=57344
; @launch kernel=k2_attn_kernel grid=(256,1,1) block=(256,1,1) lds=69632
.amdgcn_target "amdgcn-amd-amdhsa--gfx950"
.text
.globl k1_qkv_kernel
.p2align 8
.type k1_qkv_kernel,@function
k1_qkv_kernel:
    s_cmp_ge_u32 s2, 256
    s_cbranch_scc1 k1_qkv_kernel_end
    s_load_dwordx2 s[4:5], s[0:1], 0
    s_load_dwordx2 s[6:7], s[0:1], 8
    s_load_dwordx2 s[8:9], s[0:1], 80
    s_load_dwordx2 s[10:11], s[0:1], 40
    v_lshrrev_b32 v1, 6, v0
    v_and_b32 v0, 63, v0
    s_and_b32 s35, s2, 7
    s_lshr_b32 s36, s2, 3
    v_readfirstlane_b32 s33, v1
    s_lshr_b32 s37, s36, 2
    s_and_b32 s32, s36, 3
    s_bitcmp1_b32 s35, 0
    s_cbranch_scc0 k1_qkv_kernel_map
    s_cmp_ge_u32 s36, 24
    s_cbranch_scc1 k1_qkv_kernel_end
    s_mul_i32 s37, s36, 43
    s_lshr_b32 s37, s37, 7
    s_mul_i32 s38, s37, 3
    s_sub_u32 s32, s36, s38
    s_add_u32 s32, s32, 4
    k1_qkv_kernel_map:
    s_lshr_b32 s31, s35, 1
    s_lshl_b32 s31, s31, 3
    s_add_u32 s31, s31, s37
    s_mul_i32 s92, s31, 7
    s_add_u32 s92, s92, s32
    k1_qkv_kernel_mapped:
    s_mov_b32 s28, 0x5040100
    s_mov_b32 s29, 0x7060302
    s_getpc_b64 s[94:95]
    s_lshr_b32 s93, s2, 3
    s_lshl_b32 s93, s93, 2
    s_add_u32 s93, s93, s33
    s_lshl_b32 s93, s93, 10
    s_cmp_ge_u32 s93, 52224
    s_cbranch_scc1 k1_qkv_kernel_ncp
    s_add_u32 s94, s94, s93
    s_addc_u32 s95, s95, 0
    v_lshlrev_b32 v48, 4, v0
    v_mov_b32 v49, s95
    v_add_co_u32 v48, vcc, s94, v48
    s_nop 1
    v_addc_co_u32 v49, vcc, 0, v49, vcc
    global_load_dwordx4 v[50:53], v[48:49], off
k1_qkv_kernel_ncp:
    s_mul_i32 s34, s32, 3
    s_add_u32 s34, s34, s33
    v_and_b32 v2, 15, v0
    v_lshrrev_b32 v3, 4, v0
    s_min_u32 s34, s34, 20
    s_lshl_b32 s39, s34, 7
    v_mul_u32_u24 v4, 21504, v3
    v_lshl_add_u32 v4, v2, 3, v4
    v_add_u32 v8, s39, v4
    v_add_u32 v9, 2688, v8
    v_add_u32 v10, 5376, v8
    v_add_u32 v11, 8064, v8
    v_add_u32 v12, 10752, v8
    v_add_u32 v13, 13440, v8
    v_add_u32 v14, 16128, v8
    v_add_u32 v15, 18816, v8
    v_lshrrev_b32 v5, 2, v0
    v_and_b32 v6, 3, v0
    s_lshl_b32 s40, s31, 2
    s_add_u32 s40, s40, s33
    s_mul_i32 s40, s40, 14336
    v_mul_u32_u24 v7, 896, v5
    v_lshl_add_u32 v7, v6, 4, v7
    v_add_u32 v7, s40, v7
    s_waitcnt lgkmcnt(0)
    s_mov_b32 s12, s4
    s_mov_b32 s13, s5
    s_mov_b32 s14, 0x1c0000
    s_mov_b32 s15, 0x00020000
    s_mov_b32 s16, s6
    s_mov_b32 s17, s7
    s_mov_b32 s18, 0x126000
    s_mov_b32 s19, 0x00020000
    s_mov_b32 s20, s8
    s_mov_b32 s21, s9
    s_mov_b32 s22, 0x600000
    s_mov_b32 s23, 0x00020000
    buffer_load_dwordx4 v[64:67], v7, s[12:15], 0 offen offset:0
    buffer_load_dwordx4 v[68:71], v7, s[12:15], 0 offen offset:64
    buffer_load_dwordx4 v[72:75], v7, s[12:15], 0 offen offset:128
    buffer_load_dwordx4 v[76:79], v7, s[12:15], 0 offen offset:192
    buffer_load_dwordx4 v[80:83], v7, s[12:15], 0 offen offset:256
    buffer_load_dwordx4 v[84:87], v7, s[12:15], 0 offen offset:320
    buffer_load_dwordx4 v[88:91], v7, s[12:15], 0 offen offset:384
    buffer_load_dwordx4 v[92:95], v7, s[12:15], 0 offen offset:448
    buffer_load_dwordx4 v[96:99], v7, s[12:15], 0 offen offset:512
    buffer_load_dwordx4 v[100:103], v7, s[12:15], 0 offen offset:576
    buffer_load_dwordx4 v[104:107], v7, s[12:15], 0 offen offset:640
    buffer_load_dwordx4 v[108:111], v7, s[12:15], 0 offen offset:704
    buffer_load_dwordx4 v[112:115], v7, s[12:15], 0 offen offset:768
    buffer_load_dwordx4 v[116:119], v7, s[12:15], 0 offen offset:832
    s_cmp_eq_u32 s33, 3
    s_cbranch_scc1 k1_qkv_kernel_now
    s_mov_b32 s30, 0
    buffer_load_dwordx2 a[0:1], v8, s[16:19], s30 offen
    buffer_load_dwordx2 a[2:3], v9, s[16:19], s30 offen
    buffer_load_dwordx2 a[4:5], v10, s[16:19], s30 offen
    buffer_load_dwordx2 a[6:7], v11, s[16:19], s30 offen
    buffer_load_dwordx2 a[8:9], v12, s[16:19], s30 offen
    buffer_load_dwordx2 a[10:11], v13, s[16:19], s30 offen
    buffer_load_dwordx2 a[12:13], v14, s[16:19], s30 offen
    buffer_load_dwordx2 a[14:15], v15, s[16:19], s30 offen
    s_mov_b32 s30, 86016
    buffer_load_dwordx2 a[16:17], v8, s[16:19], s30 offen
    buffer_load_dwordx2 a[18:19], v9, s[16:19], s30 offen
    buffer_load_dwordx2 a[20:21], v10, s[16:19], s30 offen
    buffer_load_dwordx2 a[22:23], v11, s[16:19], s30 offen
    buffer_load_dwordx2 a[24:25], v12, s[16:19], s30 offen
    buffer_load_dwordx2 a[26:27], v13, s[16:19], s30 offen
    buffer_load_dwordx2 a[28:29], v14, s[16:19], s30 offen
    buffer_load_dwordx2 a[30:31], v15, s[16:19], s30 offen
    s_waitcnt vmcnt(16)
    s_branch k1_qkv_kernel_ln
k1_qkv_kernel_now:
    s_waitcnt vmcnt(0)
k1_qkv_kernel_ln:
    v_mov_b32 v28, 0x3f803f80
    v_mov_b32 v30, 0
    v_mov_b32 v31, 0
    v_mov_b32 v32, 0
    v_mov_b32 v33, 0
    s_cmp_eq_u32 s33, 3
    s_cbranch_scc1 k1_qkv_kernel_nwd0
    s_mov_b32 s30, 172032
    buffer_load_dwordx2 a[32:33], v8, s[16:19], s30 offen
    buffer_load_dwordx2 a[34:35], v9, s[16:19], s30 offen
    buffer_load_dwordx2 a[36:37], v10, s[16:19], s30 offen
    buffer_load_dwordx2 a[38:39], v11, s[16:19], s30 offen
    buffer_load_dwordx2 a[40:41], v12, s[16:19], s30 offen
    buffer_load_dwordx2 a[42:43], v13, s[16:19], s30 offen
    buffer_load_dwordx2 a[44:45], v14, s[16:19], s30 offen
    buffer_load_dwordx2 a[46:47], v15, s[16:19], s30 offen
k1_qkv_kernel_nwd0:
    v_dot2c_f32_bf16 v30, v64, v28
    v_dot2c_f32_bf16 v32, v64, v64
    v_dot2c_f32_bf16 v31, v65, v28
    v_dot2c_f32_bf16 v33, v65, v65
    v_dot2c_f32_bf16 v30, v66, v28
    v_dot2c_f32_bf16 v32, v66, v66
    v_dot2c_f32_bf16 v31, v67, v28
    v_dot2c_f32_bf16 v33, v67, v67
    v_dot2c_f32_bf16 v30, v68, v28
    v_dot2c_f32_bf16 v32, v68, v68
    v_dot2c_f32_bf16 v31, v69, v28
    v_dot2c_f32_bf16 v33, v69, v69
    v_dot2c_f32_bf16 v30, v70, v28
    v_dot2c_f32_bf16 v32, v70, v70
    v_dot2c_f32_bf16 v31, v71, v28
    v_dot2c_f32_bf16 v33, v71, v71
    v_dot2c_f32_bf16 v30, v72, v28
    v_dot2c_f32_bf16 v32, v72, v72
    v_dot2c_f32_bf16 v31, v73, v28
    v_dot2c_f32_bf16 v33, v73, v73
    v_dot2c_f32_bf16 v30, v74, v28
    v_dot2c_f32_bf16 v32, v74, v74
    v_dot2c_f32_bf16 v31, v75, v28
    v_dot2c_f32_bf16 v33, v75, v75
    v_dot2c_f32_bf16 v30, v76, v28
    v_dot2c_f32_bf16 v32, v76, v76
    v_dot2c_f32_bf16 v31, v77, v28
    v_dot2c_f32_bf16 v33, v77, v77
    v_dot2c_f32_bf16 v30, v78, v28
    v_dot2c_f32_bf16 v32, v78, v78
    v_dot2c_f32_bf16 v31, v79, v28
    v_dot2c_f32_bf16 v33, v79, v79
    v_dot2c_f32_bf16 v30, v80, v28
    v_dot2c_f32_bf16 v32, v80, v80
    v_dot2c_f32_bf16 v31, v81, v28
    v_dot2c_f32_bf16 v33, v81, v81
    v_dot2c_f32_bf16 v30, v82, v28
    v_dot2c_f32_bf16 v32, v82, v82
    v_dot2c_f32_bf16 v31, v83, v28
    v_dot2c_f32_bf16 v33, v83, v83
    v_dot2c_f32_bf16 v30, v84, v28
    v_dot2c_f32_bf16 v32, v84, v84
    v_dot2c_f32_bf16 v31, v85, v28
    v_dot2c_f32_bf16 v33, v85, v85
    v_dot2c_f32_bf16 v30, v86, v28
    v_dot2c_f32_bf16 v32, v86, v86
    v_dot2c_f32_bf16 v31, v87, v28
    v_dot2c_f32_bf16 v33, v87, v87
    v_dot2c_f32_bf16 v30, v88, v28
    v_dot2c_f32_bf16 v32, v88, v88
    v_dot2c_f32_bf16 v31, v89, v28
    v_dot2c_f32_bf16 v33, v89, v89
    v_dot2c_f32_bf16 v30, v90, v28
    v_dot2c_f32_bf16 v32, v90, v90
    v_dot2c_f32_bf16 v31, v91, v28
    v_dot2c_f32_bf16 v33, v91, v91
    s_cmp_eq_u32 s33, 3
    s_cbranch_scc1 k1_qkv_kernel_nwd28
    s_mov_b32 s30, 258048
    buffer_load_dwordx2 a[48:49], v8, s[16:19], s30 offen
    buffer_load_dwordx2 a[50:51], v9, s[16:19], s30 offen
    buffer_load_dwordx2 a[52:53], v10, s[16:19], s30 offen
    buffer_load_dwordx2 a[54:55], v11, s[16:19], s30 offen
    buffer_load_dwordx2 a[56:57], v12, s[16:19], s30 offen
    buffer_load_dwordx2 a[58:59], v13, s[16:19], s30 offen
    buffer_load_dwordx2 a[60:61], v14, s[16:19], s30 offen
    buffer_load_dwordx2 a[62:63], v15, s[16:19], s30 offen
k1_qkv_kernel_nwd28:
    v_dot2c_f32_bf16 v30, v92, v28
    v_dot2c_f32_bf16 v32, v92, v92
    v_dot2c_f32_bf16 v31, v93, v28
    v_dot2c_f32_bf16 v33, v93, v93
    v_dot2c_f32_bf16 v30, v94, v28
    v_dot2c_f32_bf16 v32, v94, v94
    v_dot2c_f32_bf16 v31, v95, v28
    v_dot2c_f32_bf16 v33, v95, v95
    v_dot2c_f32_bf16 v30, v96, v28
    v_dot2c_f32_bf16 v32, v96, v96
    v_dot2c_f32_bf16 v31, v97, v28
    v_dot2c_f32_bf16 v33, v97, v97
    v_dot2c_f32_bf16 v30, v98, v28
    v_dot2c_f32_bf16 v32, v98, v98
    v_dot2c_f32_bf16 v31, v99, v28
    v_dot2c_f32_bf16 v33, v99, v99
    v_dot2c_f32_bf16 v30, v100, v28
    v_dot2c_f32_bf16 v32, v100, v100
    v_dot2c_f32_bf16 v31, v101, v28
    v_dot2c_f32_bf16 v33, v101, v101
    v_dot2c_f32_bf16 v30, v102, v28
    v_dot2c_f32_bf16 v32, v102, v102
    v_dot2c_f32_bf16 v31, v103, v28
    v_dot2c_f32_bf16 v33, v103, v103
    v_dot2c_f32_bf16 v30, v104, v28
    v_dot2c_f32_bf16 v32, v104, v104
    v_dot2c_f32_bf16 v31, v105, v28
    v_dot2c_f32_bf16 v33, v105, v105
    v_dot2c_f32_bf16 v30, v106, v28
    v_dot2c_f32_bf16 v32, v106, v106
    v_dot2c_f32_bf16 v31, v107, v28
    v_dot2c_f32_bf16 v33, v107, v107
    v_dot2c_f32_bf16 v30, v108, v28
    v_dot2c_f32_bf16 v32, v108, v108
    v_dot2c_f32_bf16 v31, v109, v28
    v_dot2c_f32_bf16 v33, v109, v109
    v_dot2c_f32_bf16 v30, v110, v28
    v_dot2c_f32_bf16 v32, v110, v110
    v_dot2c_f32_bf16 v31, v111, v28
    v_dot2c_f32_bf16 v33, v111, v111
    v_dot2c_f32_bf16 v30, v112, v28
    v_dot2c_f32_bf16 v32, v112, v112
    v_dot2c_f32_bf16 v31, v113, v28
    v_dot2c_f32_bf16 v33, v113, v113
    v_dot2c_f32_bf16 v30, v114, v28
    v_dot2c_f32_bf16 v32, v114, v114
    v_dot2c_f32_bf16 v31, v115, v28
    v_dot2c_f32_bf16 v33, v115, v115
    v_dot2c_f32_bf16 v30, v116, v28
    v_dot2c_f32_bf16 v32, v116, v116
    v_dot2c_f32_bf16 v31, v117, v28
    v_dot2c_f32_bf16 v33, v117, v117
    v_dot2c_f32_bf16 v30, v118, v28
    v_dot2c_f32_bf16 v32, v118, v118
    v_dot2c_f32_bf16 v31, v119, v28
    v_dot2c_f32_bf16 v33, v119, v119
    s_nop 2
    v_add_f32 v30, v30, v31
    v_add_f32 v32, v32, v33
    s_nop 1
    v_add_f32_dpp v30, v30, v30 quad_perm:[1,0,3,2] row_mask:0xf bank_mask:0xf
    v_add_f32_dpp v32, v32, v32 quad_perm:[1,0,3,2] row_mask:0xf bank_mask:0xf
    s_nop 1
    v_add_f32_dpp v30, v30, v30 quad_perm:[2,3,0,1] row_mask:0xf bank_mask:0xf
    v_add_f32_dpp v32, v32, v32 quad_perm:[2,3,0,1] row_mask:0xf bank_mask:0xf
    s_nop 1
    v_mul_f32 v30, 0x3b124925, v30
    v_mul_f32 v32, 0x3b124925, v32
    v_fma_f32 v32, -v30, v30, v32
    v_max_f32 v32, 0, v32
    v_add_f32 v32, 0x3727c5ac, v32
    v_rsq_f32 v34, v32
    s_nop 0
    v_mul_f32 v36, v30, v34
    v_sub_f32 v36, 0, v36
    v_mov_b32 v35, v34
    v_mov_b32 v37, v36
    v_lshlrev_b32 v38, 1, v6
    v_xor_b32 v38, v38, v5
    v_lshlrev_b32 v38, 4, v38
    v_lshl_add_u32 v38, v6, 8, v38
    s_mul_i32 s41, s33, 14336
    v_add_u32 v38, s41, v38
    v_lshlrev_b32 v40, 16, v64
    v_and_b32 v41, 0xffff0000, v64
    v_pk_fma_f32 v[40:41], v[40:41], v[34:35], v[36:37]
    v_cvt_pk_bf16_f32 v64, v40, v41
    v_lshlrev_b32 v42, 16, v65
    v_and_b32 v43, 0xffff0000, v65
    v_pk_fma_f32 v[42:43], v[42:43], v[34:35], v[36:37]
    v_cvt_pk_bf16_f32 v65, v42, v43
    v_lshlrev_b32 v40, 16, v66
    v_and_b32 v41, 0xffff0000, v66
    v_pk_fma_f32 v[40:41], v[40:41], v[34:35], v[36:37]
    v_cvt_pk_bf16_f32 v66, v40, v41
    v_lshlrev_b32 v42, 16, v67
    v_and_b32 v43, 0xffff0000, v67
    v_pk_fma_f32 v[42:43], v[42:43], v[34:35], v[36:37]
    v_cvt_pk_bf16_f32 v67, v42, v43
    ds_write_b128 v38, v[64:67] offset:0
    s_cmp_eq_u32 s33, 3
    s_cbranch_scc1 k1_qkv_kernel_nwn0
    s_mov_b32 s30, 344064
    buffer_load_dwordx2 a[64:65], v8, s[16:19], s30 offen
    buffer_load_dwordx2 a[66:67], v9, s[16:19], s30 offen
    buffer_load_dwordx2 a[68:69], v10, s[16:19], s30 offen
    buffer_load_dwordx2 a[70:71], v11, s[16:19], s30 offen
    buffer_load_dwordx2 a[72:73], v12, s[16:19], s30 offen
    buffer_load_dwordx2 a[74:75], v13, s[16:19], s30 offen
    buffer_load_dwordx2 a[76:77], v14, s[16:19], s30 offen
    buffer_load_dwordx2 a[78:79], v15, s[16:19], s30 offen
k1_qkv_kernel_nwn0:
    v_lshlrev_b32 v40, 16, v68
    v_and_b32 v41, 0xffff0000, v68
    v_pk_fma_f32 v[40:41], v[40:41], v[34:35], v[36:37]
    v_cvt_pk_bf16_f32 v68, v40, v41
    v_lshlrev_b32 v42, 16, v69
    v_and_b32 v43, 0xffff0000, v69
    v_pk_fma_f32 v[42:43], v[42:43], v[34:35], v[36:37]
    v_cvt_pk_bf16_f32 v69, v42, v43
    v_lshlrev_b32 v40, 16, v70
    v_and_b32 v41, 0xffff0000, v70
    v_pk_fma_f32 v[40:41], v[40:41], v[34:35], v[36:37]
    v_cvt_pk_bf16_f32 v70, v40, v41
    v_lshlrev_b32 v42, 16, v71
    v_and_b32 v43, 0xffff0000, v71
    v_pk_fma_f32 v[42:43], v[42:43], v[34:35], v[36:37]
    v_cvt_pk_bf16_f32 v71, v42, v43
    ds_write_b128 v38, v[68:71] offset:1024
    v_lshlrev_b32 v40, 16, v72
    v_and_b32 v41, 0xffff0000, v72
    v_pk_fma_f32 v[40:41], v[40:41], v[34:35], v[36:37]
    v_cvt_pk_bf16_f32 v72, v40, v41
    v_lshlrev_b32 v42, 16, v73
    v_and_b32 v43, 0xffff0000, v73
    v_pk_fma_f32 v[42:43], v[42:43], v[34:35], v[36:37]
    v_cvt_pk_bf16_f32 v73, v42, v43
    v_lshlrev_b32 v40, 16, v74
    v_and_b32 v41, 0xffff0000, v74
    v_pk_fma_f32 v[40:41], v[40:41], v[34:35], v[36:37]
    v_cvt_pk_bf16_f32 v74, v40, v41
    v_lshlrev_b32 v42, 16, v75
    v_and_b32 v43, 0xffff0000, v75
    v_pk_fma_f32 v[42:43], v[42:43], v[34:35], v[36:37]
    v_cvt_pk_bf16_f32 v75, v42, v43
    ds_write_b128 v38, v[72:75] offset:2048
    v_lshlrev_b32 v40, 16, v76
    v_and_b32 v41, 0xffff0000, v76
    v_pk_fma_f32 v[40:41], v[40:41], v[34:35], v[36:37]
    v_cvt_pk_bf16_f32 v76, v40, v41
    v_lshlrev_b32 v42, 16, v77
    v_and_b32 v43, 0xffff0000, v77
    v_pk_fma_f32 v[42:43], v[42:43], v[34:35], v[36:37]
    v_cvt_pk_bf16_f32 v77, v42, v43
    v_lshlrev_b32 v40, 16, v78
    v_and_b32 v41, 0xffff0000, v78
    v_pk_fma_f32 v[40:41], v[40:41], v[34:35], v[36:37]
    v_cvt_pk_bf16_f32 v78, v40, v41
    v_lshlrev_b32 v42, 16, v79
    v_and_b32 v43, 0xffff0000, v79
    v_pk_fma_f32 v[42:43], v[42:43], v[34:35], v[36:37]
    v_cvt_pk_bf16_f32 v79, v42, v43
    ds_write_b128 v38, v[76:79] offset:3072
    s_cmp_eq_u32 s33, 3
    s_cbranch_scc1 k1_qkv_kernel_nwn3
    s_mov_b32 s30, 430080
    buffer_load_dwordx2 a[80:81], v8, s[16:19], s30 offen
    buffer_load_dwordx2 a[82:83], v9, s[16:19], s30 offen
    buffer_load_dwordx2 a[84:85], v10, s[16:19], s30 offen
    buffer_load_dwordx2 a[86:87], v11, s[16:19], s30 offen
    buffer_load_dwordx2 a[88:89], v12, s[16:19], s30 offen
    buffer_load_dwordx2 a[90:91], v13, s[16:19], s30 offen
    buffer_load_dwordx2 a[92:93], v14, s[16:19], s30 offen
    buffer_load_dwordx2 a[94:95], v15, s[16:19], s30 offen
k1_qkv_kernel_nwn3:
    v_lshlrev_b32 v40, 16, v80
    v_and_b32 v41, 0xffff0000, v80
    v_pk_fma_f32 v[40:41], v[40:41], v[34:35], v[36:37]
    v_cvt_pk_bf16_f32 v80, v40, v41
    v_lshlrev_b32 v42, 16, v81
    v_and_b32 v43, 0xffff0000, v81
    v_pk_fma_f32 v[42:43], v[42:43], v[34:35], v[36:37]
    v_cvt_pk_bf16_f32 v81, v42, v43
    v_lshlrev_b32 v40, 16, v82
    v_and_b32 v41, 0xffff0000, v82
    v_pk_fma_f32 v[40:41], v[40:41], v[34:35], v[36:37]
    v_cvt_pk_bf16_f32 v82, v40, v41
    v_lshlrev_b32 v42, 16, v83
    v_and_b32 v43, 0xffff0000, v83
    v_pk_fma_f32 v[42:43], v[42:43], v[34:35], v[36:37]
    v_cvt_pk_bf16_f32 v83, v42, v43
    ds_write_b128 v38, v[80:83] offset:4096
    v_lshlrev_b32 v40, 16, v84
    v_and_b32 v41, 0xffff0000, v84
    v_pk_fma_f32 v[40:41], v[40:41], v[34:35], v[36:37]
    v_cvt_pk_bf16_f32 v84, v40, v41
    v_lshlrev_b32 v42, 16, v85
    v_and_b32 v43, 0xffff0000, v85
    v_pk_fma_f32 v[42:43], v[42:43], v[34:35], v[36:37]
    v_cvt_pk_bf16_f32 v85, v42, v43
    v_lshlrev_b32 v40, 16, v86
    v_and_b32 v41, 0xffff0000, v86
    v_pk_fma_f32 v[40:41], v[40:41], v[34:35], v[36:37]
    v_cvt_pk_bf16_f32 v86, v40, v41
    v_lshlrev_b32 v42, 16, v87
    v_and_b32 v43, 0xffff0000, v87
    v_pk_fma_f32 v[42:43], v[42:43], v[34:35], v[36:37]
    v_cvt_pk_bf16_f32 v87, v42, v43
    ds_write_b128 v38, v[84:87] offset:5120
    v_lshlrev_b32 v40, 16, v88
    v_and_b32 v41, 0xffff0000, v88
    v_pk_fma_f32 v[40:41], v[40:41], v[34:35], v[36:37]
    v_cvt_pk_bf16_f32 v88, v40, v41
    v_lshlrev_b32 v42, 16, v89
    v_and_b32 v43, 0xffff0000, v89
    v_pk_fma_f32 v[42:43], v[42:43], v[34:35], v[36:37]
    v_cvt_pk_bf16_f32 v89, v42, v43
    v_lshlrev_b32 v40, 16, v90
    v_and_b32 v41, 0xffff0000, v90
    v_pk_fma_f32 v[40:41], v[40:41], v[34:35], v[36:37]
    v_cvt_pk_bf16_f32 v90, v40, v41
    v_lshlrev_b32 v42, 16, v91
    v_and_b32 v43, 0xffff0000, v91
    v_pk_fma_f32 v[42:43], v[42:43], v[34:35], v[36:37]
    v_cvt_pk_bf16_f32 v91, v42, v43
    ds_write_b128 v38, v[88:91] offset:6144
    s_cmp_eq_u32 s33, 3
    s_cbranch_scc1 k1_qkv_kernel_nwn6
    s_mov_b32 s30, 516096
    buffer_load_dwordx2 a[96:97], v8, s[16:19], s30 offen
    buffer_load_dwordx2 a[98:99], v9, s[16:19], s30 offen
    buffer_load_dwordx2 a[100:101], v10, s[16:19], s30 offen
    buffer_load_dwordx2 a[102:103], v11, s[16:19], s30 offen
    buffer_load_dwordx2 a[104:105], v12, s[16:19], s30 offen
    buffer_load_dwordx2 a[106:107], v13, s[16:19], s30 offen
    buffer_load_dwordx2 a[108:109], v14, s[16:19], s30 offen
    buffer_load_dwordx2 a[110:111], v15, s[16:19], s30 offen
k1_qkv_kernel_nwn6:
    v_lshlrev_b32 v40, 16, v92
    v_and_b32 v41, 0xffff0000, v92
    v_pk_fma_f32 v[40:41], v[40:41], v[34:35], v[36:37]
    v_cvt_pk_bf16_f32 v92, v40, v41
    v_lshlrev_b32 v42, 16, v93
    v_and_b32 v43, 0xffff0000, v93
    v_pk_fma_f32 v[42:43], v[42:43], v[34:35], v[36:37]
    v_cvt_pk_bf16_f32 v93, v42, v43
    v_lshlrev_b32 v40, 16, v94
    v_and_b32 v41, 0xffff0000, v94
    v_pk_fma_f32 v[40:41], v[40:41], v[34:35], v[36:37]
    v_cvt_pk_bf16_f32 v94, v40, v41
    v_lshlrev_b32 v42, 16, v95
    v_and_b32 v43, 0xffff0000, v95
    v_pk_fma_f32 v[42:43], v[42:43], v[34:35], v[36:37]
    v_cvt_pk_bf16_f32 v95, v42, v43
    ds_write_b128 v38, v[92:95] offset:7168
    v_lshlrev_b32 v40, 16, v96
    v_and_b32 v41, 0xffff0000, v96
    v_pk_fma_f32 v[40:41], v[40:41], v[34:35], v[36:37]
    v_cvt_pk_bf16_f32 v96, v40, v41
    v_lshlrev_b32 v42, 16, v97
    v_and_b32 v43, 0xffff0000, v97
    v_pk_fma_f32 v[42:43], v[42:43], v[34:35], v[36:37]
    v_cvt_pk_bf16_f32 v97, v42, v43
    v_lshlrev_b32 v40, 16, v98
    v_and_b32 v41, 0xffff0000, v98
    v_pk_fma_f32 v[40:41], v[40:41], v[34:35], v[36:37]
    v_cvt_pk_bf16_f32 v98, v40, v41
    v_lshlrev_b32 v42, 16, v99
    v_and_b32 v43, 0xffff0000, v99
    v_pk_fma_f32 v[42:43], v[42:43], v[34:35], v[36:37]
    v_cvt_pk_bf16_f32 v99, v42, v43
    ds_write_b128 v38, v[96:99] offset:8192
    v_lshlrev_b32 v40, 16, v100
    v_and_b32 v41, 0xffff0000, v100
    v_pk_fma_f32 v[40:41], v[40:41], v[34:35], v[36:37]
    v_cvt_pk_bf16_f32 v100, v40, v41
    v_lshlrev_b32 v42, 16, v101
    v_and_b32 v43, 0xffff0000, v101
    v_pk_fma_f32 v[42:43], v[42:43], v[34:35], v[36:37]
    v_cvt_pk_bf16_f32 v101, v42, v43
    v_lshlrev_b32 v40, 16, v102
    v_and_b32 v41, 0xffff0000, v102
    v_pk_fma_f32 v[40:41], v[40:41], v[34:35], v[36:37]
    v_cvt_pk_bf16_f32 v102, v40, v41
    v_lshlrev_b32 v42, 16, v103
    v_and_b32 v43, 0xffff0000, v103
    v_pk_fma_f32 v[42:43], v[42:43], v[34:35], v[36:37]
    v_cvt_pk_bf16_f32 v103, v42, v43
    ds_write_b128 v38, v[100:103] offset:9216
    s_cmp_eq_u32 s33, 3
    s_cbranch_scc1 k1_qkv_kernel_nwn9
    s_waitcnt vmcnt(48)
    s_mov_b32 s30, 602112
    buffer_load_dwordx2 a[112:113], v8, s[16:19], s30 offen
    buffer_load_dwordx2 a[114:115], v9, s[16:19], s30 offen
    buffer_load_dwordx2 a[116:117], v10, s[16:19], s30 offen
    buffer_load_dwordx2 a[118:119], v11, s[16:19], s30 offen
    buffer_load_dwordx2 a[120:121], v12, s[16:19], s30 offen
    buffer_load_dwordx2 a[122:123], v13, s[16:19], s30 offen
    buffer_load_dwordx2 a[124:125], v14, s[16:19], s30 offen
    buffer_load_dwordx2 a[126:127], v15, s[16:19], s30 offen
k1_qkv_kernel_nwn9:
    v_lshlrev_b32 v40, 16, v104
    v_and_b32 v41, 0xffff0000, v104
    v_pk_fma_f32 v[40:41], v[40:41], v[34:35], v[36:37]
    v_cvt_pk_bf16_f32 v104, v40, v41
    v_lshlrev_b32 v42, 16, v105
    v_and_b32 v43, 0xffff0000, v105
    v_pk_fma_f32 v[42:43], v[42:43], v[34:35], v[36:37]
    v_cvt_pk_bf16_f32 v105, v42, v43
    v_lshlrev_b32 v40, 16, v106
    v_and_b32 v41, 0xffff0000, v106
    v_pk_fma_f32 v[40:41], v[40:41], v[34:35], v[36:37]
    v_cvt_pk_bf16_f32 v106, v40, v41
    v_lshlrev_b32 v42, 16, v107
    v_and_b32 v43, 0xffff0000, v107
    v_pk_fma_f32 v[42:43], v[42:43], v[34:35], v[36:37]
    v_cvt_pk_bf16_f32 v107, v42, v43
    ds_write_b128 v38, v[104:107] offset:10240
    v_lshlrev_b32 v40, 16, v108
    v_and_b32 v41, 0xffff0000, v108
    v_pk_fma_f32 v[40:41], v[40:41], v[34:35], v[36:37]
    v_cvt_pk_bf16_f32 v108, v40, v41
    v_lshlrev_b32 v42, 16, v109
    v_and_b32 v43, 0xffff0000, v109
    v_pk_fma_f32 v[42:43], v[42:43], v[34:35], v[36:37]
    v_cvt_pk_bf16_f32 v109, v42, v43
    v_lshlrev_b32 v40, 16, v110
    v_and_b32 v41, 0xffff0000, v110
    v_pk_fma_f32 v[40:41], v[40:41], v[34:35], v[36:37]
    v_cvt_pk_bf16_f32 v110, v40, v41
    v_lshlrev_b32 v42, 16, v111
    v_and_b32 v43, 0xffff0000, v111
    v_pk_fma_f32 v[42:43], v[42:43], v[34:35], v[36:37]
    v_cvt_pk_bf16_f32 v111, v42, v43
    ds_write_b128 v38, v[108:111] offset:11264
    v_lshlrev_b32 v40, 16, v112
    v_and_b32 v41, 0xffff0000, v112
    v_pk_fma_f32 v[40:41], v[40:41], v[34:35], v[36:37]
    v_cvt_pk_bf16_f32 v112, v40, v41
    v_lshlrev_b32 v42, 16, v113
    v_and_b32 v43, 0xffff0000, v113
    v_pk_fma_f32 v[42:43], v[42:43], v[34:35], v[36:37]
    v_cvt_pk_bf16_f32 v113, v42, v43
    v_lshlrev_b32 v40, 16, v114
    v_and_b32 v41, 0xffff0000, v114
    v_pk_fma_f32 v[40:41], v[40:41], v[34:35], v[36:37]
    v_cvt_pk_bf16_f32 v114, v40, v41
    v_lshlrev_b32 v42, 16, v115
    v_and_b32 v43, 0xffff0000, v115
    v_pk_fma_f32 v[42:43], v[42:43], v[34:35], v[36:37]
    v_cvt_pk_bf16_f32 v115, v42, v43
    ds_write_b128 v38, v[112:115] offset:12288
    s_cmp_eq_u32 s33, 3
    s_cbranch_scc1 k1_qkv_kernel_nwn12
    s_waitcnt vmcnt(48)
    s_mov_b32 s30, 688128
    buffer_load_dwordx2 a[128:129], v8, s[16:19], s30 offen
    buffer_load_dwordx2 a[130:131], v9, s[16:19], s30 offen
    buffer_load_dwordx2 a[132:133], v10, s[16:19], s30 offen
    buffer_load_dwordx2 a[134:135], v11, s[16:19], s30 offen
    buffer_load_dwordx2 a[136:137], v12, s[16:19], s30 offen
    buffer_load_dwordx2 a[138:139], v13, s[16:19], s30 offen
    buffer_load_dwordx2 a[140:141], v14, s[16:19], s30 offen
    buffer_load_dwordx2 a[142:143], v15, s[16:19], s30 offen
k1_qkv_kernel_nwn12:
    v_lshlrev_b32 v40, 16, v116
    v_and_b32 v41, 0xffff0000, v116
    v_pk_fma_f32 v[40:41], v[40:41], v[34:35], v[36:37]
    v_cvt_pk_bf16_f32 v116, v40, v41
    v_lshlrev_b32 v42, 16, v117
    v_and_b32 v43, 0xffff0000, v117
    v_pk_fma_f32 v[42:43], v[42:43], v[34:35], v[36:37]
    v_cvt_pk_bf16_f32 v117, v42, v43
    v_lshlrev_b32 v40, 16, v118
    v_and_b32 v41, 0xffff0000, v118
    v_pk_fma_f32 v[40:41], v[40:41], v[34:35], v[36:37]
    v_cvt_pk_bf16_f32 v118, v40, v41
    v_lshlrev_b32 v42, 16, v119
    v_and_b32 v43, 0xffff0000, v119
    v_pk_fma_f32 v[42:43], v[42:43], v[34:35], v[36:37]
    v_cvt_pk_bf16_f32 v119, v42, v43
    ds_write_b128 v38, v[116:119] offset:13312
    v_lshlrev_b32 v39, 1, v3
    v_xor_b32 v39, v39, v2
    v_lshlrev_b32 v39, 4, v39
    v_lshl_add_u32 v39, v3, 8, v39
    s_waitcnt lgkmcnt(0)
    s_barrier
    s_cmp_eq_u32 s33, 3
    s_cbranch_scc1 k1_qkv_kernel_pf
    v_mov_b32 v64, 0
    v_mov_b32 v65, 0
    v_mov_b32 v66, 0
    v_mov_b32 v67, 0
    v_mov_b32 v68, 0
    v_mov_b32 v69, 0
    v_mov_b32 v70, 0
    v_mov_b32 v71, 0
    v_mov_b32 v72, 0
    v_mov_b32 v73, 0
    v_mov_b32 v74, 0
    v_mov_b32 v75, 0
    v_mov_b32 v76, 0
    v_mov_b32 v77, 0
    v_mov_b32 v78, 0
    v_mov_b32 v79, 0
    v_mov_b32 v80, 0
    v_mov_b32 v81, 0
    v_mov_b32 v82, 0
    v_mov_b32 v83, 0
    v_mov_b32 v84, 0
    v_mov_b32 v85, 0
    v_mov_b32 v86, 0
    v_mov_b32 v87, 0
    v_mov_b32 v88, 0
    v_mov_b32 v89, 0
    v_mov_b32 v90, 0
    v_mov_b32 v91, 0
    v_mov_b32 v92, 0
    v_mov_b32 v93, 0
    v_mov_b32 v94, 0
    v_mov_b32 v95, 0
    v_mov_b32 v96, 0
    v_mov_b32 v97, 0
    v_mov_b32 v98, 0
    v_mov_b32 v99, 0
    v_mov_b32 v100, 0
    v_mov_b32 v101, 0
    v_mov_b32 v102, 0
    v_mov_b32 v103, 0
    v_mov_b32 v104, 0
    v_mov_b32 v105, 0
    v_mov_b32 v106, 0
    v_mov_b32 v107, 0
    v_mov_b32 v108, 0
    v_mov_b32 v109, 0
    v_mov_b32 v110, 0
    v_mov_b32 v111, 0
    v_mov_b32 v112, 0
    v_mov_b32 v113, 0
    v_mov_b32 v114, 0
    v_mov_b32 v115, 0
    v_mov_b32 v116, 0
    v_mov_b32 v117, 0
    v_mov_b32 v118, 0
    v_mov_b32 v119, 0
    v_mov_b32 v120, 0
    v_mov_b32 v121, 0
    v_mov_b32 v122, 0
    v_mov_b32 v123, 0
    v_mov_b32 v124, 0
    v_mov_b32 v125, 0
    v_mov_b32 v126, 0
    v_mov_b32 v127, 0
    s_cmp_ge_u32 s34, 14
    s_cbranch_scc1 k1_qkv_kernel_v
    ds_read_b128 v[128:131], v39 offset:0
    ds_read_b128 v[132:135], v39 offset:14336
    ds_read_b128 v[136:139], v39 offset:28672
    ds_read_b128 v[140:143], v39 offset:43008
    v_accvgpr_read_b32 v160, a0
    v_accvgpr_read_b32 v161, a1
    v_accvgpr_read_b32 v162, a2
    v_accvgpr_read_b32 v163, a3
    v_accvgpr_read_b32 v164, a4
    v_accvgpr_read_b32 v165, a5
    v_accvgpr_read_b32 v166, a6
    v_accvgpr_read_b32 v167, a7
    v_accvgpr_read_b32 v168, a8
    v_accvgpr_read_b32 v169, a9
    v_accvgpr_read_b32 v170, a10
    v_accvgpr_read_b32 v171, a11
    v_accvgpr_read_b32 v172, a12
    v_accvgpr_read_b32 v173, a13
    v_accvgpr_read_b32 v174, a14
    v_accvgpr_read_b32 v175, a15
    v_perm_b32 v224, v162, v160, s28
    v_perm_b32 v225, v166, v164, s28
    v_perm_b32 v226, v170, v168, s28
    v_perm_b32 v227, v174, v172, s28
    v_perm_b32 v228, v162, v160, s29
    v_perm_b32 v229, v166, v164, s29
    v_perm_b32 v230, v170, v168, s29
    v_perm_b32 v231, v174, v172, s29
    v_perm_b32 v232, v163, v161, s28
    v_perm_b32 v233, v167, v165, s28
    v_perm_b32 v234, v171, v169, s28
    v_perm_b32 v235, v175, v173, s28
    v_perm_b32 v236, v163, v161, s29
    v_perm_b32 v237, v167, v165, s29
    v_perm_b32 v238, v171, v169, s29
    v_perm_b32 v239, v175, v173, s29
    s_waitcnt lgkmcnt(0)
    ds_read_b128 v[144:147], v39 offset:1024
    ds_read_b128 v[148:151], v39 offset:15360
    ds_read_b128 v[152:155], v39 offset:29696
    ds_read_b128 v[156:159], v39 offset:44032
    v_mfma_f32_16x16x32_bf16 v[64:67], v[224:227], v[128:131], v[64:67]
    v_accvgpr_read_b32 v160, a16
    v_accvgpr_read_b32 v161, a17
    v_mfma_f32_16x16x32_bf16 v[68:71], v[228:231], v[128:131], v[68:71]
    v_accvgpr_read_b32 v162, a18
    v_accvgpr_read_b32 v163, a19
    v_mfma_f32_16x16x32_bf16 v[72:75], v[232:235], v[128:131], v[72:75]
    v_accvgpr_read_b32 v164, a20
    v_accvgpr_read_b32 v165, a21
    v_mfma_f32_16x16x32_bf16 v[76:79], v[236:239], v[128:131], v[76:79]
    v_accvgpr_read_b32 v166, a22
    v_accvgpr_read_b32 v167, a23
    v_mfma_f32_16x16x32_bf16 v[80:83], v[224:227], v[132:135], v[80:83]
    v_accvgpr_read_b32 v168, a24
    v_accvgpr_read_b32 v169, a25
    v_mfma_f32_16x16x32_bf16 v[84:87], v[228:231], v[132:135], v[84:87]
    v_accvgpr_read_b32 v170, a26
    v_accvgpr_read_b32 v171, a27
    v_mfma_f32_16x16x32_bf16 v[88:91], v[232:235], v[132:135], v[88:91]
    v_accvgpr_read_b32 v172, a28
    v_accvgpr_read_b32 v173, a29
    v_mfma_f32_16x16x32_bf16 v[92:95], v[236:239], v[132:135], v[92:95]
    v_accvgpr_read_b32 v174, a30
    v_accvgpr_read_b32 v175, a31
    v_mfma_f32_16x16x32_bf16 v[96:99], v[224:227], v[136:139], v[96:99]
    v_perm_b32 v240, v162, v160, s28
    v_perm_b32 v241, v166, v164, s28
    v_mfma_f32_16x16x32_bf16 v[100:103], v[228:231], v[136:139], v[100:103]
    v_perm_b32 v242, v170, v168, s28
    v_perm_b32 v243, v174, v172, s28
    v_mfma_f32_16x16x32_bf16 v[104:107], v[232:235], v[136:139], v[104:107]
    v_perm_b32 v244, v162, v160, s29
    v_perm_b32 v245, v166, v164, s29
    v_mfma_f32_16x16x32_bf16 v[108:111], v[236:239], v[136:139], v[108:111]
    v_perm_b32 v246, v170, v168, s29
    v_perm_b32 v247, v174, v172, s29
    v_mfma_f32_16x16x32_bf16 v[112:115], v[224:227], v[140:143], v[112:115]
    v_perm_b32 v248, v163, v161, s28
    v_perm_b32 v249, v167, v165, s28
    v_mfma_f32_16x16x32_bf16 v[116:119], v[228:231], v[140:143], v[116:119]
    v_perm_b32 v250, v171, v169, s28
    v_perm_b32 v251, v175, v173, s28
    v_mfma_f32_16x16x32_bf16 v[120:123], v[232:235], v[140:143], v[120:123]
    v_perm_b32 v252, v163, v161, s29
    v_perm_b32 v253, v167, v165, s29
    v_mfma_f32_16x16x32_bf16 v[124:127], v[236:239], v[140:143], v[124:127]
    v_perm_b32 v254, v171, v169, s29
    v_perm_b32 v255, v175, v173, s29
    s_waitcnt vmcnt(48)
    s_mov_b32 s30, 774144
    buffer_load_dwordx2 a[144:145], v8, s[16:19], s30 offen
    buffer_load_dwordx2 a[146:147], v9, s[16:19], s30 offen
    buffer_load_dwordx2 a[148:149], v10, s[16:19], s30 offen
    buffer_load_dwordx2 a[150:151], v11, s[16:19], s30 offen
    buffer_load_dwordx2 a[152:153], v12, s[16:19], s30 offen
    buffer_load_dwordx2 a[154:155], v13, s[16:19], s30 offen
    buffer_load_dwordx2 a[156:157], v14, s[16:19], s30 offen
    buffer_load_dwordx2 a[158:159], v15, s[16:19], s30 offen
    s_waitcnt lgkmcnt(0)
    ds_read_b128 v[128:131], v39 offset:2048
    ds_read_b128 v[132:135], v39 offset:16384
    ds_read_b128 v[136:139], v39 offset:30720
    ds_read_b128 v[140:143], v39 offset:45056
    v_mfma_f32_16x16x32_bf16 v[64:67], v[240:243], v[144:147], v[64:67]
    v_accvgpr_read_b32 v160, a32
    v_accvgpr_read_b32 v161, a33
    v_mfma_f32_16x16x32_bf16 v[68:71], v[244:247], v[144:147], v[68:71]
    v_accvgpr_read_b32 v162, a34
    v_accvgpr_read_b32 v163, a35
    v_mfma_f32_16x16x32_bf16 v[72:75], v[248:251], v[144:147], v[72:75]
    v_accvgpr_read_b32 v164, a36
    v_accvgpr_read_b32 v165, a37
    v_mfma_f32_16x16x32_bf16 v[76:79], v[252:255], v[144:147], v[76:79]
    v_accvgpr_read_b32 v166, a38
    v_accvgpr_read_b32 v167, a39
    v_mfma_f32_16x16x32_bf16 v[80:83], v[240:243], v[148:151], v[80:83]
    v_accvgpr_read_b32 v168, a40
    v_accvgpr_read_b32 v169, a41
    v_mfma_f32_16x16x32_bf16 v[84:87], v[244:247], v[148:151], v[84:87]
    v_accvgpr_read_b32 v170, a42
    v_accvgpr_read_b32 v171, a43
    v_mfma_f32_16x16x32_bf16 v[88:91], v[248:251], v[148:151], v[88:91]
    v_accvgpr_read_b32 v172, a44
    v_accvgpr_read_b32 v173, a45
    v_mfma_f32_16x16x32_bf16 v[92:95], v[252:255], v[148:151], v[92:95]
    v_accvgpr_read_b32 v174, a46
    v_accvgpr_read_b32 v175, a47
    v_mfma_f32_16x16x32_bf16 v[96:99], v[240:243], v[152:155], v[96:99]
    v_perm_b32 v224, v162, v160, s28
    v_perm_b32 v225, v166, v164, s28
    v_mfma_f32_16x16x32_bf16 v[100:103], v[244:247], v[152:155], v[100:103]
    v_perm_b32 v226, v170, v168, s28
    v_perm_b32 v227, v174, v172, s28
    v_mfma_f32_16x16x32_bf16 v[104:107], v[248:251], v[152:155], v[104:107]
    v_perm_b32 v228, v162, v160, s29
    v_perm_b32 v229, v166, v164, s29
    v_mfma_f32_16x16x32_bf16 v[108:111], v[252:255], v[152:155], v[108:111]
    v_perm_b32 v230, v170, v168, s29
    v_perm_b32 v231, v174, v172, s29
    v_mfma_f32_16x16x32_bf16 v[112:115], v[240:243], v[156:159], v[112:115]
    v_perm_b32 v232, v163, v161, s28
    v_perm_b32 v233, v167, v165, s28
    v_mfma_f32_16x16x32_bf16 v[116:119], v[244:247], v[156:159], v[116:119]
    v_perm_b32 v234, v171, v169, s28
    v_perm_b32 v235, v175, v173, s28
    v_mfma_f32_16x16x32_bf16 v[120:123], v[248:251], v[156:159], v[120:123]
    v_perm_b32 v236, v163, v161, s29
    v_perm_b32 v237, v167, v165, s29
    v_mfma_f32_16x16x32_bf16 v[124:127], v[252:255], v[156:159], v[124:127]
    v_perm_b32 v238, v171, v169, s29
    v_perm_b32 v239, v175, v173, s29
    s_waitcnt vmcnt(48)
    s_mov_b32 s30, 860160
    buffer_load_dwordx2 a[160:161], v8, s[16:19], s30 offen
    buffer_load_dwordx2 a[162:163], v9, s[16:19], s30 offen
    buffer_load_dwordx2 a[164:165], v10, s[16:19], s30 offen
    buffer_load_dwordx2 a[166:167], v11, s[16:19], s30 offen
    buffer_load_dwordx2 a[168:169], v12, s[16:19], s30 offen
    buffer_load_dwordx2 a[170:171], v13, s[16:19], s30 offen
    buffer_load_dwordx2 a[172:173], v14, s[16:19], s30 offen
    buffer_load_dwordx2 a[174:175], v15, s[16:19], s30 offen
    s_waitcnt lgkmcnt(0)
    ds_read_b128 v[144:147], v39 offset:3072
    ds_read_b128 v[148:151], v39 offset:17408
    ds_read_b128 v[152:155], v39 offset:31744
    ds_read_b128 v[156:159], v39 offset:46080
    v_mfma_f32_16x16x32_bf16 v[64:67], v[224:227], v[128:131], v[64:67]
    v_accvgpr_read_b32 v160, a48
    v_accvgpr_read_b32 v161, a49
    v_mfma_f32_16x16x32_bf16 v[68:71], v[228:231], v[128:131], v[68:71]
    v_accvgpr_read_b32 v162, a50
    v_accvgpr_read_b32 v163, a51
    v_mfma_f32_16x16x32_bf16 v[72:75], v[232:235], v[128:131], v[72:75]
    v_accvgpr_read_b32 v164, a52
    v_accvgpr_read_b32 v165, a53
    v_mfma_f32_16x16x32_bf16 v[76:79], v[236:239], v[128:131], v[76:79]
    v_accvgpr_read_b32 v166, a54
    v_accvgpr_read_b32 v167, a55
    v_mfma_f32_16x16x32_bf16 v[80:83], v[224:227], v[132:135], v[80:83]
    v_accvgpr_read_b32 v168, a56
    v_accvgpr_read_b32 v169, a57
    v_mfma_f32_16x16x32_bf16 v[84:87], v[228:231], v[132:135], v[84:87]
    v_accvgpr_read_b32 v170, a58
    v_accvgpr_read_b32 v171, a59
    v_mfma_f32_16x16x32_bf16 v[88:91], v[232:235], v[132:135], v[88:91]
    v_accvgpr_read_b32 v172, a60
    v_accvgpr_read_b32 v173, a61
    v_mfma_f32_16x16x32_bf16 v[92:95], v[236:239], v[132:135], v[92:95]
    v_accvgpr_read_b32 v174, a62
    v_accvgpr_read_b32 v175, a63
    v_mfma_f32_16x16x32_bf16 v[96:99], v[224:227], v[136:139], v[96:99]
    v_perm_b32 v240, v162, v160, s28
    v_perm_b32 v241, v166, v164, s28
    v_mfma_f32_16x16x32_bf16 v[100:103], v[228:231], v[136:139], v[100:103]
    v_perm_b32 v242, v170, v168, s28
    v_perm_b32 v243, v174, v172, s28
    v_mfma_f32_16x16x32_bf16 v[104:107], v[232:235], v[136:139], v[104:107]
    v_perm_b32 v244, v162, v160, s29
    v_perm_b32 v245, v166, v164, s29
    v_mfma_f32_16x16x32_bf16 v[108:111], v[236:239], v[136:139], v[108:111]
    v_perm_b32 v246, v170, v168, s29
    v_perm_b32 v247, v174, v172, s29
    v_mfma_f32_16x16x32_bf16 v[112:115], v[224:227], v[140:143], v[112:115]
    v_perm_b32 v248, v163, v161, s28
    v_perm_b32 v249, v167, v165, s28
    v_mfma_f32_16x16x32_bf16 v[116:119], v[228:231], v[140:143], v[116:119]
    v_perm_b32 v250, v171, v169, s28
    v_perm_b32 v251, v175, v173, s28
    v_mfma_f32_16x16x32_bf16 v[120:123], v[232:235], v[140:143], v[120:123]
    v_perm_b32 v252, v163, v161, s29
    v_perm_b32 v253, v167, v165, s29
    v_mfma_f32_16x16x32_bf16 v[124:127], v[236:239], v[140:143], v[124:127]
    v_perm_b32 v254, v171, v169, s29
    v_perm_b32 v255, v175, v173, s29
    s_waitcnt vmcnt(48)
    s_mov_b32 s30, 946176
    buffer_load_dwordx2 a[176:177], v8, s[16:19], s30 offen
    buffer_load_dwordx2 a[178:179], v9, s[16:19], s30 offen
    buffer_load_dwordx2 a[180:181], v10, s[16:19], s30 offen
    buffer_load_dwordx2 a[182:183], v11, s[16:19], s30 offen
    buffer_load_dwordx2 a[184:185], v12, s[16:19], s30 offen
    buffer_load_dwordx2 a[186:187], v13, s[16:19], s30 offen
    buffer_load_dwordx2 a[188:189], v14, s[16:19], s30 offen
    buffer_load_dwordx2 a[190:191], v15, s[16:19], s30 offen
    s_waitcnt lgkmcnt(0)
    ds_read_b128 v[128:131], v39 offset:4096
    ds_read_b128 v[132:135], v39 offset:18432
    ds_read_b128 v[136:139], v39 offset:32768
    ds_read_b128 v[140:143], v39 offset:47104
    v_mfma_f32_16x16x32_bf16 v[64:67], v[240:243], v[144:147], v[64:67]
    v_accvgpr_read_b32 v160, a64
    v_accvgpr_read_b32 v161, a65
    v_mfma_f32_16x16x32_bf16 v[68:71], v[244:247], v[144:147], v[68:71]
    v_accvgpr_read_b32 v162, a66
    v_accvgpr_read_b32 v163, a67
    v_mfma_f32_16x16x32_bf16 v[72:75], v[248:251], v[144:147], v[72:75]
    v_accvgpr_read_b32 v164, a68
    v_accvgpr_read_b32 v165, a69
    v_mfma_f32_16x16x32_bf16 v[76:79], v[252:255], v[144:147], v[76:79]
    v_accvgpr_read_b32 v166, a70
    v_accvgpr_read_b32 v167, a71
    v_mfma_f32_16x16x32_bf16 v[80:83], v[240:243], v[148:151], v[80:83]
    v_accvgpr_read_b32 v168, a72
    v_accvgpr_read_b32 v169, a73
    v_mfma_f32_16x16x32_bf16 v[84:87], v[244:247], v[148:151], v[84:87]
    v_accvgpr_read_b32 v170, a74
    v_accvgpr_read_b32 v171, a75
    v_mfma_f32_16x16x32_bf16 v[88:91], v[248:251], v[148:151], v[88:91]
    v_accvgpr_read_b32 v172, a76
    v_accvgpr_read_b32 v173, a77
    v_mfma_f32_16x16x32_bf16 v[92:95], v[252:255], v[148:151], v[92:95]
    v_accvgpr_read_b32 v174, a78
    v_accvgpr_read_b32 v175, a79
    v_mfma_f32_16x16x32_bf16 v[96:99], v[240:243], v[152:155], v[96:99]
    v_perm_b32 v224, v162, v160, s28
    v_perm_b32 v225, v166, v164, s28
    v_mfma_f32_16x16x32_bf16 v[100:103], v[244:247], v[152:155], v[100:103]
    v_perm_b32 v226, v170, v168, s28
    v_perm_b32 v227, v174, v172, s28
    v_mfma_f32_16x16x32_bf16 v[104:107], v[248:251], v[152:155], v[104:107]
    v_perm_b32 v228, v162, v160, s29
    v_perm_b32 v229, v166, v164, s29
    v_mfma_f32_16x16x32_bf16 v[108:111], v[252:255], v[152:155], v[108:111]
    v_perm_b32 v230, v170, v168, s29
    v_perm_b32 v231, v174, v172, s29
    v_mfma_f32_16x16x32_bf16 v[112:115], v[240:243], v[156:159], v[112:115]
    v_perm_b32 v232, v163, v161, s28
    v_perm_b32 v233, v167, v165, s28
    v_mfma_f32_16x16x32_bf16 v[116:119], v[244:247], v[156:159], v[116:119]
    v_perm_b32 v234, v171, v169, s28
    v_perm_b32 v235, v175, v173, s28
    v_mfma_f32_16x16x32_bf16 v[120:123], v[248:251], v[156:159], v[120:123]
    v_perm_b32 v236, v163, v161, s29
    v_perm_b32 v237, v167, v165, s29
    v_mfma_f32_16x16x32_bf16 v[124:127], v[252:255], v[156:159], v[124:127]
    v_perm_b32 v238, v171, v169, s29
    v_perm_b32 v239, v175, v173, s29
    s_waitcnt vmcnt(48)
    s_mov_b32 s30, 1032192
    buffer_load_dwordx2 a[192:193], v8, s[16:19], s30 offen
    buffer_load_dwordx2 a[194:195], v9, s[16:19], s30 offen
    buffer_load_dwordx2 a[196:197], v10, s[16:19], s30 offen
    buffer_load_dwordx2 a[198:199], v11, s[16:19], s30 offen
    buffer_load_dwordx2 a[200:201], v12, s[16:19], s30 offen
    buffer_load_dwordx2 a[202:203], v13, s[16:19], s30 offen
    buffer_load_dwordx2 a[204:205], v14, s[16:19], s30 offen
    buffer_load_dwordx2 a[206:207], v15, s[16:19], s30 offen
    s_waitcnt lgkmcnt(0)
    ds_read_b128 v[144:147], v39 offset:5120
    ds_read_b128 v[148:151], v39 offset:19456
    ds_read_b128 v[152:155], v39 offset:33792
    ds_read_b128 v[156:159], v39 offset:48128
    v_mfma_f32_16x16x32_bf16 v[64:67], v[224:227], v[128:131], v[64:67]
    v_accvgpr_read_b32 v160, a80
    v_accvgpr_read_b32 v161, a81
    v_mfma_f32_16x16x32_bf16 v[68:71], v[228:231], v[128:131], v[68:71]
    v_accvgpr_read_b32 v162, a82
    v_accvgpr_read_b32 v163, a83
    v_mfma_f32_16x16x32_bf16 v[72:75], v[232:235], v[128:131], v[72:75]
    v_accvgpr_read_b32 v164, a84
    v_accvgpr_read_b32 v165, a85
    v_mfma_f32_16x16x32_bf16 v[76:79], v[236:239], v[128:131], v[76:79]
    v_accvgpr_read_b32 v166, a86
    v_accvgpr_read_b32 v167, a87
    v_mfma_f32_16x16x32_bf16 v[80:83], v[224:227], v[132:135], v[80:83]
    v_accvgpr_read_b32 v168, a88
    v_accvgpr_read_b32 v169, a89
    v_mfma_f32_16x16x32_bf16 v[84:87], v[228:231], v[132:135], v[84:87]
    v_accvgpr_read_b32 v170, a90
    v_accvgpr_read_b32 v171, a91
    v_mfma_f32_16x16x32_bf16 v[88:91], v[232:235], v[132:135], v[88:91]
    v_accvgpr_read_b32 v172, a92
    v_accvgpr_read_b32 v173, a93
    v_mfma_f32_16x16x32_bf16 v[92:95], v[236:239], v[132:135], v[92:95]
    v_accvgpr_read_b32 v174, a94
    v_accvgpr_read_b32 v175, a95
    v_mfma_f32_16x16x32_bf16 v[96:99], v[224:227], v[136:139], v[96:99]
    v_perm_b32 v240, v162, v160, s28
    v_perm_b32 v241, v166, v164, s28
    v_mfma_f32_16x16x32_bf16 v[100:103], v[228:231], v[136:139], v[100:103]
    v_perm_b32 v242, v170, v168, s28
    v_perm_b32 v243, v174, v172, s28
    v_mfma_f32_16x16x32_bf16 v[104:107], v[232:235], v[136:139], v[104:107]
    v_perm_b32 v244, v162, v160, s29
    v_perm_b32 v245, v166, v164, s29
    v_mfma_f32_16x16x32_bf16 v[108:111], v[236:239], v[136:139], v[108:111]
    v_perm_b32 v246, v170, v168, s29
    v_perm_b32 v247, v174, v172, s29
    v_mfma_f32_16x16x32_bf16 v[112:115], v[224:227], v[140:143], v[112:115]
    v_perm_b32 v248, v163, v161, s28
    v_perm_b32 v249, v167, v165, s28
    v_mfma_f32_16x16x32_bf16 v[116:119], v[228:231], v[140:143], v[116:119]
    v_perm_b32 v250, v171, v169, s28
    v_perm_b32 v251, v175, v173, s28
    v_mfma_f32_16x16x32_bf16 v[120:123], v[232:235], v[140:143], v[120:123]
    v_perm_b32 v252, v163, v161, s29
    v_perm_b32 v253, v167, v165, s29
    v_mfma_f32_16x16x32_bf16 v[124:127], v[236:239], v[140:143], v[124:127]
    v_perm_b32 v254, v171, v169, s29
    v_perm_b32 v255, v175, v173, s29
    s_waitcnt vmcnt(48)
    s_mov_b32 s30, 1118208
    buffer_load_dwordx2 a[208:209], v8, s[16:19], s30 offen
    buffer_load_dwordx2 a[210:211], v9, s[16:19], s30 offen
    buffer_load_dwordx2 a[212:213], v10, s[16:19], s30 offen
    buffer_load_dwordx2 a[214:215], v11, s[16:19], s30 offen
    buffer_load_dwordx2 a[216:217], v12, s[16:19], s30 offen
    buffer_load_dwordx2 a[218:219], v13, s[16:19], s30 offen
    buffer_load_dwordx2 a[220:221], v14, s[16:19], s30 offen
    buffer_load_dwordx2 a[222:223], v15, s[16:19], s30 offen
    s_waitcnt lgkmcnt(0)
    ds_read_b128 v[128:131], v39 offset:6144
    ds_read_b128 v[132:135], v39 offset:20480
    ds_read_b128 v[136:139], v39 offset:34816
    ds_read_b128 v[140:143], v39 offset:49152
    v_mfma_f32_16x16x32_bf16 v[64:67], v[240:243], v[144:147], v[64:67]
    v_accvgpr_read_b32 v160, a96
    v_accvgpr_read_b32 v161, a97
    v_mfma_f32_16x16x32_bf16 v[68:71], v[244:247], v[144:147], v[68:71]
    v_accvgpr_read_b32 v162, a98
    v_accvgpr_read_b32 v163, a99
    v_mfma_f32_16x16x32_bf16 v[72:75], v[248:251], v[144:147], v[72:75]
    v_accvgpr_read_b32 v164, a100
    v_accvgpr_read_b32 v165, a101
    v_mfma_f32_16x16x32_bf16 v[76:79], v[252:255], v[144:147], v[76:79]
    v_accvgpr_read_b32 v166, a102
    v_accvgpr_read_b32 v167, a103
    v_mfma_f32_16x16x32_bf16 v[80:83], v[240:243], v[148:151], v[80:83]
    v_accvgpr_read_b32 v168, a104
    v_accvgpr_read_b32 v169, a105
    v_mfma_f32_16x16x32_bf16 v[84:87], v[244:247], v[148:151], v[84:87]
    v_accvgpr_read_b32 v170, a106
    v_accvgpr_read_b32 v171, a107
    v_mfma_f32_16x16x32_bf16 v[88:91], v[248:251], v[148:151], v[88:91]
    v_accvgpr_read_b32 v172, a108
    v_accvgpr_read_b32 v173, a109
    v_mfma_f32_16x16x32_bf16 v[92:95], v[252:255], v[148:151], v[92:95]
    v_accvgpr_read_b32 v174, a110
    v_accvgpr_read_b32 v175, a111
    v_mfma_f32_16x16x32_bf16 v[96:99], v[240:243], v[152:155], v[96:99]
    v_perm_b32 v224, v162, v160, s28
    v_perm_b32 v225, v166, v164, s28
    v_mfma_f32_16x16x32_bf16 v[100:103], v[244:247], v[152:155], v[100:103]
    v_perm_b32 v226, v170, v168, s28
    v_perm_b32 v227, v174, v172, s28
    v_mfma_f32_16x16x32_bf16 v[104:107], v[248:251], v[152:155], v[104:107]
    v_perm_b32 v228, v162, v160, s29
    v_perm_b32 v229, v166, v164, s29
    v_mfma_f32_16x16x32_bf16 v[108:111], v[252:255], v[152:155], v[108:111]
    v_perm_b32 v230, v170, v168, s29
    v_perm_b32 v231, v174, v172, s29
    v_mfma_f32_16x16x32_bf16 v[112:115], v[240:243], v[156:159], v[112:115]
    v_perm_b32 v232, v163, v161, s28
    v_perm_b32 v233, v167, v165, s28
    v_mfma_f32_16x16x32_bf16 v[116:119], v[244:247], v[156:159], v[116:119]
    v_perm_b32 v234, v171, v169, s28
    v_perm_b32 v235, v175, v173, s28
    v_mfma_f32_16x16x32_bf16 v[120:123], v[248:251], v[156:159], v[120:123]
    v_perm_b32 v236, v163, v161, s29
    v_perm_b32 v237, v167, v165, s29
    v_mfma_f32_16x16x32_bf16 v[124:127], v[252:255], v[156:159], v[124:127]
    v_perm_b32 v238, v171, v169, s29
    v_perm_b32 v239, v175, v173, s29
    s_waitcnt vmcnt(48)
    s_waitcnt lgkmcnt(0)
    ds_read_b128 v[144:147], v39 offset:7168
    ds_read_b128 v[148:151], v39 offset:21504
    ds_read_b128 v[152:155], v39 offset:35840
    ds_read_b128 v[156:159], v39 offset:50176
    v_mfma_f32_16x16x32_bf16 v[64:67], v[224:227], v[128:131], v[64:67]
    v_accvgpr_read_b32 v160, a112
    v_accvgpr_read_b32 v161, a113
    v_mfma_f32_16x16x32_bf16 v[68:71], v[228:231], v[128:131], v[68:71]
    v_accvgpr_read_b32 v162, a114
    v_accvgpr_read_b32 v163, a115
    v_mfma_f32_16x16x32_bf16 v[72:75], v[232:235], v[128:131], v[72:75]
    v_accvgpr_read_b32 v164, a116
    v_accvgpr_read_b32 v165, a117
    v_mfma_f32_16x16x32_bf16 v[76:79], v[236:239], v[128:131], v[76:79]
    v_accvgpr_read_b32 v166, a118
    v_accvgpr_read_b32 v167, a119
    v_mfma_f32_16x16x32_bf16 v[80:83], v[224:227], v[132:135], v[80:83]
    v_accvgpr_read_b32 v168, a120
    v_accvgpr_read_b32 v169, a121
    v_mfma_f32_16x16x32_bf16 v[84:87], v[228:231], v[132:135], v[84:87]
    v_accvgpr_read_b32 v170, a122
    v_accvgpr_read_b32 v171, a123
    v_mfma_f32_16x16x32_bf16 v[88:91], v[232:235], v[132:135], v[88:91]
    v_accvgpr_read_b32 v172, a124
    v_accvgpr_read_b32 v173, a125
    v_mfma_f32_16x16x32_bf16 v[92:95], v[236:239], v[132:135], v[92:95]
    v_accvgpr_read_b32 v174, a126
    v_accvgpr_read_b32 v175, a127
    v_mfma_f32_16x16x32_bf16 v[96:99], v[224:227], v[136:139], v[96:99]
    v_perm_b32 v240, v162, v160, s28
    v_perm_b32 v241, v166, v164, s28
    v_mfma_f32_16x16x32_bf16 v[100:103], v[228:231], v[136:139], v[100:103]
    v_perm_b32 v242, v170, v168, s28
    v_perm_b32 v243, v174, v172, s28
    v_mfma_f32_16x16x32_bf16 v[104:107], v[232:235], v[136:139], v[104:107]
    v_perm_b32 v244, v162, v160, s29
    v_perm_b32 v245, v166, v164, s29
    v_mfma_f32_16x16x32_bf16 v[108:111], v[236:239], v[136:139], v[108:111]
    v_perm_b32 v246, v170, v168, s29
    v_perm_b32 v247, v174, v172, s29
    v_mfma_f32_16x16x32_bf16 v[112:115], v[224:227], v[140:143], v[112:115]
    v_perm_b32 v248, v163, v161, s28
    v_perm_b32 v249, v167, v165, s28
    v_mfma_f32_16x16x32_bf16 v[116:119], v[228:231], v[140:143], v[116:119]
    v_perm_b32 v250, v171, v169, s28
    v_perm_b32 v251, v175, v173, s28
    v_mfma_f32_16x16x32_bf16 v[120:123], v[232:235], v[140:143], v[120:123]
    v_perm_b32 v252, v163, v161, s29
    v_perm_b32 v253, v167, v165, s29
    v_mfma_f32_16x16x32_bf16 v[124:127], v[236:239], v[140:143], v[124:127]
    v_perm_b32 v254, v171, v169, s29
    v_perm_b32 v255, v175, v173, s29
    s_waitcnt vmcnt(40)
    s_waitcnt lgkmcnt(0)
    ds_read_b128 v[128:131], v39 offset:8192
    ds_read_b128 v[132:135], v39 offset:22528
    ds_read_b128 v[136:139], v39 offset:36864
    ds_read_b128 v[140:143], v39 offset:51200
    v_mfma_f32_16x16x32_bf16 v[64:67], v[240:243], v[144:147], v[64:67]
    v_accvgpr_read_b32 v160, a128
    v_accvgpr_read_b32 v161, a129
    v_mfma_f32_16x16x32_bf16 v[68:71], v[244:247], v[144:147], v[68:71]
    v_accvgpr_read_b32 v162, a130
    v_accvgpr_read_b32 v163, a131
    v_mfma_f32_16x16x32_bf16 v[72:75], v[248:251], v[144:147], v[72:75]
    v_accvgpr_read_b32 v164, a132
    v_accvgpr_read_b32 v165, a133
    v_mfma_f32_16x16x32_bf16 v[76:79], v[252:255], v[144:147], v[76:79]
    v_accvgpr_read_b32 v166, a134
    v_accvgpr_read_b32 v167, a135
    v_mfma_f32_16x16x32_bf16 v[80:83], v[240:243], v[148:151], v[80:83]
    v_accvgpr_read_b32 v168, a136
    v_accvgpr_read_b32 v169, a137
    v_mfma_f32_16x16x32_bf16 v[84:87], v[244:247], v[148:151], v[84:87]
    v_accvgpr_read_b32 v170, a138
    v_accvgpr_read_b32 v171, a139
    v_mfma_f32_16x16x32_bf16 v[88:91], v[248:251], v[148:151], v[88:91]
    v_accvgpr_read_b32 v172, a140
    v_accvgpr_read_b32 v173, a141
    v_mfma_f32_16x16x32_bf16 v[92:95], v[252:255], v[148:151], v[92:95]
    v_accvgpr_read_b32 v174, a142
    v_accvgpr_read_b32 v175, a143
    v_mfma_f32_16x16x32_bf16 v[96:99], v[240:243], v[152:155], v[96:99]
    v_perm_b32 v224, v162, v160, s28
    v_perm_b32 v225, v166, v164, s28
    v_mfma_f32_16x16x32_bf16 v[100:103], v[244:247], v[152:155], v[100:103]
    v_perm_b32 v226, v170, v168, s28
    v_perm_b32 v227, v174, v172, s28
    v_mfma_f32_16x16x32_bf16 v[104:107], v[248:251], v[152:155], v[104:107]
    v_perm_b32 v228, v162, v160, s29
    v_perm_b32 v229, v166, v164, s29
    v_mfma_f32_16x16x32_bf16 v[108:111], v[252:255], v[152:155], v[108:111]
    v_perm_b32 v230, v170, v168, s29
    v_perm_b32 v231, v174, v172, s29
    v_mfma_f32_16x16x32_bf16 v[112:115], v[240:243], v[156:159], v[112:115]
    v_perm_b32 v232, v163, v161, s28
    v_perm_b32 v233, v167, v165, s28
    v_mfma_f32_16x16x32_bf16 v[116:119], v[244:247], v[156:159], v[116:119]
    v_perm_b32 v234, v171, v169, s28
    v_perm_b32 v235, v175, v173, s28
    v_mfma_f32_16x16x32_bf16 v[120:123], v[248:251], v[156:159], v[120:123]
    v_perm_b32 v236, v163, v161, s29
    v_perm_b32 v237, v167, v165, s29
    v_mfma_f32_16x16x32_bf16 v[124:127], v[252:255], v[156:159], v[124:127]
    v_perm_b32 v238, v171, v169, s29
    v_perm_b32 v239, v175, v173, s29
    s_waitcnt vmcnt(32)
    s_waitcnt lgkmcnt(0)
    ds_read_b128 v[144:147], v39 offset:9216
    ds_read_b128 v[148:151], v39 offset:23552
    ds_read_b128 v[152:155], v39 offset:37888
    ds_read_b128 v[156:159], v39 offset:52224
    v_mfma_f32_16x16x32_bf16 v[64:67], v[224:227], v[128:131], v[64:67]
    v_accvgpr_read_b32 v160, a144
    v_accvgpr_read_b32 v161, a145
    v_mfma_f32_16x16x32_bf16 v[68:71], v[228:231], v[128:131], v[68:71]
    v_accvgpr_read_b32 v162, a146
    v_accvgpr_read_b32 v163, a147
    v_mfma_f32_16x16x32_bf16 v[72:75], v[232:235], v[128:131], v[72:75]
    v_accvgpr_read_b32 v164, a148
    v_accvgpr_read_b32 v165, a149
    v_mfma_f32_16x16x32_bf16 v[76:79], v[236:239], v[128:131], v[76:79]
    v_accvgpr_read_b32 v166, a150
    v_accvgpr_read_b32 v167, a151
    v_mfma_f32_16x16x32_bf16 v[80:83], v[224:227], v[132:135], v[80:83]
    v_accvgpr_read_b32 v168, a152
    v_accvgpr_read_b32 v169, a153
    v_mfma_f32_16x16x32_bf16 v[84:87], v[228:231], v[132:135], v[84:87]
    v_accvgpr_read_b32 v170, a154
    v_accvgpr_read_b32 v171, a155
    v_mfma_f32_16x16x32_bf16 v[88:91], v[232:235], v[132:135], v[88:91]
    v_accvgpr_read_b32 v172, a156
    v_accvgpr_read_b32 v173, a157
    v_mfma_f32_16x16x32_bf16 v[92:95], v[236:239], v[132:135], v[92:95]
    v_accvgpr_read_b32 v174, a158
    v_accvgpr_read_b32 v175, a159
    v_mfma_f32_16x16x32_bf16 v[96:99], v[224:227], v[136:139], v[96:99]
    v_perm_b32 v240, v162, v160, s28
    v_perm_b32 v241, v166, v164, s28
    v_mfma_f32_16x16x32_bf16 v[100:103], v[228:231], v[136:139], v[100:103]
    v_perm_b32 v242, v170, v168, s28
    v_perm_b32 v243, v174, v172, s28
    v_mfma_f32_16x16x32_bf16 v[104:107], v[232:235], v[136:139], v[104:107]
    v_perm_b32 v244, v162, v160, s29
    v_perm_b32 v245, v166, v164, s29
    v_mfma_f32_16x16x32_bf16 v[108:111], v[236:239], v[136:139], v[108:111]
    v_perm_b32 v246, v170, v168, s29
    v_perm_b32 v247, v174, v172, s29
    v_mfma_f32_16x16x32_bf16 v[112:115], v[224:227], v[140:143], v[112:115]
    v_perm_b32 v248, v163, v161, s28
    v_perm_b32 v249, v167, v165, s28
    v_mfma_f32_16x16x32_bf16 v[116:119], v[228:231], v[140:143], v[116:119]
    v_perm_b32 v250, v171, v169, s28
    v_perm_b32 v251, v175, v173, s28
    v_mfma_f32_16x16x32_bf16 v[120:123], v[232:235], v[140:143], v[120:123]
    v_perm_b32 v252, v163, v161, s29
    v_perm_b32 v253, v167, v165, s29
    v_mfma_f32_16x16x32_bf16 v[124:127], v[236:239], v[140:143], v[124:127]
    v_perm_b32 v254, v171, v169, s29
    v_perm_b32 v255, v175, v173, s29
    s_waitcnt vmcnt(24)
    s_waitcnt lgkmcnt(0)
    ds_read_b128 v[128:131], v39 offset:10240
    ds_read_b128 v[132:135], v39 offset:24576
    ds_read_b128 v[136:139], v39 offset:38912
    ds_read_b128 v[140:143], v39 offset:53248
    v_mfma_f32_16x16x32_bf16 v[64:67], v[240:243], v[144:147], v[64:67]
    v_accvgpr_read_b32 v160, a160
    v_accvgpr_read_b32 v161, a161
    v_mfma_f32_16x16x32_bf16 v[68:71], v[244:247], v[144:147], v[68:71]
    v_accvgpr_read_b32 v162, a162
    v_accvgpr_read_b32 v163, a163
    v_mfma_f32_16x16x32_bf16 v[72:75], v[248:251], v[144:147], v[72:75]
    v_accvgpr_read_b32 v164, a164
    v_accvgpr_read_b32 v165, a165
    v_mfma_f32_16x16x32_bf16 v[76:79], v[252:255], v[144:147], v[76:79]
    v_accvgpr_read_b32 v166, a166
    v_accvgpr_read_b32 v167, a167
    v_mfma_f32_16x16x32_bf16 v[80:83], v[240:243], v[148:151], v[80:83]
    v_accvgpr_read_b32 v168, a168
    v_accvgpr_read_b32 v169, a169
    v_mfma_f32_16x16x32_bf16 v[84:87], v[244:247], v[148:151], v[84:87]
    v_accvgpr_read_b32 v170, a170
    v_accvgpr_read_b32 v171, a171
    v_mfma_f32_16x16x32_bf16 v[88:91], v[248:251], v[148:151], v[88:91]
    v_accvgpr_read_b32 v172, a172
    v_accvgpr_read_b32 v173, a173
    v_mfma_f32_16x16x32_bf16 v[92:95], v[252:255], v[148:151], v[92:95]
    v_accvgpr_read_b32 v174, a174
    v_accvgpr_read_b32 v175, a175
    v_mfma_f32_16x16x32_bf16 v[96:99], v[240:243], v[152:155], v[96:99]
    v_perm_b32 v224, v162, v160, s28
    v_perm_b32 v225, v166, v164, s28
    v_mfma_f32_16x16x32_bf16 v[100:103], v[244:247], v[152:155], v[100:103]
    v_perm_b32 v226, v170, v168, s28
    v_perm_b32 v227, v174, v172, s28
    v_mfma_f32_16x16x32_bf16 v[104:107], v[248:251], v[152:155], v[104:107]
    v_perm_b32 v228, v162, v160, s29
    v_perm_b32 v229, v166, v164, s29
    v_mfma_f32_16x16x32_bf16 v[108:111], v[252:255], v[152:155], v[108:111]
    v_perm_b32 v230, v170, v168, s29
    v_perm_b32 v231, v174, v172, s29
    v_mfma_f32_16x16x32_bf16 v[112:115], v[240:243], v[156:159], v[112:115]
    v_perm_b32 v232, v163, v161, s28
    v_perm_b32 v233, v167, v165, s28
    v_mfma_f32_16x16x32_bf16 v[116:119], v[244:247], v[156:159], v[116:119]
    v_perm_b32 v234, v171, v169, s28
    v_perm_b32 v235, v175, v173, s28
    v_mfma_f32_16x16x32_bf16 v[120:123], v[248:251], v[156:159], v[120:123]
    v_perm_b32 v236, v163, v161, s29
    v_perm_b32 v237, v167, v165, s29
    v_mfma_f32_16x16x32_bf16 v[124:127], v[252:255], v[156:159], v[124:127]
    v_perm_b32 v238, v171, v169, s29
    v_perm_b32 v239, v175, v173, s29
    s_waitcnt vmcnt(16)
    s_waitcnt lgkmcnt(0)
    ds_read_b128 v[144:147], v39 offset:11264
    ds_read_b128 v[148:151], v39 offset:25600
    ds_read_b128 v[152:155], v39 offset:39936
    ds_read_b128 v[156:159], v39 offset:54272
    v_mfma_f32_16x16x32_bf16 v[64:67], v[224:227], v[128:131], v[64:67]
    v_accvgpr_read_b32 v160, a176
    v_accvgpr_read_b32 v161, a177
    v_mfma_f32_16x16x32_bf16 v[68:71], v[228:231], v[128:131], v[68:71]
    v_accvgpr_read_b32 v162, a178
    v_accvgpr_read_b32 v163, a179
    v_mfma_f32_16x16x32_bf16 v[72:75], v[232:235], v[128:131], v[72:75]
    v_accvgpr_read_b32 v164, a180
    v_accvgpr_read_b32 v165, a181
    v_mfma_f32_16x16x32_bf16 v[76:79], v[236:239], v[128:131], v[76:79]
    v_accvgpr_read_b32 v166, a182
    v_accvgpr_read_b32 v167, a183
    v_mfma_f32_16x16x32_bf16 v[80:83], v[224:227], v[132:135], v[80:83]
    v_accvgpr_read_b32 v168, a184
    v_accvgpr_read_b32 v169, a185
    v_mfma_f32_16x16x32_bf16 v[84:87], v[228:231], v[132:135], v[84:87]
    v_accvgpr_read_b32 v170, a186
    v_accvgpr_read_b32 v171, a187
    v_mfma_f32_16x16x32_bf16 v[88:91], v[232:235], v[132:135], v[88:91]
    v_accvgpr_read_b32 v172, a188
    v_accvgpr_read_b32 v173, a189
    v_mfma_f32_16x16x32_bf16 v[92:95], v[236:239], v[132:135], v[92:95]
    v_accvgpr_read_b32 v174, a190
    v_accvgpr_read_b32 v175, a191
    v_mfma_f32_16x16x32_bf16 v[96:99], v[224:227], v[136:139], v[96:99]
    v_perm_b32 v240, v162, v160, s28
    v_perm_b32 v241, v166, v164, s28
    v_mfma_f32_16x16x32_bf16 v[100:103], v[228:231], v[136:139], v[100:103]
    v_perm_b32 v242, v170, v168, s28
    v_perm_b32 v243, v174, v172, s28
    v_mfma_f32_16x16x32_bf16 v[104:107], v[232:235], v[136:139], v[104:107]
    v_perm_b32 v244, v162, v160, s29
    v_perm_b32 v245, v166, v164, s29
    v_mfma_f32_16x16x32_bf16 v[108:111], v[236:239], v[136:139], v[108:111]
    v_perm_b32 v246, v170, v168, s29
    v_perm_b32 v247, v174, v172, s29
    v_mfma_f32_16x16x32_bf16 v[112:115], v[224:227], v[140:143], v[112:115]
    v_perm_b32 v248, v163, v161, s28
    v_perm_b32 v249, v167, v165, s28
    v_mfma_f32_16x16x32_bf16 v[116:119], v[228:231], v[140:143], v[116:119]
    v_perm_b32 v250, v171, v169, s28
    v_perm_b32 v251, v175, v173, s28
    v_mfma_f32_16x16x32_bf16 v[120:123], v[232:235], v[140:143], v[120:123]
    v_perm_b32 v252, v163, v161, s29
    v_perm_b32 v253, v167, v165, s29
    v_mfma_f32_16x16x32_bf16 v[124:127], v[236:239], v[140:143], v[124:127]
    v_perm_b32 v254, v171, v169, s29
    v_perm_b32 v255, v175, v173, s29
    s_waitcnt vmcnt(8)
    s_waitcnt lgkmcnt(0)
    ds_read_b128 v[128:131], v39 offset:12288
    ds_read_b128 v[132:135], v39 offset:26624
    ds_read_b128 v[136:139], v39 offset:40960
    ds_read_b128 v[140:143], v39 offset:55296
    v_mfma_f32_16x16x32_bf16 v[64:67], v[240:243], v[144:147], v[64:67]
    v_accvgpr_read_b32 v160, a192
    v_accvgpr_read_b32 v161, a193
    v_mfma_f32_16x16x32_bf16 v[68:71], v[244:247], v[144:147], v[68:71]
    v_accvgpr_read_b32 v162, a194
    v_accvgpr_read_b32 v163, a195
    v_mfma_f32_16x16x32_bf16 v[72:75], v[248:251], v[144:147], v[72:75]
    v_accvgpr_read_b32 v164, a196
    v_accvgpr_read_b32 v165, a197
    v_mfma_f32_16x16x32_bf16 v[76:79], v[252:255], v[144:147], v[76:79]
    v_accvgpr_read_b32 v166, a198
    v_accvgpr_read_b32 v167, a199
    v_mfma_f32_16x16x32_bf16 v[80:83], v[240:243], v[148:151], v[80:83]
    v_accvgpr_read_b32 v168, a200
    v_accvgpr_read_b32 v169, a201
    v_mfma_f32_16x16x32_bf16 v[84:87], v[244:247], v[148:151], v[84:87]
    v_accvgpr_read_b32 v170, a202
    v_accvgpr_read_b32 v171, a203
    v_mfma_f32_16x16x32_bf16 v[88:91], v[248:251], v[148:151], v[88:91]
    v_accvgpr_read_b32 v172, a204
    v_accvgpr_read_b32 v173, a205
    v_mfma_f32_16x16x32_bf16 v[92:95], v[252:255], v[148:151], v[92:95]
    v_accvgpr_read_b32 v174, a206
    v_accvgpr_read_b32 v175, a207
    v_mfma_f32_16x16x32_bf16 v[96:99], v[240:243], v[152:155], v[96:99]
    v_perm_b32 v224, v162, v160, s28
    v_perm_b32 v225, v166, v164, s28
    v_mfma_f32_16x16x32_bf16 v[100:103], v[244:247], v[152:155], v[100:103]
    v_perm_b32 v226, v170, v168, s28
    v_perm_b32 v227, v174, v172, s28
    v_mfma_f32_16x16x32_bf16 v[104:107], v[248:251], v[152:155], v[104:107]
    v_perm_b32 v228, v162, v160, s29
    v_perm_b32 v229, v166, v164, s29
    v_mfma_f32_16x16x32_bf16 v[108:111], v[252:255], v[152:155], v[108:111]
    v_perm_b32 v230, v170, v168, s29
    v_perm_b32 v231, v174, v172, s29
    v_mfma_f32_16x16x32_bf16 v[112:115], v[240:243], v[156:159], v[112:115]
    v_perm_b32 v232, v163, v161, s28
    v_perm_b32 v233, v167, v165, s28
    v_mfma_f32_16x16x32_bf16 v[116:119], v[244:247], v[156:159], v[116:119]
    v_perm_b32 v234, v171, v169, s28
    v_perm_b32 v235, v175, v173, s28
    v_mfma_f32_16x16x32_bf16 v[120:123], v[248:251], v[156:159], v[120:123]
    v_perm_b32 v236, v163, v161, s29
    v_perm_b32 v237, v167, v165, s29
    v_mfma_f32_16x16x32_bf16 v[124:127], v[252:255], v[156:159], v[124:127]
    v_perm_b32 v238, v171, v169, s29
    v_perm_b32 v239, v175, v173, s29
    s_waitcnt vmcnt(0)
    s_waitcnt lgkmcnt(0)
    ds_read_b128 v[144:147], v39 offset:13312
    ds_read_b128 v[148:151], v39 offset:27648
    ds_read_b128 v[152:155], v39 offset:41984
    ds_read_b128 v[156:159], v39 offset:56320
    v_mfma_f32_16x16x32_bf16 v[64:67], v[224:227], v[128:131], v[64:67]
    v_accvgpr_read_b32 v160, a208
    v_accvgpr_read_b32 v161, a209
    v_mfma_f32_16x16x32_bf16 v[68:71], v[228:231], v[128:131], v[68:71]
    v_accvgpr_read_b32 v162, a210
    v_accvgpr_read_b32 v163, a211
    v_mfma_f32_16x16x32_bf16 v[72:75], v[232:235], v[128:131], v[72:75]
    v_accvgpr_read_b32 v164, a212
    v_accvgpr_read_b32 v165, a213
    v_mfma_f32_16x16x32_bf16 v[76:79], v[236:239], v[128:131], v[76:79]
    v_accvgpr_read_b32 v166, a214
    v_accvgpr_read_b32 v167, a215
    v_mfma_f32_16x16x32_bf16 v[80:83], v[224:227], v[132:135], v[80:83]
    v_accvgpr_read_b32 v168, a216
    v_accvgpr_read_b32 v169, a217
    v_mfma_f32_16x16x32_bf16 v[84:87], v[228:231], v[132:135], v[84:87]
    v_accvgpr_read_b32 v170, a218
    v_accvgpr_read_b32 v171, a219
    v_mfma_f32_16x16x32_bf16 v[88:91], v[232:235], v[132:135], v[88:91]
    v_accvgpr_read_b32 v172, a220
    v_accvgpr_read_b32 v173, a221
    v_mfma_f32_16x16x32_bf16 v[92:95], v[236:239], v[132:135], v[92:95]
    v_accvgpr_read_b32 v174, a222
    v_accvgpr_read_b32 v175, a223
    v_mfma_f32_16x16x32_bf16 v[96:99], v[224:227], v[136:139], v[96:99]
    v_perm_b32 v240, v162, v160, s28
    v_perm_b32 v241, v166, v164, s28
    v_mfma_f32_16x16x32_bf16 v[100:103], v[228:231], v[136:139], v[100:103]
    v_perm_b32 v242, v170, v168, s28
    v_perm_b32 v243, v174, v172, s28
    v_mfma_f32_16x16x32_bf16 v[104:107], v[232:235], v[136:139], v[104:107]
    v_perm_b32 v244, v162, v160, s29
    v_perm_b32 v245, v166, v164, s29
    v_mfma_f32_16x16x32_bf16 v[108:111], v[236:239], v[136:139], v[108:111]
    v_perm_b32 v246, v170, v168, s29
    v_perm_b32 v247, v174, v172, s29
    v_mfma_f32_16x16x32_bf16 v[112:115], v[224:227], v[140:143], v[112:115]
    v_perm_b32 v248, v163, v161, s28
    v_perm_b32 v249, v167, v165, s28
    v_mfma_f32_16x16x32_bf16 v[116:119], v[228:231], v[140:143], v[116:119]
    v_perm_b32 v250, v171, v169, s28
    v_perm_b32 v251, v175, v173, s28
    v_mfma_f32_16x16x32_bf16 v[120:123], v[232:235], v[140:143], v[120:123]
    v_perm_b32 v252, v163, v161, s29
    v_perm_b32 v253, v167, v165, s29
    v_mfma_f32_16x16x32_bf16 v[124:127], v[236:239], v[140:143], v[124:127]
    v_perm_b32 v254, v171, v169, s29
    v_perm_b32 v255, v175, v173, s29
    s_waitcnt lgkmcnt(0)
    v_mfma_f32_16x16x32_bf16 v[64:67], v[240:243], v[144:147], v[64:67]
    v_mfma_f32_16x16x32_bf16 v[68:71], v[244:247], v[144:147], v[68:71]
    v_mfma_f32_16x16x32_bf16 v[72:75], v[248:251], v[144:147], v[72:75]
    v_mfma_f32_16x16x32_bf16 v[76:79], v[252:255], v[144:147], v[76:79]
    v_mfma_f32_16x16x32_bf16 v[80:83], v[240:243], v[148:151], v[80:83]
    v_mfma_f32_16x16x32_bf16 v[84:87], v[244:247], v[148:151], v[84:87]
    v_mfma_f32_16x16x32_bf16 v[88:91], v[248:251], v[148:151], v[88:91]
    v_mfma_f32_16x16x32_bf16 v[92:95], v[252:255], v[148:151], v[92:95]
    v_mfma_f32_16x16x32_bf16 v[96:99], v[240:243], v[152:155], v[96:99]
    v_mfma_f32_16x16x32_bf16 v[100:103], v[244:247], v[152:155], v[100:103]
    v_mfma_f32_16x16x32_bf16 v[104:107], v[248:251], v[152:155], v[104:107]
    v_mfma_f32_16x16x32_bf16 v[108:111], v[252:255], v[152:155], v[108:111]
    v_mfma_f32_16x16x32_bf16 v[112:115], v[240:243], v[156:159], v[112:115]
    v_mfma_f32_16x16x32_bf16 v[116:119], v[244:247], v[156:159], v[116:119]
    v_mfma_f32_16x16x32_bf16 v[120:123], v[248:251], v[156:159], v[120:123]
    v_mfma_f32_16x16x32_bf16 v[124:127], v[252:255], v[156:159], v[124:127]
    s_nop 7
    s_cmp_ge_u32 s34, 7
    s_cselect_b32 s42, 7, 0
    s_cselect_b32 s43, 0x200000, 0
    s_sub_u32 s42, s34, s42
    s_lshl_b32 s42, s42, 4
    s_lshl_b32 s44, s31, 12
    s_add_u32 s43, s43, s44
    v_lshl_add_u32 v16, v3, 2, s42
    v_add_u32 v17, 0, v16
    v_mul_u32_u24 v18, 147, v17
    v_lshrrev_b32 v18, 10, v18
    v_mul_u32_u24 v19, 7, v18
    v_sub_u32 v19, v17, v19
    v_lshlrev_b32 v20, 17, v18
    v_lshrrev_b32 v17, 2, v19
    v_lshl_add_u32 v20, v17, 10, v20
    v_bfe_u32 v17, v19, 1, 1
    v_lshl_add_u32 v20, v17, 9, v20
    v_and_b32 v17, 1, v19
    v_lshl_add_u32 v20, v17, 3, v20
    v_lshl_add_u32 v20, v2, 4, v20
    v_add_u32 v17, 1, v16
    v_mul_u32_u24 v18, 147, v17
    v_lshrrev_b32 v18, 10, v18
    v_mul_u32_u24 v19, 7, v18
    v_sub_u32 v19, v17, v19
    v_lshlrev_b32 v21, 17, v18
    v_lshrrev_b32 v17, 2, v19
    v_lshl_add_u32 v21, v17, 10, v21
    v_bfe_u32 v17, v19, 1, 1
    v_lshl_add_u32 v21, v17, 9, v21
    v_and_b32 v17, 1, v19
    v_lshl_add_u32 v21, v17, 3, v21
    v_lshl_add_u32 v21, v2, 4, v21
    v_add_u32 v17, 2, v16
    v_mul_u32_u24 v18, 147, v17
    v_lshrrev_b32 v18, 10, v18
    v_mul_u32_u24 v19, 7, v18
    v_sub_u32 v19, v17, v19
    v_lshlrev_b32 v22, 17, v18
    v_lshrrev_b32 v17, 2, v19
    v_lshl_add_u32 v22, v17, 10, v22
    v_bfe_u32 v17, v19, 1, 1
    v_lshl_add_u32 v22, v17, 9, v22
    v_and_b32 v17, 1, v19
    v_lshl_add_u32 v22, v17, 3, v22
    v_lshl_add_u32 v22, v2, 4, v22
    v_add_u32 v17, 3, v16
    v_mul_u32_u24 v18, 147, v17
    v_lshrrev_b32 v18, 10, v18
    v_mul_u32_u24 v19, 7, v18
    v_sub_u32 v19, v17, v19
    v_lshlrev_b32 v23, 17, v18
    v_lshrrev_b32 v17, 2, v19
    v_lshl_add_u32 v23, v17, 10, v23
    v_bfe_u32 v17, v19, 1, 1
    v_lshl_add_u32 v23, v17, 9, v23
    v_and_b32 v17, 1, v19
    v_lshl_add_u32 v23, v17, 3, v23
    v_lshl_add_u32 v23, v2, 4, v23
    s_mov_b32 s45, 0x3e8b97f6
    s_cmp_ge_u32 s34, 7
    s_cbranch_scc1 k1_qkv_kernel_nosc
    v_mul_f32 v64, s45, v64
    v_mul_f32 v65, s45, v65
    v_mul_f32 v66, s45, v66
    v_mul_f32 v67, s45, v67
    v_mul_f32 v68, s45, v68
    v_mul_f32 v69, s45, v69
    v_mul_f32 v70, s45, v70
    v_mul_f32 v71, s45, v71
    v_mul_f32 v72, s45, v72
    v_mul_f32 v73, s45, v73
    v_mul_f32 v74, s45, v74
    v_mul_f32 v75, s45, v75
    v_mul_f32 v76, s45, v76
    v_mul_f32 v77, s45, v77
    v_mul_f32 v78, s45, v78
    v_mul_f32 v79, s45, v79
    v_mul_f32 v80, s45, v80
    v_mul_f32 v81, s45, v81
    v_mul_f32 v82, s45, v82
    v_mul_f32 v83, s45, v83
    v_mul_f32 v84, s45, v84
    v_mul_f32 v85, s45, v85
    v_mul_f32 v86, s45, v86
    v_mul_f32 v87, s45, v87
    v_mul_f32 v88, s45, v88
    v_mul_f32 v89, s45, v89
    v_mul_f32 v90, s45, v90
    v_mul_f32 v91, s45, v91
    v_mul_f32 v92, s45, v92
    v_mul_f32 v93, s45, v93
    v_mul_f32 v94, s45, v94
    v_mul_f32 v95, s45, v95
    v_mul_f32 v96, s45, v96
    v_mul_f32 v97, s45, v97
    v_mul_f32 v98, s45, v98
    v_mul_f32 v99, s45, v99
    v_mul_f32 v100, s45, v100
    v_mul_f32 v101, s45, v101
    v_mul_f32 v102, s45, v102
    v_mul_f32 v103, s45, v103
    v_mul_f32 v104, s45, v104
    v_mul_f32 v105, s45, v105
    v_mul_f32 v106, s45, v106
    v_mul_f32 v107, s45, v107
    v_mul_f32 v108, s45, v108
    v_mul_f32 v109, s45, v109
    v_mul_f32 v110, s45, v110
    v_mul_f32 v111, s45, v111
    v_mul_f32 v112, s45, v112
    v_mul_f32 v113, s45, v113
    v_mul_f32 v114, s45, v114
    v_mul_f32 v115, s45, v115
    v_mul_f32 v116, s45, v116
    v_mul_f32 v117, s45, v117
    v_mul_f32 v118, s45, v118
    v_mul_f32 v119, s45, v119
    v_mul_f32 v120, s45, v120
    v_mul_f32 v121, s45, v121
    v_mul_f32 v122, s45, v122
    v_mul_f32 v123, s45, v123
    v_mul_f32 v124, s45, v124
    v_mul_f32 v125, s45, v125
    v_mul_f32 v126, s45, v126
    v_mul_f32 v127, s45, v127
k1_qkv_kernel_nosc:
    v_cvt_pk_bf16_f32 v24, v64, v68
    v_cvt_pk_bf16_f32 v25, v72, v76
    buffer_store_dwordx2 v[24:25], v20, s[20:23], s43 offen offset:0
    v_cvt_pk_bf16_f32 v26, v65, v69
    v_cvt_pk_bf16_f32 v27, v73, v77
    buffer_store_dwordx2 v[26:27], v21, s[20:23], s43 offen offset:0
    v_cvt_pk_bf16_f32 v28, v66, v70
    v_cvt_pk_bf16_f32 v29, v74, v78
    buffer_store_dwordx2 v[28:29], v22, s[20:23], s43 offen offset:0
    v_cvt_pk_bf16_f32 v30, v67, v71
    v_cvt_pk_bf16_f32 v31, v75, v79
    buffer_store_dwordx2 v[30:31], v23, s[20:23], s43 offen offset:0
    v_cvt_pk_bf16_f32 v32, v80, v84
    v_cvt_pk_bf16_f32 v33, v88, v92
    buffer_store_dwordx2 v[32:33], v20, s[20:23], s43 offen offset:256
    v_cvt_pk_bf16_f32 v34, v81, v85
    v_cvt_pk_bf16_f32 v35, v89, v93
    buffer_store_dwordx2 v[34:35], v21, s[20:23], s43 offen offset:256
    v_cvt_pk_bf16_f32 v36, v82, v86
    v_cvt_pk_bf16_f32 v37, v90, v94
    buffer_store_dwordx2 v[36:37], v22, s[20:23], s43 offen offset:256
    v_cvt_pk_bf16_f32 v38, v83, v87
    v_cvt_pk_bf16_f32 v39, v91, v95
    buffer_store_dwordx2 v[38:39], v23, s[20:23], s43 offen offset:256
    v_cvt_pk_bf16_f32 v24, v96, v100
    v_cvt_pk_bf16_f32 v25, v104, v108
    buffer_store_dwordx2 v[24:25], v20, s[20:23], s43 offen offset:2048
    v_cvt_pk_bf16_f32 v26, v97, v101
    v_cvt_pk_bf16_f32 v27, v105, v109
    buffer_store_dwordx2 v[26:27], v21, s[20:23], s43 offen offset:2048
    v_cvt_pk_bf16_f32 v28, v98, v102
    v_cvt_pk_bf16_f32 v29, v106, v110
    buffer_store_dwordx2 v[28:29], v22, s[20:23], s43 offen offset:2048
    v_cvt_pk_bf16_f32 v30, v99, v103
    v_cvt_pk_bf16_f32 v31, v107, v111
    buffer_store_dwordx2 v[30:31], v23, s[20:23], s43 offen offset:2048
    v_cvt_pk_bf16_f32 v32, v112, v116
    v_cvt_pk_bf16_f32 v33, v120, v124
    buffer_store_dwordx2 v[32:33], v20, s[20:23], s43 offen offset:2304
    v_cvt_pk_bf16_f32 v34, v113, v117
    v_cvt_pk_bf16_f32 v35, v121, v125
    buffer_store_dwordx2 v[34:35], v21, s[20:23], s43 offen offset:2304
    v_cvt_pk_bf16_f32 v36, v114, v118
    v_cvt_pk_bf16_f32 v37, v122, v126
    buffer_store_dwordx2 v[36:37], v22, s[20:23], s43 offen offset:2304
    v_cvt_pk_bf16_f32 v38, v115, v119
    v_cvt_pk_bf16_f32 v39, v123, v127
    buffer_store_dwordx2 v[38:39], v23, s[20:23], s43 offen offset:2304
    s_endpgm
k1_qkv_kernel_v:
    ds_read_b128 v[128:131], v39 offset:0
    ds_read_b128 v[132:135], v39 offset:14336
    ds_read_b128 v[136:139], v39 offset:28672
    ds_read_b128 v[140:143], v39 offset:43008
    v_accvgpr_read_b32 v160, a0
    v_accvgpr_read_b32 v161, a1
    v_accvgpr_read_b32 v162, a2
    v_accvgpr_read_b32 v163, a3
    v_accvgpr_read_b32 v164, a4
    v_accvgpr_read_b32 v165, a5
    v_accvgpr_read_b32 v166, a6
    v_accvgpr_read_b32 v167, a7
    v_accvgpr_read_b32 v168, a8
    v_accvgpr_read_b32 v169, a9
    v_accvgpr_read_b32 v170, a10
    v_accvgpr_read_b32 v171, a11
    v_accvgpr_read_b32 v172, a12
    v_accvgpr_read_b32 v173, a13
    v_accvgpr_read_b32 v174, a14
    v_accvgpr_read_b32 v175, a15
    v_perm_b32 v224, v162, v160, s28
    v_perm_b32 v225, v166, v164, s28
    v_perm_b32 v226, v170, v168, s28
    v_perm_b32 v227, v174, v172, s28
    v_perm_b32 v228, v162, v160, s29
    v_perm_b32 v229, v166, v164, s29
    v_perm_b32 v230, v170, v168, s29
    v_perm_b32 v231, v174, v172, s29
    v_perm_b32 v232, v163, v161, s28
    v_perm_b32 v233, v167, v165, s28
    v_perm_b32 v234, v171, v169, s28
    v_perm_b32 v235, v175, v173, s28
    v_perm_b32 v236, v163, v161, s29
    v_perm_b32 v237, v167, v165, s29
    v_perm_b32 v238, v171, v169, s29
    v_perm_b32 v239, v175, v173, s29
    s_waitcnt lgkmcnt(0)
    ds_read_b128 v[144:147], v39 offset:1024
    ds_read_b128 v[148:151], v39 offset:15360
    ds_read_b128 v[152:155], v39 offset:29696
    ds_read_b128 v[156:159], v39 offset:44032
    v_mfma_f32_16x16x32_bf16 v[64:67], v[128:131], v[224:227], v[64:67]
    v_accvgpr_read_b32 v160, a16
    v_accvgpr_read_b32 v161, a17
    v_mfma_f32_16x16x32_bf16 v[68:71], v[128:131], v[228:231], v[68:71]
    v_accvgpr_read_b32 v162, a18
    v_accvgpr_read_b32 v163, a19
    v_mfma_f32_16x16x32_bf16 v[72:75], v[128:131], v[232:235], v[72:75]
    v_accvgpr_read_b32 v164, a20
    v_accvgpr_read_b32 v165, a21
    v_mfma_f32_16x16x32_bf16 v[76:79], v[128:131], v[236:239], v[76:79]
    v_accvgpr_read_b32 v166, a22
    v_accvgpr_read_b32 v167, a23
    v_mfma_f32_16x16x32_bf16 v[80:83], v[132:135], v[224:227], v[80:83]
    v_accvgpr_read_b32 v168, a24
    v_accvgpr_read_b32 v169, a25
    v_mfma_f32_16x16x32_bf16 v[84:87], v[132:135], v[228:231], v[84:87]
    v_accvgpr_read_b32 v170, a26
    v_accvgpr_read_b32 v171, a27
    v_mfma_f32_16x16x32_bf16 v[88:91], v[132:135], v[232:235], v[88:91]
    v_accvgpr_read_b32 v172, a28
    v_accvgpr_read_b32 v173, a29
    v_mfma_f32_16x16x32_bf16 v[92:95], v[132:135], v[236:239], v[92:95]
    v_accvgpr_read_b32 v174, a30
    v_accvgpr_read_b32 v175, a31
    v_mfma_f32_16x16x32_bf16 v[96:99], v[136:139], v[224:227], v[96:99]
    v_perm_b32 v240, v162, v160, s28
    v_perm_b32 v241, v166, v164, s28
    v_mfma_f32_16x16x32_bf16 v[100:103], v[136:139], v[228:231], v[100:103]
    v_perm_b32 v242, v170, v168, s28
    v_perm_b32 v243, v174, v172, s28
    v_mfma_f32_16x16x32_bf16 v[104:107], v[136:139], v[232:235], v[104:107]
    v_perm_b32 v244, v162, v160, s29
    v_perm_b32 v245, v166, v164, s29
    v_mfma_f32_16x16x32_bf16 v[108:111], v[136:139], v[236:239], v[108:111]
    v_perm_b32 v246, v170, v168, s29
    v_perm_b32 v247, v174, v172, s29
    v_mfma_f32_16x16x32_bf16 v[112:115], v[140:143], v[224:227], v[112:115]
    v_perm_b32 v248, v163, v161, s28
    v_perm_b32 v249, v167, v165, s28
    v_mfma_f32_16x16x32_bf16 v[116:119], v[140:143], v[228:231], v[116:119]
    v_perm_b32 v250, v171, v169, s28
    v_perm_b32 v251, v175, v173, s28
    v_mfma_f32_16x16x32_bf16 v[120:123], v[140:143], v[232:235], v[120:123]
    v_perm_b32 v252, v163, v161, s29
    v_perm_b32 v253, v167, v165, s29
    v_mfma_f32_16x16x32_bf16 v[124:127], v[140:143], v[236:239], v[124:127]
    v_perm_b32 v254, v171, v169, s29
    v_perm_b32 v255, v175, v173, s29
    s_waitcnt vmcnt(48)
    s_mov_b32 s30, 774144
    buffer_load_dwordx2 a[144:145], v8, s[16:19], s30 offen
    buffer_load_dwordx2 a[146:147], v9, s[16:19], s30 offen
    buffer_load_dwordx2 a[148:149], v10, s[16:19], s30 offen
    buffer_load_dwordx2 a[150:151], v11, s[16:19], s30 offen
    buffer_load_dwordx2 a[152:153], v12, s[16:19], s30 offen
    buffer_load_dwordx2 a[154:155], v13, s[16:19], s30 offen
    buffer_load_dwordx2 a[156:157], v14, s[16:19], s30 offen
    buffer_load_dwordx2 a[158:159], v15, s[16:19], s30 offen
    s_waitcnt lgkmcnt(0)
    ds_read_b128 v[128:131], v39 offset:2048
    ds_read_b128 v[132:135], v39 offset:16384
    ds_read_b128 v[136:139], v39 offset:30720
    ds_read_b128 v[140:143], v39 offset:45056
    v_mfma_f32_16x16x32_bf16 v[64:67], v[144:147], v[240:243], v[64:67]
    v_accvgpr_read_b32 v160, a32
    v_accvgpr_read_b32 v161, a33
    v_mfma_f32_16x16x32_bf16 v[68:71], v[144:147], v[244:247], v[68:71]
    v_accvgpr_read_b32 v162, a34
    v_accvgpr_read_b32 v163, a35
    v_mfma_f32_16x16x32_bf16 v[72:75], v[144:147], v[248:251], v[72:75]
    v_accvgpr_read_b32 v164, a36
    v_accvgpr_read_b32 v165, a37
    v_mfma_f32_16x16x32_bf16 v[76:79], v[144:147], v[252:255], v[76:79]
    v_accvgpr_read_b32 v166, a38
    v_accvgpr_read_b32 v167, a39
    v_mfma_f32_16x16x32_bf16 v[80:83], v[148:151], v[240:243], v[80:83]
    v_accvgpr_read_b32 v168, a40
    v_accvgpr_read_b32 v169, a41
    v_mfma_f32_16x16x32_bf16 v[84:87], v[148:151], v[244:247], v[84:87]
    v_accvgpr_read_b32 v170, a42
    v_accvgpr_read_b32 v171, a43
    v_mfma_f32_16x16x32_bf16 v[88:91], v[148:151], v[248:251], v[88:91]
    v_accvgpr_read_b32 v172, a44
    v_accvgpr_read_b32 v173, a45
    v_mfma_f32_16x16x32_bf16 v[92:95], v[148:151], v[252:255], v[92:95]
    v_accvgpr_read_b32 v174, a46
    v_accvgpr_read_b32 v175, a47
    v_mfma_f32_16x16x32_bf16 v[96:99], v[152:155], v[240:243], v[96:99]
    v_perm_b32 v224, v162, v160, s28
    v_perm_b32 v225, v166, v164, s28
    v_mfma_f32_16x16x32_bf16 v[100:103], v[152:155], v[244:247], v[100:103]
    v_perm_b32 v226, v170, v168, s28
    v_perm_b32 v227, v174, v172, s28
    v_mfma_f32_16x16x32_bf16 v[104:107], v[152:155], v[248:251], v[104:107]
    v_perm_b32 v228, v162, v160, s29
    v_perm_b32 v229, v166, v164, s29
    v_mfma_f32_16x16x32_bf16 v[108:111], v[152:155], v[252:255], v[108:111]
    v_perm_b32 v230, v170, v168, s29
    v_perm_b32 v231, v174, v172, s29
    v_mfma_f32_16x16x32_bf16 v[112:115], v[156:159], v[240:243], v[112:115]
    v_perm_b32 v232, v163, v161, s28
    v_perm_b32 v233, v167, v165, s28
    v_mfma_f32_16x16x32_bf16 v[116:119], v[156:159], v[244:247], v[116:119]
    v_perm_b32 v234, v171, v169, s28
    v_perm_b32 v235, v175, v173, s28
    v_mfma_f32_16x16x32_bf16 v[120:123], v[156:159], v[248:251], v[120:123]
    v_perm_b32 v236, v163, v161, s29
    v_perm_b32 v237, v167, v165, s29
    v_mfma_f32_16x16x32_bf16 v[124:127], v[156:159], v[252:255], v[124:127]
    v_perm_b32 v238, v171, v169, s29
    v_perm_b32 v239, v175, v173, s29
    s_waitcnt vmcnt(48)
    s_mov_b32 s30, 860160
    buffer_load_dwordx2 a[160:161], v8, s[16:19], s30 offen
    buffer_load_dwordx2 a[162:163], v9, s[16:19], s30 offen
    buffer_load_dwordx2 a[164:165], v10, s[16:19], s30 offen
    buffer_load_dwordx2 a[166:167], v11, s[16:19], s30 offen
    buffer_load_dwordx2 a[168:169], v12, s[16:19], s30 offen
    buffer_load_dwordx2 a[170:171], v13, s[16:19], s30 offen
    buffer_load_dwordx2 a[172:173], v14, s[16:19], s30 offen
    buffer_load_dwordx2 a[174:175], v15, s[16:19], s30 offen
    s_waitcnt lgkmcnt(0)
    ds_read_b128 v[144:147], v39 offset:3072
    ds_read_b128 v[148:151], v39 offset:17408
    ds_read_b128 v[152:155], v39 offset:31744
    ds_read_b128 v[156:159], v39 offset:46080
    v_mfma_f32_16x16x32_bf16 v[64:67], v[128:131], v[224:227], v[64:67]
    v_accvgpr_read_b32 v160, a48
    v_accvgpr_read_b32 v161, a49
    v_mfma_f32_16x16x32_bf16 v[68:71], v[128:131], v[228:231], v[68:71]
    v_accvgpr_read_b32 v162, a50
    v_accvgpr_read_b32 v163, a51
    v_mfma_f32_16x16x32_bf16 v[72:75], v[128:131], v[232:235], v[72:75]
    v_accvgpr_read_b32 v164, a52
    v_accvgpr_read_b32 v165, a53
    v_mfma_f32_16x16x32_bf16 v[76:79], v[128:131], v[236:239], v[76:79]
    v_accvgpr_read_b32 v166, a54
    v_accvgpr_read_b32 v167, a55
    v_mfma_f32_16x16x32_bf16 v[80:83], v[132:135], v[224:227], v[80:83]
    v_accvgpr_read_b32 v168, a56
    v_accvgpr_read_b32 v169, a57
    v_mfma_f32_16x16x32_bf16 v[84:87], v[132:135], v[228:231], v[84:87]
    v_accvgpr_read_b32 v170, a58
    v_accvgpr_read_b32 v171, a59
    v_mfma_f32_16x16x32_bf16 v[88:91], v[132:135], v[232:235], v[88:91]
    v_accvgpr_read_b32 v172, a60
    v_accvgpr_read_b32 v173, a61
    v_mfma_f32_16x16x32_bf16 v[92:95], v[132:135], v[236:239], v[92:95]
    v_accvgpr_read_b32 v174, a62
    v_accvgpr_read_b32 v175, a63
    v_mfma_f32_16x16x32_bf16 v[96:99], v[136:139], v[224:227], v[96:99]
    v_perm_b32 v240, v162, v160, s28
    v_perm_b32 v241, v166, v164, s28
    v_mfma_f32_16x16x32_bf16 v[100:103], v[136:139], v[228:231], v[100:103]
    v_perm_b32 v242, v170, v168, s28
    v_perm_b32 v243, v174, v172, s28
    v_mfma_f32_16x16x32_bf16 v[104:107], v[136:139], v[232:235], v[104:107]
    v_perm_b32 v244, v162, v160, s29
    v_perm_b32 v245, v166, v164, s29
    v_mfma_f32_16x16x32_bf16 v[108:111], v[136:139], v[236:239], v[108:111]
    v_perm_b32 v246, v170, v168, s29
    v_perm_b32 v247, v174, v172, s29
    v_mfma_f32_16x16x32_bf16 v[112:115], v[140:143], v[224:227], v[112:115]
    v_perm_b32 v248, v163, v161, s28
    v_perm_b32 v249, v167, v165, s28
    v_mfma_f32_16x16x32_bf16 v[116:119], v[140:143], v[228:231], v[116:119]
    v_perm_b32 v250, v171, v169, s28
    v_perm_b32 v251, v175, v173, s28
    v_mfma_f32_16x16x32_bf16 v[120:123], v[140:143], v[232:235], v[120:123]
    v_perm_b32 v252, v163, v161, s29
    v_perm_b32 v253, v167, v165, s29
    v_mfma_f32_16x16x32_bf16 v[124:127], v[140:143], v[236:239], v[124:127]
    v_perm_b32 v254, v171, v169, s29
    v_perm_b32 v255, v175, v173, s29
    s_waitcnt vmcnt(48)
    s_mov_b32 s30, 946176
    buffer_load_dwordx2 a[176:177], v8, s[16:19], s30 offen
    buffer_load_dwordx2 a[178:179], v9, s[16:19], s30 offen
    buffer_load_dwordx2 a[180:181], v10, s[16:19], s30 offen
    buffer_load_dwordx2 a[182:183], v11, s[16:19], s30 offen
    buffer_load_dwordx2 a[184:185], v12, s[16:19], s30 offen
    buffer_load_dwordx2 a[186:187], v13, s[16:19], s30 offen
    buffer_load_dwordx2 a[188:189], v14, s[16:19], s30 offen
    buffer_load_dwordx2 a[190:191], v15, s[16:19], s30 offen
    s_waitcnt lgkmcnt(0)
    ds_read_b128 v[128:131], v39 offset:4096
    ds_read_b128 v[132:135], v39 offset:18432
    ds_read_b128 v[136:139], v39 offset:32768
    ds_read_b128 v[140:143], v39 offset:47104
    v_mfma_f32_16x16x32_bf16 v[64:67], v[144:147], v[240:243], v[64:67]
    v_accvgpr_read_b32 v160, a64
    v_accvgpr_read_b32 v161, a65
    v_mfma_f32_16x16x32_bf16 v[68:71], v[144:147], v[244:247], v[68:71]
    v_accvgpr_read_b32 v162, a66
    v_accvgpr_read_b32 v163, a67
    v_mfma_f32_16x16x32_bf16 v[72:75], v[144:147], v[248:251], v[72:75]
    v_accvgpr_read_b32 v164, a68
    v_accvgpr_read_b32 v165, a69
    v_mfma_f32_16x16x32_bf16 v[76:79], v[144:147], v[252:255], v[76:79]
    v_accvgpr_read_b32 v166, a70
    v_accvgpr_read_b32 v167, a71
    v_mfma_f32_16x16x32_bf16 v[80:83], v[148:151], v[240:243], v[80:83]
    v_accvgpr_read_b32 v168, a72
    v_accvgpr_read_b32 v169, a73
    v_mfma_f32_16x16x32_bf16 v[84:87], v[148:151], v[244:247], v[84:87]
    v_accvgpr_read_b32 v170, a74
    v_accvgpr_read_b32 v171, a75
    v_mfma_f32_16x16x32_bf16 v[88:91], v[148:151], v[248:251], v[88:91]
    v_accvgpr_read_b32 v172, a76
    v_accvgpr_read_b32 v173, a77
    v_mfma_f32_16x16x32_bf16 v[92:95], v[148:151], v[252:255], v[92:95]
    v_accvgpr_read_b32 v174, a78
    v_accvgpr_read_b32 v175, a79
    v_mfma_f32_16x16x32_bf16 v[96:99], v[152:155], v[240:243], v[96:99]
    v_perm_b32 v224, v162, v160, s28
    v_perm_b32 v225, v166, v164, s28
    v_mfma_f32_16x16x32_bf16 v[100:103], v[152:155], v[244:247], v[100:103]
    v_perm_b32 v226, v170, v168, s28
    v_perm_b32 v227, v174, v172, s28
    v_mfma_f32_16x16x32_bf16 v[104:107], v[152:155], v[248:251], v[104:107]
    v_perm_b32 v228, v162, v160, s29
    v_perm_b32 v229, v166, v164, s29
    v_mfma_f32_16x16x32_bf16 v[108:111], v[152:155], v[252:255], v[108:111]
    v_perm_b32 v230, v170, v168, s29
    v_perm_b32 v231, v174, v172, s29
    v_mfma_f32_16x16x32_bf16 v[112:115], v[156:159], v[240:243], v[112:115]
    v_perm_b32 v232, v163, v161, s28
    v_perm_b32 v233, v167, v165, s28
    v_mfma_f32_16x16x32_bf16 v[116:119], v[156:159], v[244:247], v[116:119]
    v_perm_b32 v234, v171, v169, s28
    v_perm_b32 v235, v175, v173, s28
    v_mfma_f32_16x16x32_bf16 v[120:123], v[156:159], v[248:251], v[120:123]
    v_perm_b32 v236, v163, v161, s29
    v_perm_b32 v237, v167, v165, s29
    v_mfma_f32_16x16x32_bf16 v[124:127], v[156:159], v[252:255], v[124:127]
    v_perm_b32 v238, v171, v169, s29
    v_perm_b32 v239, v175, v173, s29
    s_waitcnt vmcnt(48)
    s_mov_b32 s30, 1032192
    buffer_load_dwordx2 a[192:193], v8, s[16:19], s30 offen
    buffer_load_dwordx2 a[194:195], v9, s[16:19], s30 offen
    buffer_load_dwordx2 a[196:197], v10, s[16:19], s30 offen
    buffer_load_dwordx2 a[198:199], v11, s[16:19], s30 offen
    buffer_load_dwordx2 a[200:201], v12, s[16:19], s30 offen
    buffer_load_dwordx2 a[202:203], v13, s[16:19], s30 offen
    buffer_load_dwordx2 a[204:205], v14, s[16:19], s30 offen
    buffer_load_dwordx2 a[206:207], v15, s[16:19], s30 offen
    s_waitcnt lgkmcnt(0)
    ds_read_b128 v[144:147], v39 offset:5120
    ds_read_b128 v[148:151], v39 offset:19456
    ds_read_b128 v[152:155], v39 offset:33792
    ds_read_b128 v[156:159], v39 offset:48128
    v_mfma_f32_16x16x32_bf16 v[64:67], v[128:131], v[224:227], v[64:67]
    v_accvgpr_read_b32 v160, a80
    v_accvgpr_read_b32 v161, a81
    v_mfma_f32_16x16x32_bf16 v[68:71], v[128:131], v[228:231], v[68:71]
    v_accvgpr_read_b32 v162, a82
    v_accvgpr_read_b32 v163, a83
    v_mfma_f32_16x16x32_bf16 v[72:75], v[128:131], v[232:235], v[72:75]
    v_accvgpr_read_b32 v164, a84
    v_accvgpr_read_b32 v165, a85
    v_mfma_f32_16x16x32_bf16 v[76:79], v[128:131], v[236:239], v[76:79]
    v_accvgpr_read_b32 v166, a86
    v_accvgpr_read_b32 v167, a87
    v_mfma_f32_16x16x32_bf16 v[80:83], v[132:135], v[224:227], v[80:83]
    v_accvgpr_read_b32 v168, a88
    v_accvgpr_read_b32 v169, a89
    v_mfma_f32_16x16x32_bf16 v[84:87], v[132:135], v[228:231], v[84:87]
    v_accvgpr_read_b32 v170, a90
    v_accvgpr_read_b32 v171, a91
    v_mfma_f32_16x16x32_bf16 v[88:91], v[132:135], v[232:235], v[88:91]
    v_accvgpr_read_b32 v172, a92
    v_accvgpr_read_b32 v173, a93
    v_mfma_f32_16x16x32_bf16 v[92:95], v[132:135], v[236:239], v[92:95]
    v_accvgpr_read_b32 v174, a94
    v_accvgpr_read_b32 v175, a95
    v_mfma_f32_16x16x32_bf16 v[96:99], v[136:139], v[224:227], v[96:99]
    v_perm_b32 v240, v162, v160, s28
    v_perm_b32 v241, v166, v164, s28
    v_mfma_f32_16x16x32_bf16 v[100:103], v[136:139], v[228:231], v[100:103]
    v_perm_b32 v242, v170, v168, s28
    v_perm_b32 v243, v174, v172, s28
    v_mfma_f32_16x16x32_bf16 v[104:107], v[136:139], v[232:235], v[104:107]
    v_perm_b32 v244, v162, v160, s29
    v_perm_b32 v245, v166, v164, s29
    v_mfma_f32_16x16x32_bf16 v[108:111], v[136:139], v[236:239], v[108:111]
    v_perm_b32 v246, v170, v168, s29
    v_perm_b32 v247, v174, v172, s29
    v_mfma_f32_16x16x32_bf16 v[112:115], v[140:143], v[224:227], v[112:115]
    v_perm_b32 v248, v163, v161, s28
    v_perm_b32 v249, v167, v165, s28
    v_mfma_f32_16x16x32_bf16 v[116:119], v[140:143], v[228:231], v[116:119]
    v_perm_b32 v250, v171, v169, s28
    v_perm_b32 v251, v175, v173, s28
    v_mfma_f32_16x16x32_bf16 v[120:123], v[140:143], v[232:235], v[120:123]
    v_perm_b32 v252, v163, v161, s29
    v_perm_b32 v253, v167, v165, s29
    v_mfma_f32_16x16x32_bf16 v[124:127], v[140:143], v[236:239], v[124:127]
    v_perm_b32 v254, v171, v169, s29
    v_perm_b32 v255, v175, v173, s29
    s_waitcnt vmcnt(48)
    s_mov_b32 s30, 1118208
    buffer_load_dwordx2 a[208:209], v8, s[16:19], s30 offen
    buffer_load_dwordx2 a[210:211], v9, s[16:19], s30 offen
    buffer_load_dwordx2 a[212:213], v10, s[16:19], s30 offen
    buffer_load_dwordx2 a[214:215], v11, s[16:19], s30 offen
    buffer_load_dwordx2 a[216:217], v12, s[16:19], s30 offen
    buffer_load_dwordx2 a[218:219], v13, s[16:19], s30 offen
    buffer_load_dwordx2 a[220:221], v14, s[16:19], s30 offen
    buffer_load_dwordx2 a[222:223], v15, s[16:19], s30 offen
    s_waitcnt lgkmcnt(0)
    ds_read_b128 v[128:131], v39 offset:6144
    ds_read_b128 v[132:135], v39 offset:20480
    ds_read_b128 v[136:139], v39 offset:34816
    ds_read_b128 v[140:143], v39 offset:49152
    v_mfma_f32_16x16x32_bf16 v[64:67], v[144:147], v[240:243], v[64:67]
    v_accvgpr_read_b32 v160, a96
    v_accvgpr_read_b32 v161, a97
    v_mfma_f32_16x16x32_bf16 v[68:71], v[144:147], v[244:247], v[68:71]
    v_accvgpr_read_b32 v162, a98
    v_accvgpr_read_b32 v163, a99
    v_mfma_f32_16x16x32_bf16 v[72:75], v[144:147], v[248:251], v[72:75]
    v_accvgpr_read_b32 v164, a100
    v_accvgpr_read_b32 v165, a101
    v_mfma_f32_16x16x32_bf16 v[76:79], v[144:147], v[252:255], v[76:79]
    v_accvgpr_read_b32 v166, a102
    v_accvgpr_read_b32 v167, a103
    v_mfma_f32_16x16x32_bf16 v[80:83], v[148:151], v[240:243], v[80:83]
    v_accvgpr_read_b32 v168, a104
    v_accvgpr_read_b32 v169, a105
    v_mfma_f32_16x16x32_bf16 v[84:87], v[148:151], v[244:247], v[84:87]
    v_accvgpr_read_b32 v170, a106
    v_accvgpr_read_b32 v171, a107
    v_mfma_f32_16x16x32_bf16 v[88:91], v[148:151], v[248:251], v[88:91]
    v_accvgpr_read_b32 v172, a108
    v_accvgpr_read_b32 v173, a109
    v_mfma_f32_16x16x32_bf16 v[92:95], v[148:151], v[252:255], v[92:95]
    v_accvgpr_read_b32 v174, a110
    v_accvgpr_read_b32 v175, a111
    v_mfma_f32_16x16x32_bf16 v[96:99], v[152:155], v[240:243], v[96:99]
    v_perm_b32 v224, v162, v160, s28
    v_perm_b32 v225, v166, v164, s28
    v_mfma_f32_16x16x32_bf16 v[100:103], v[152:155], v[244:247], v[100:103]
    v_perm_b32 v226, v170, v168, s28
    v_perm_b32 v227, v174, v172, s28
    v_mfma_f32_16x16x32_bf16 v[104:107], v[152:155], v[248:251], v[104:107]
    v_perm_b32 v228, v162, v160, s29
    v_perm_b32 v229, v166, v164, s29
    v_mfma_f32_16x16x32_bf16 v[108:111], v[152:155], v[252:255], v[108:111]
    v_perm_b32 v230, v170, v168, s29
    v_perm_b32 v231, v174, v172, s29
    v_mfma_f32_16x16x32_bf16 v[112:115], v[156:159], v[240:243], v[112:115]
    v_perm_b32 v232, v163, v161, s28
    v_perm_b32 v233, v167, v165, s28
    v_mfma_f32_16x16x32_bf16 v[116:119], v[156:159], v[244:247], v[116:119]
    v_perm_b32 v234, v171, v169, s28
    v_perm_b32 v235, v175, v173, s28
    v_mfma_f32_16x16x32_bf16 v[120:123], v[156:159], v[248:251], v[120:123]
    v_perm_b32 v236, v163, v161, s29
    v_perm_b32 v237, v167, v165, s29
    v_mfma_f32_16x16x32_bf16 v[124:127], v[156:159], v[252:255], v[124:127]
    v_perm_b32 v238, v171, v169, s29
    v_perm_b32 v239, v175, v173, s29
    s_waitcnt vmcnt(48)
    s_waitcnt lgkmcnt(0)
    ds_read_b128 v[144:147], v39 offset:7168
    ds_read_b128 v[148:151], v39 offset:21504
    ds_read_b128 v[152:155], v39 offset:35840
    ds_read_b128 v[156:159], v39 offset:50176
    v_mfma_f32_16x16x32_bf16 v[64:67], v[128:131], v[224:227], v[64:67]
    v_accvgpr_read_b32 v160, a112
    v_accvgpr_read_b32 v161, a113
    v_mfma_f32_16x16x32_bf16 v[68:71], v[128:131], v[228:231], v[68:71]
    v_accvgpr_read_b32 v162, a114
    v_accvgpr_read_b32 v163, a115
    v_mfma_f32_16x16x32_bf16 v[72:75], v[128:131], v[232:235], v[72:75]
    v_accvgpr_read_b32 v164, a116
    v_accvgpr_read_b32 v165, a117
    v_mfma_f32_16x16x32_bf16 v[76:79], v[128:131], v[236:239], v[76:79]
    v_accvgpr_read_b32 v166, a118
    v_accvgpr_read_b32 v167, a119
    v_mfma_f32_16x16x32_bf16 v[80:83], v[132:135], v[224:227], v[80:83]
    v_accvgpr_read_b32 v168, a120
    v_accvgpr_read_b32 v169, a121
    v_mfma_f32_16x16x32_bf16 v[84:87], v[132:135], v[228:231], v[84:87]
    v_accvgpr_read_b32 v170, a122
    v_accvgpr_read_b32 v171, a123
    v_mfma_f32_16x16x32_bf16 v[88:91], v[132:135], v[232:235], v[88:91]
    v_accvgpr_read_b32 v172, a124
    v_accvgpr_read_b32 v173, a125
    v_mfma_f32_16x16x32_bf16 v[92:95], v[132:135], v[236:239], v[92:95]
    v_accvgpr_read_b32 v174, a126
    v_accvgpr_read_b32 v175, a127
    v_mfma_f32_16x16x32_bf16 v[96:99], v[136:139], v[224:227], v[96:99]
    v_perm_b32 v240, v162, v160, s28
    v_perm_b32 v241, v166, v164, s28
    v_mfma_f32_16x16x32_bf16 v[100:103], v[136:139], v[228:231], v[100:103]
    v_perm_b32 v242, v170, v168, s28
    v_perm_b32 v243, v174, v172, s28
    v_mfma_f32_16x16x32_bf16 v[104:107], v[136:139], v[232:235], v[104:107]
    v_perm_b32 v244, v162, v160, s29
    v_perm_b32 v245, v166, v164, s29
    v_mfma_f32_16x16x32_bf16 v[108:111], v[136:139], v[236:239], v[108:111]
    v_perm_b32 v246, v170, v168, s29
    v_perm_b32 v247, v174, v172, s29
    v_mfma_f32_16x16x32_bf16 v[112:115], v[140:143], v[224:227], v[112:115]
    v_perm_b32 v248, v163, v161, s28
    v_perm_b32 v249, v167, v165, s28
    v_mfma_f32_16x16x32_bf16 v[116:119], v[140:143], v[228:231], v[116:119]
    v_perm_b32 v250, v171, v169, s28
    v_perm_b32 v251, v175, v173, s28
    v_mfma_f32_16x16x32_bf16 v[120:123], v[140:143], v[232:235], v[120:123]
    v_perm_b32 v252, v163, v161, s29
    v_perm_b32 v253, v167, v165, s29
    v_mfma_f32_16x16x32_bf16 v[124:127], v[140:143], v[236:239], v[124:127]
    v_perm_b32 v254, v171, v169, s29
    v_perm_b32 v255, v175, v173, s29
    s_waitcnt vmcnt(40)
    s_waitcnt lgkmcnt(0)
    ds_read_b128 v[128:131], v39 offset:8192
    ds_read_b128 v[132:135], v39 offset:22528
    ds_read_b128 v[136:139], v39 offset:36864
    ds_read_b128 v[140:143], v39 offset:51200
    v_mfma_f32_16x16x32_bf16 v[64:67], v[144:147], v[240:243], v[64:67]
    v_accvgpr_read_b32 v160, a128
    v_accvgpr_read_b32 v161, a129
    v_mfma_f32_16x16x32_bf16 v[68:71], v[144:147], v[244:247], v[68:71]
    v_accvgpr_read_b32 v162, a130
    v_accvgpr_read_b32 v163, a131
    v_mfma_f32_16x16x32_bf16 v[72:75], v[144:147], v[248:251], v[72:75]
    v_accvgpr_read_b32 v164, a132
    v_accvgpr_read_b32 v165, a133
    v_mfma_f32_16x16x32_bf16 v[76:79], v[144:147], v[252:255], v[76:79]
    v_accvgpr_read_b32 v166, a134
    v_accvgpr_read_b32 v167, a135
    v_mfma_f32_16x16x32_bf16 v[80:83], v[148:151], v[240:243], v[80:83]
    v_accvgpr_read_b32 v168, a136
    v_accvgpr_read_b32 v169, a137
    v_mfma_f32_16x16x32_bf16 v[84:87], v[148:151], v[244:247], v[84:87]
    v_accvgpr_read_b32 v170, a138
    v_accvgpr_read_b32 v171, a139
    v_mfma_f32_16x16x32_bf16 v[88:91], v[148:151], v[248:251], v[88:91]
    v_accvgpr_read_b32 v172, a140
    v_accvgpr_read_b32 v173, a141
    v_mfma_f32_16x16x32_bf16 v[92:95], v[148:151], v[252:255], v[92:95]
    v_accvgpr_read_b32 v174, a142
    v_accvgpr_read_b32 v175, a143
    v_mfma_f32_16x16x32_bf16 v[96:99], v[152:155], v[240:243], v[96:99]
    v_perm_b32 v224, v162, v160, s28
    v_perm_b32 v225, v166, v164, s28
    v_mfma_f32_16x16x32_bf16 v[100:103], v[152:155], v[244:247], v[100:103]
    v_perm_b32 v226, v170, v168, s28
    v_perm_b32 v227, v174, v172, s28
    v_mfma_f32_16x16x32_bf16 v[104:107], v[152:155], v[248:251], v[104:107]
    v_perm_b32 v228, v162, v160, s29
    v_perm_b32 v229, v166, v164, s29
    v_mfma_f32_16x16x32_bf16 v[108:111], v[152:155], v[252:255], v[108:111]
    v_perm_b32 v230, v170, v168, s29
    v_perm_b32 v231, v174, v172, s29
    v_mfma_f32_16x16x32_bf16 v[112:115], v[156:159], v[240:243], v[112:115]
    v_perm_b32 v232, v163, v161, s28
    v_perm_b32 v233, v167, v165, s28
    v_mfma_f32_16x16x32_bf16 v[116:119], v[156:159], v[244:247], v[116:119]
    v_perm_b32 v234, v171, v169, s28
    v_perm_b32 v235, v175, v173, s28
    v_mfma_f32_16x16x32_bf16 v[120:123], v[156:159], v[248:251], v[120:123]
    v_perm_b32 v236, v163, v161, s29
    v_perm_b32 v237, v167, v165, s29
    v_mfma_f32_16x16x32_bf16 v[124:127], v[156:159], v[252:255], v[124:127]
    v_perm_b32 v238, v171, v169, s29
    v_perm_b32 v239, v175, v173, s29
    s_waitcnt vmcnt(32)
    s_waitcnt lgkmcnt(0)
    ds_read_b128 v[144:147], v39 offset:9216
    ds_read_b128 v[148:151], v39 offset:23552
    ds_read_b128 v[152:155], v39 offset:37888
    ds_read_b128 v[156:159], v39 offset:52224
    v_mfma_f32_16x16x32_bf16 v[64:67], v[128:131], v[224:227], v[64:67]
    v_accvgpr_read_b32 v160, a144
    v_accvgpr_read_b32 v161, a145
    v_mfma_f32_16x16x32_bf16 v[68:71], v[128:131], v[228:231], v[68:71]
    v_accvgpr_read_b32 v162, a146
    v_accvgpr_read_b32 v163, a147
    v_mfma_f32_16x16x32_bf16 v[72:75], v[128:131], v[232:235], v[72:75]
    v_accvgpr_read_b32 v164, a148
    v_accvgpr_read_b32 v165, a149
    v_mfma_f32_16x16x32_bf16 v[76:79], v[128:131], v[236:239], v[76:79]
    v_accvgpr_read_b32 v166, a150
    v_accvgpr_read_b32 v167, a151
    v_mfma_f32_16x16x32_bf16 v[80:83], v[132:135], v[224:227], v[80:83]
    v_accvgpr_read_b32 v168, a152
    v_accvgpr_read_b32 v169, a153
    v_mfma_f32_16x16x32_bf16 v[84:87], v[132:135], v[228:231], v[84:87]
    v_accvgpr_read_b32 v170, a154
    v_accvgpr_read_b32 v171, a155
    v_mfma_f32_16x16x32_bf16 v[88:91], v[132:135], v[232:235], v[88:91]
    v_accvgpr_read_b32 v172, a156
    v_accvgpr_read_b32 v173, a157
    v_mfma_f32_16x16x32_bf16 v[92:95], v[132:135], v[236:239], v[92:95]
    v_accvgpr_read_b32 v174, a158
    v_accvgpr_read_b32 v175, a159
    v_mfma_f32_16x16x32_bf16 v[96:99], v[136:139], v[224:227], v[96:99]
    v_perm_b32 v240, v162, v160, s28
    v_perm_b32 v241, v166, v164, s28
    v_mfma_f32_16x16x32_bf16 v[100:103], v[136:139], v[228:231], v[100:103]
    v_perm_b32 v242, v170, v168, s28
    v_perm_b32 v243, v174, v172, s28
    v_mfma_f32_16x16x32_bf16 v[104:107], v[136:139], v[232:235], v[104:107]
    v_perm_b32 v244, v162, v160, s29
    v_perm_b32 v245, v166, v164, s29
    v_mfma_f32_16x16x32_bf16 v[108:111], v[136:139], v[236:239], v[108:111]
    v_perm_b32 v246, v170, v168, s29
    v_perm_b32 v247, v174, v172, s29
    v_mfma_f32_16x16x32_bf16 v[112:115], v[140:143], v[224:227], v[112:115]
    v_perm_b32 v248, v163, v161, s28
    v_perm_b32 v249, v167, v165, s28
    v_mfma_f32_16x16x32_bf16 v[116:119], v[140:143], v[228:231], v[116:119]
    v_perm_b32 v250, v171, v169, s28
    v_perm_b32 v251, v175, v173, s28
    v_mfma_f32_16x16x32_bf16 v[120:123], v[140:143], v[232:235], v[120:123]
    v_perm_b32 v252, v163, v161, s29
    v_perm_b32 v253, v167, v165, s29
    v_mfma_f32_16x16x32_bf16 v[124:127], v[140:143], v[236:239], v[124:127]
    v_perm_b32 v254, v171, v169, s29
    v_perm_b32 v255, v175, v173, s29
    s_waitcnt vmcnt(24)
    s_waitcnt lgkmcnt(0)
    ds_read_b128 v[128:131], v39 offset:10240
    ds_read_b128 v[132:135], v39 offset:24576
    ds_read_b128 v[136:139], v39 offset:38912
    ds_read_b128 v[140:143], v39 offset:53248
    v_mfma_f32_16x16x32_bf16 v[64:67], v[144:147], v[240:243], v[64:67]
    v_accvgpr_read_b32 v160, a160
    v_accvgpr_read_b32 v161, a161
    v_mfma_f32_16x16x32_bf16 v[68:71], v[144:147], v[244:247], v[68:71]
    v_accvgpr_read_b32 v162, a162
    v_accvgpr_read_b32 v163, a163
    v_mfma_f32_16x16x32_bf16 v[72:75], v[144:147], v[248:251], v[72:75]
    v_accvgpr_read_b32 v164, a164
    v_accvgpr_read_b32 v165, a165
    v_mfma_f32_16x16x32_bf16 v[76:79], v[144:147], v[252:255], v[76:79]
    v_accvgpr_read_b32 v166, a166
    v_accvgpr_read_b32 v167, a167
    v_mfma_f32_16x16x32_bf16 v[80:83], v[148:151], v[240:243], v[80:83]
    v_accvgpr_read_b32 v168, a168
    v_accvgpr_read_b32 v169, a169
    v_mfma_f32_16x16x32_bf16 v[84:87], v[148:151], v[244:247], v[84:87]
    v_accvgpr_read_b32 v170, a170
    v_accvgpr_read_b32 v171, a171
    v_mfma_f32_16x16x32_bf16 v[88:91], v[148:151], v[248:251], v[88:91]
    v_accvgpr_read_b32 v172, a172
    v_accvgpr_read_b32 v173, a173
    v_mfma_f32_16x16x32_bf16 v[92:95], v[148:151], v[252:255], v[92:95]
    v_accvgpr_read_b32 v174, a174
    v_accvgpr_read_b32 v175, a175
    v_mfma_f32_16x16x32_bf16 v[96:99], v[152:155], v[240:243], v[96:99]
    v_perm_b32 v224, v162, v160, s28
    v_perm_b32 v225, v166, v164, s28
    v_mfma_f32_16x16x32_bf16 v[100:103], v[152:155], v[244:247], v[100:103]
    v_perm_b32 v226, v170, v168, s28
    v_perm_b32 v227, v174, v172, s28
    v_mfma_f32_16x16x32_bf16 v[104:107], v[152:155], v[248:251], v[104:107]
    v_perm_b32 v228, v162, v160, s29
    v_perm_b32 v229, v166, v164, s29
    v_mfma_f32_16x16x32_bf16 v[108:111], v[152:155], v[252:255], v[108:111]
    v_perm_b32 v230, v170, v168, s29
    v_perm_b32 v231, v174, v172, s29
    v_mfma_f32_16x16x32_bf16 v[112:115], v[156:159], v[240:243], v[112:115]
    v_perm_b32 v232, v163, v161, s28
    v_perm_b32 v233, v167, v165, s28
    v_mfma_f32_16x16x32_bf16 v[116:119], v[156:159], v[244:247], v[116:119]
    v_perm_b32 v234, v171, v169, s28
    v_perm_b32 v235, v175, v173, s28
    v_mfma_f32_16x16x32_bf16 v[120:123], v[156:159], v[248:251], v[120:123]
    v_perm_b32 v236, v163, v161, s29
    v_perm_b32 v237, v167, v165, s29
    v_mfma_f32_16x16x32_bf16 v[124:127], v[156:159], v[252:255], v[124:127]
    v_perm_b32 v238, v171, v169, s29
    v_perm_b32 v239, v175, v173, s29
    s_waitcnt vmcnt(16)
    s_waitcnt lgkmcnt(0)
    ds_read_b128 v[144:147], v39 offset:11264
    ds_read_b128 v[148:151], v39 offset:25600
    ds_read_b128 v[152:155], v39 offset:39936
    ds_read_b128 v[156:159], v39 offset:54272
    v_mfma_f32_16x16x32_bf16 v[64:67], v[128:131], v[224:227], v[64:67]
    v_accvgpr_read_b32 v160, a176
    v_accvgpr_read_b32 v161, a177
    v_mfma_f32_16x16x32_bf16 v[68:71], v[128:131], v[228:231], v[68:71]
    v_accvgpr_read_b32 v162, a178
    v_accvgpr_read_b32 v163, a179
    v_mfma_f32_16x16x32_bf16 v[72:75], v[128:131], v[232:235], v[72:75]
    v_accvgpr_read_b32 v164, a180
    v_accvgpr_read_b32 v165, a181
    v_mfma_f32_16x16x32_bf16 v[76:79], v[128:131], v[236:239], v[76:79]
    v_accvgpr_read_b32 v166, a182
    v_accvgpr_read_b32 v167, a183
    v_mfma_f32_16x16x32_bf16 v[80:83], v[132:135], v[224:227], v[80:83]
    v_accvgpr_read_b32 v168, a184
    v_accvgpr_read_b32 v169, a185
    v_mfma_f32_16x16x32_bf16 v[84:87], v[132:135], v[228:231], v[84:87]
    v_accvgpr_read_b32 v170, a186
    v_accvgpr_read_b32 v171, a187
    v_mfma_f32_16x16x32_bf16 v[88:91], v[132:135], v[232:235], v[88:91]
    v_accvgpr_read_b32 v172, a188
    v_accvgpr_read_b32 v173, a189
    v_mfma_f32_16x16x32_bf16 v[92:95], v[132:135], v[236:239], v[92:95]
    v_accvgpr_read_b32 v174, a190
    v_accvgpr_read_b32 v175, a191
    v_mfma_f32_16x16x32_bf16 v[96:99], v[136:139], v[224:227], v[96:99]
    v_perm_b32 v240, v162, v160, s28
    v_perm_b32 v241, v166, v164, s28
    v_mfma_f32_16x16x32_bf16 v[100:103], v[136:139], v[228:231], v[100:103]
    v_perm_b32 v242, v170, v168, s28
    v_perm_b32 v243, v174, v172, s28
    v_mfma_f32_16x16x32_bf16 v[104:107], v[136:139], v[232:235], v[104:107]
    v_perm_b32 v244, v162, v160, s29
    v_perm_b32 v245, v166, v164, s29
    v_mfma_f32_16x16x32_bf16 v[108:111], v[136:139], v[236:239], v[108:111]
    v_perm_b32 v246, v170, v168, s29
    v_perm_b32 v247, v174, v172, s29
    v_mfma_f32_16x16x32_bf16 v[112:115], v[140:143], v[224:227], v[112:115]
    v_perm_b32 v248, v163, v161, s28
    v_perm_b32 v249, v167, v165, s28
    v_mfma_f32_16x16x32_bf16 v[116:119], v[140:143], v[228:231], v[116:119]
    v_perm_b32 v250, v171, v169, s28
    v_perm_b32 v251, v175, v173, s28
    v_mfma_f32_16x16x32_bf16 v[120:123], v[140:143], v[232:235], v[120:123]
    v_perm_b32 v252, v163, v161, s29
    v_perm_b32 v253, v167, v165, s29
    v_mfma_f32_16x16x32_bf16 v[124:127], v[140:143], v[236:239], v[124:127]
    v_perm_b32 v254, v171, v169, s29
    v_perm_b32 v255, v175, v173, s29
    s_waitcnt vmcnt(8)
    s_waitcnt lgkmcnt(0)
    ds_read_b128 v[128:131], v39 offset:12288
    ds_read_b128 v[132:135], v39 offset:26624
    ds_read_b128 v[136:139], v39 offset:40960
    ds_read_b128 v[140:143], v39 offset:55296
    v_mfma_f32_16x16x32_bf16 v[64:67], v[144:147], v[240:243], v[64:67]
    v_accvgpr_read_b32 v160, a192
    v_accvgpr_read_b32 v161, a193
    v_mfma_f32_16x16x32_bf16 v[68:71], v[144:147], v[244:247], v[68:71]
    v_accvgpr_read_b32 v162, a194
    v_accvgpr_read_b32 v163, a195
    v_mfma_f32_16x16x32_bf16 v[72:75], v[144:147], v[248:251], v[72:75]
    v_accvgpr_read_b32 v164, a196
    v_accvgpr_read_b32 v165, a197
    v_mfma_f32_16x16x32_bf16 v[76:79], v[144:147], v[252:255], v[76:79]
    v_accvgpr_read_b32 v166, a198
    v_accvgpr_read_b32 v167, a199
    v_mfma_f32_16x16x32_bf16 v[80:83], v[148:151], v[240:243], v[80:83]
    v_accvgpr_read_b32 v168, a200
    v_accvgpr_read_b32 v169, a201
    v_mfma_f32_16x16x32_bf16 v[84:87], v[148:151], v[244:247], v[84:87]
    v_accvgpr_read_b32 v170, a202
    v_accvgpr_read_b32 v171, a203
    v_mfma_f32_16x16x32_bf16 v[88:91], v[148:151], v[248:251], v[88:91]
    v_accvgpr_read_b32 v172, a204
    v_accvgpr_read_b32 v173, a205
    v_mfma_f32_16x16x32_bf16 v[92:95], v[148:151], v[252:255], v[92:95]
    v_accvgpr_read_b32 v174, a206
    v_accvgpr_read_b32 v175, a207
    v_mfma_f32_16x16x32_bf16 v[96:99], v[152:155], v[240:243], v[96:99]
    v_perm_b32 v224, v162, v160, s28
    v_perm_b32 v225, v166, v164, s28
    v_mfma_f32_16x16x32_bf16 v[100:103], v[152:155], v[244:247], v[100:103]
    v_perm_b32 v226, v170, v168, s28
    v_perm_b32 v227, v174, v172, s28
    v_mfma_f32_16x16x32_bf16 v[104:107], v[152:155], v[248:251], v[104:107]
    v_perm_b32 v228, v162, v160, s29
    v_perm_b32 v229, v166, v164, s29
    v_mfma_f32_16x16x32_bf16 v[108:111], v[152:155], v[252:255], v[108:111]
    v_perm_b32 v230, v170, v168, s29
    v_perm_b32 v231, v174, v172, s29
    v_mfma_f32_16x16x32_bf16 v[112:115], v[156:159], v[240:243], v[112:115]
    v_perm_b32 v232, v163, v161, s28
    v_perm_b32 v233, v167, v165, s28
    v_mfma_f32_16x16x32_bf16 v[116:119], v[156:159], v[244:247], v[116:119]
    v_perm_b32 v234, v171, v169, s28
    v_perm_b32 v235, v175, v173, s28
    v_mfma_f32_16x16x32_bf16 v[120:123], v[156:159], v[248:251], v[120:123]
    v_perm_b32 v236, v163, v161, s29
    v_perm_b32 v237, v167, v165, s29
    v_mfma_f32_16x16x32_bf16 v[124:127], v[156:159], v[252:255], v[124:127]
    v_perm_b32 v238, v171, v169, s29
    v_perm_b32 v239, v175, v173, s29
    s_waitcnt vmcnt(0)
    s_waitcnt lgkmcnt(0)
    ds_read_b128 v[144:147], v39 offset:13312
    ds_read_b128 v[148:151], v39 offset:27648
    ds_read_b128 v[152:155], v39 offset:41984
    ds_read_b128 v[156:159], v39 offset:56320
    v_mfma_f32_16x16x32_bf16 v[64:67], v[128:131], v[224:227], v[64:67]
    v_accvgpr_read_b32 v160, a208
    v_accvgpr_read_b32 v161, a209
    v_mfma_f32_16x16x32_bf16 v[68:71], v[128:131], v[228:231], v[68:71]
    v_accvgpr_read_b32 v162, a210
    v_accvgpr_read_b32 v163, a211
    v_mfma_f32_16x16x32_bf16 v[72:75], v[128:131], v[232:235], v[72:75]
    v_accvgpr_read_b32 v164, a212
    v_accvgpr_read_b32 v165, a213
    v_mfma_f32_16x16x32_bf16 v[76:79], v[128:131], v[236:239], v[76:79]
    v_accvgpr_read_b32 v166, a214
    v_accvgpr_read_b32 v167, a215
    v_mfma_f32_16x16x32_bf16 v[80:83], v[132:135], v[224:227], v[80:83]
    v_accvgpr_read_b32 v168, a216
    v_accvgpr_read_b32 v169, a217
    v_mfma_f32_16x16x32_bf16 v[84:87], v[132:135], v[228:231], v[84:87]
    v_accvgpr_read_b32 v170, a218
    v_accvgpr_read_b32 v171, a219
    v_mfma_f32_16x16x32_bf16 v[88:91], v[132:135], v[232:235], v[88:91]
    v_accvgpr_read_b32 v172, a220
    v_accvgpr_read_b32 v173, a221
    v_mfma_f32_16x16x32_bf16 v[92:95], v[132:135], v[236:239], v[92:95]
    v_accvgpr_read_b32 v174, a222
    v_accvgpr_read_b32 v175, a223
    v_mfma_f32_16x16x32_bf16 v[96:99], v[136:139], v[224:227], v[96:99]
    v_perm_b32 v240, v162, v160, s28
    v_perm_b32 v241, v166, v164, s28
    v_mfma_f32_16x16x32_bf16 v[100:103], v[136:139], v[228:231], v[100:103]
    v_perm_b32 v242, v170, v168, s28
    v_perm_b32 v243, v174, v172, s28
    v_mfma_f32_16x16x32_bf16 v[104:107], v[136:139], v[232:235], v[104:107]
    v_perm_b32 v244, v162, v160, s29
    v_perm_b32 v245, v166, v164, s29
    v_mfma_f32_16x16x32_bf16 v[108:111], v[136:139], v[236:239], v[108:111]
    v_perm_b32 v246, v170, v168, s29
    v_perm_b32 v247, v174, v172, s29
    v_mfma_f32_16x16x32_bf16 v[112:115], v[140:143], v[224:227], v[112:115]
    v_perm_b32 v248, v163, v161, s28
    v_perm_b32 v249, v167, v165, s28
    v_mfma_f32_16x16x32_bf16 v[116:119], v[140:143], v[228:231], v[116:119]
    v_perm_b32 v250, v171, v169, s28
    v_perm_b32 v251, v175, v173, s28
    v_mfma_f32_16x16x32_bf16 v[120:123], v[140:143], v[232:235], v[120:123]
    v_perm_b32 v252, v163, v161, s29
    v_perm_b32 v253, v167, v165, s29
    v_mfma_f32_16x16x32_bf16 v[124:127], v[140:143], v[236:239], v[124:127]
    v_perm_b32 v254, v171, v169, s29
    v_perm_b32 v255, v175, v173, s29
    s_waitcnt lgkmcnt(0)
    v_mfma_f32_16x16x32_bf16 v[64:67], v[144:147], v[240:243], v[64:67]
    v_mfma_f32_16x16x32_bf16 v[68:71], v[144:147], v[244:247], v[68:71]
    v_mfma_f32_16x16x32_bf16 v[72:75], v[144:147], v[248:251], v[72:75]
    v_mfma_f32_16x16x32_bf16 v[76:79], v[144:147], v[252:255], v[76:79]
    v_mfma_f32_16x16x32_bf16 v[80:83], v[148:151], v[240:243], v[80:83]
    v_mfma_f32_16x16x32_bf16 v[84:87], v[148:151], v[244:247], v[84:87]
    v_mfma_f32_16x16x32_bf16 v[88:91], v[148:151], v[248:251], v[88:91]
    v_mfma_f32_16x16x32_bf16 v[92:95], v[148:151], v[252:255], v[92:95]
    v_mfma_f32_16x16x32_bf16 v[96:99], v[152:155], v[240:243], v[96:99]
    v_mfma_f32_16x16x32_bf16 v[100:103], v[152:155], v[244:247], v[100:103]
    v_mfma_f32_16x16x32_bf16 v[104:107], v[152:155], v[248:251], v[104:107]
    v_mfma_f32_16x16x32_bf16 v[108:111], v[152:155], v[252:255], v[108:111]
    v_mfma_f32_16x16x32_bf16 v[112:115], v[156:159], v[240:243], v[112:115]
    v_mfma_f32_16x16x32_bf16 v[116:119], v[156:159], v[244:247], v[116:119]
    v_mfma_f32_16x16x32_bf16 v[120:123], v[156:159], v[248:251], v[120:123]
    v_mfma_f32_16x16x32_bf16 v[124:127], v[156:159], v[252:255], v[124:127]
    s_nop 7
    s_sub_u32 s42, s34, 14
    s_lshl_b32 s42, s42, 4
    s_lshl_b32 s43, s31, 12
    s_add_u32 s43, s43, 0x400000
    v_add_u32 v17, s42, v2
    v_mul_u32_u24 v18, 147, v17
    v_lshrrev_b32 v18, 10, v18
    v_mul_u32_u24 v19, 7, v18
    v_sub_u32 v19, v17, v19
    v_lshlrev_b32 v20, 17, v18
    v_lshl_add_u32 v20, v19, 6, v20
    v_and_b32 v17, 1, v3
    v_lshl_add_u32 v20, v17, 9, v20
    v_lshrrev_b32 v17, 1, v3
    v_lshl_add_u32 v20, v17, 3, v20
    v_cvt_pk_bf16_f32 v24, v64, v65
    v_cvt_pk_bf16_f32 v25, v66, v67
    buffer_store_dwordx2 v[24:25], v20, s[20:23], s43 offen offset:0
    v_cvt_pk_bf16_f32 v26, v68, v69
    v_cvt_pk_bf16_f32 v27, v70, v71
    buffer_store_dwordx2 v[26:27], v20, s[20:23], s43 offen offset:16
    v_cvt_pk_bf16_f32 v28, v72, v73
    v_cvt_pk_bf16_f32 v29, v74, v75
    buffer_store_dwordx2 v[28:29], v20, s[20:23], s43 offen offset:32
    v_cvt_pk_bf16_f32 v30, v76, v77
    v_cvt_pk_bf16_f32 v31, v78, v79
    buffer_store_dwordx2 v[30:31], v20, s[20:23], s43 offen offset:48
    v_cvt_pk_bf16_f32 v32, v80, v81
    v_cvt_pk_bf16_f32 v33, v82, v83
    buffer_store_dwordx2 v[32:33], v20, s[20:23], s43 offen offset:1024
    v_cvt_pk_bf16_f32 v34, v84, v85
    v_cvt_pk_bf16_f32 v35, v86, v87
    buffer_store_dwordx2 v[34:35], v20, s[20:23], s43 offen offset:1040
    v_cvt_pk_bf16_f32 v36, v88, v89
    v_cvt_pk_bf16_f32 v37, v90, v91
    buffer_store_dwordx2 v[36:37], v20, s[20:23], s43 offen offset:1056
    v_cvt_pk_bf16_f32 v38, v92, v93
    v_cvt_pk_bf16_f32 v39, v94, v95
    buffer_store_dwordx2 v[38:39], v20, s[20:23], s43 offen offset:1072
    v_cvt_pk_bf16_f32 v24, v96, v97
    v_cvt_pk_bf16_f32 v25, v98, v99
    buffer_store_dwordx2 v[24:25], v20, s[20:23], s43 offen offset:2048
    v_cvt_pk_bf16_f32 v26, v100, v101
    v_cvt_pk_bf16_f32 v27, v102, v103
    buffer_store_dwordx2 v[26:27], v20, s[20:23], s43 offen offset:2064
    v_cvt_pk_bf16_f32 v28, v104, v105
    v_cvt_pk_bf16_f32 v29, v106, v107
    buffer_store_dwordx2 v[28:29], v20, s[20:23], s43 offen offset:2080
    v_cvt_pk_bf16_f32 v30, v108, v109
    v_cvt_pk_bf16_f32 v31, v110, v111
    buffer_store_dwordx2 v[30:31], v20, s[20:23], s43 offen offset:2096
    v_cvt_pk_bf16_f32 v32, v112, v113
    v_cvt_pk_bf16_f32 v33, v114, v115
    buffer_store_dwordx2 v[32:33], v20, s[20:23], s43 offen offset:3072
    v_cvt_pk_bf16_f32 v34, v116, v117
    v_cvt_pk_bf16_f32 v35, v118, v119
    buffer_store_dwordx2 v[34:35], v20, s[20:23], s43 offen offset:3088
    v_cvt_pk_bf16_f32 v36, v120, v121
    v_cvt_pk_bf16_f32 v37, v122, v123
    buffer_store_dwordx2 v[36:37], v20, s[20:23], s43 offen offset:3104
    v_cvt_pk_bf16_f32 v38, v124, v125
    v_cvt_pk_bf16_f32 v39, v126, v127
    buffer_store_dwordx2 v[38:39], v20, s[20:23], s43 offen offset:3120
k1_qkv_kernel_end:
    s_endpgm
k1_qkv_kernel_pf:
    s_load_dwordx2 s[4:5], s[0:1], 16
    s_load_dwordx2 s[6:7], s[0:1], 32
    s_load_dwordx2 s[10:11], s[0:1], 48
    v_lshlrev_b32 v22, 4, v0
    s_waitcnt lgkmcnt(0)
    s_mov_b32 s20, s8
    s_mov_b32 s21, s9
    s_mov_b32 s22, 0x1800000
    s_mov_b32 s23, 0x00020000
    s_cmp_lg_u32 s92, 223
    s_cbranch_scc1 k1_qkv_kernel_nz
    v_mov_b32 v24, 0
    v_mov_b32 v25, 0
    v_mov_b32 v26, 0
    v_mov_b32 v27, 0
    s_mov_b32 s45, 0x1700000
    buffer_store_dwordx4 v[24:27], v22, s[20:23], s45 offen
    s_add_u32 s45, s45, 1024
    buffer_store_dwordx4 v[24:27], v22, s[20:23], s45 offen
    s_add_u32 s45, s45, 1024
    buffer_store_dwordx4 v[24:27], v22, s[20:23], s45 offen
    s_add_u32 s45, s45, 1024
    buffer_store_dwordx4 v[24:27], v22, s[20:23], s45 offen
    s_add_u32 s45, s45, 1024
    buffer_store_dwordx4 v[24:27], v22, s[20:23], s45 offen
    s_add_u32 s45, s45, 1024
    buffer_store_dwordx4 v[24:27], v22, s[20:23], s45 offen
    s_add_u32 s45, s45, 1024
    buffer_store_dwordx4 v[24:27], v22, s[20:23], s45 offen
    s_add_u32 s45, s45, 1024
    buffer_store_dwordx4 v[24:27], v22, s[20:23], s45 offen
    s_add_u32 s45, s45, 1024
    buffer_store_dwordx4 v[24:27], v22, s[20:23], s45 offen
    s_add_u32 s45, s45, 1024
    buffer_store_dwordx4 v[24:27], v22, s[20:23], s45 offen
    s_add_u32 s45, s45, 1024
    buffer_store_dwordx4 v[24:27], v22, s[20:23], s45 offen
    s_add_u32 s45, s45, 1024
    buffer_store_dwordx4 v[24:27], v22, s[20:23], s45 offen
    s_add_u32 s45, s45, 1024
k1_qkv_kernel_nz:
    s_lshl_b32 s45, s92, 2
    s_add_u32 s45, s45, 0
    s_cmp_ge_u32 s45, 882
    s_cbranch_scc1 k1_qkv_kernel_u0_done
    s_cmp_ge_u32 s45, 784
    s_cbranch_scc1 k1_qkv_kernel_u0_wo
    s_cmp_ge_u32 s45, 392
    s_cbranch_scc1 k1_qkv_kernel_u0_w2
    s_mov_b32 s16, s6
    s_mov_b32 s17, s7
    s_mov_b32 s18, 0x188000
    s_mov_b32 s19, 0x00020000
    s_sub_u32 s46, s45, 0
    s_mul_i32 s47, s46, 4682
    s_lshr_b32 s47, s47, 16
    s_mul_i32 s48, s47, 14
    s_sub_u32 s48, s46, s48
    s_lshl_b32 s49, s46, 12
    s_add_u32 s50, s49, 0x1280000
    s_lshl_b32 s47, s47, 7
    s_lshr_b32 s49, s48, 1
    s_mul_i32 s49, s49, 229376
    s_and_b32 s48, s48, 1
    s_mul_i32 s48, s48, 28672
    s_add_u32 s49, s49, s48
    s_add_u32 s49, s49, s47
    v_mul_u32_u24 v4, 57344, v3
    v_lshl_add_u32 v4, v2, 3, v4
    buffer_load_dwordx2 v[128:129], v4, s[16:19], s49 offen
    s_add_u32 s49, s49, 3584
    buffer_load_dwordx2 v[130:131], v4, s[16:19], s49 offen
    s_add_u32 s49, s49, 3584
    buffer_load_dwordx2 v[132:133], v4, s[16:19], s49 offen
    s_add_u32 s49, s49, 3584
    buffer_load_dwordx2 v[134:135], v4, s[16:19], s49 offen
    s_add_u32 s49, s49, 3584
    buffer_load_dwordx2 v[136:137], v4, s[16:19], s49 offen
    s_add_u32 s49, s49, 3584
    buffer_load_dwordx2 v[138:139], v4, s[16:19], s49 offen
    s_add_u32 s49, s49, 3584
    buffer_load_dwordx2 v[140:141], v4, s[16:19], s49 offen
    s_add_u32 s49, s49, 3584
    buffer_load_dwordx2 v[142:143], v4, s[16:19], s49 offen
    s_branch k1_qkv_kernel_u0_done
k1_qkv_kernel_u0_w2:
    s_mov_b32 s16, s10
    s_mov_b32 s17, s11
    s_mov_b32 s18, 0x188000
    s_mov_b32 s19, 0x00020000
    s_sub_u32 s46, s45, 392
    s_mul_i32 s47, s46, 1171
    s_lshr_b32 s47, s47, 16
    s_mul_i32 s48, s47, 56
    s_sub_u32 s48, s46, s48
    s_lshl_b32 s49, s46, 12
    s_add_u32 s50, s49, 0x1500000
    s_lshl_b32 s47, s47, 7
    s_lshr_b32 s49, s48, 1
    s_mul_i32 s49, s49, 57344
    s_and_b32 s48, s48, 1
    s_mul_i32 s48, s48, 7168
    s_add_u32 s49, s49, s48
    s_add_u32 s49, s49, s47
    v_mul_u32_u24 v4, 14336, v3
    v_lshl_add_u32 v4, v2, 3, v4
    buffer_load_dwordx2 v[128:129], v4, s[16:19], s49 offen
    s_add_u32 s49, s49, 896
    buffer_load_dwordx2 v[130:131], v4, s[16:19], s49 offen
    s_add_u32 s49, s49, 896
    buffer_load_dwordx2 v[132:133], v4, s[16:19], s49 offen
    s_add_u32 s49, s49, 896
    buffer_load_dwordx2 v[134:135], v4, s[16:19], s49 offen
    s_add_u32 s49, s49, 896
    buffer_load_dwordx2 v[136:137], v4, s[16:19], s49 offen
    s_add_u32 s49, s49, 896
    buffer_load_dwordx2 v[138:139], v4, s[16:19], s49 offen
    s_add_u32 s49, s49, 896
    buffer_load_dwordx2 v[140:141], v4, s[16:19], s49 offen
    s_add_u32 s49, s49, 896
    buffer_load_dwordx2 v[142:143], v4, s[16:19], s49 offen
    s_branch k1_qkv_kernel_u0_done
k1_qkv_kernel_u0_wo:
    s_mov_b32 s16, s4
    s_mov_b32 s17, s5
    s_mov_b32 s18, 0x62000
    s_mov_b32 s19, 0x00020000
    s_sub_u32 s46, s45, 784
    s_mul_i32 s47, s46, 4682
    s_lshr_b32 s47, s47, 16
    s_mul_i32 s48, s47, 14
    s_sub_u32 s48, s46, s48
    s_lshl_b32 s49, s46, 12
    s_add_u32 s50, s49, 0x1200000
    s_lshl_b32 s47, s47, 7
    s_mul_i32 s49, s48, 28672
    s_add_u32 s49, s49, s47
    v_mul_u32_u24 v4, 7168, v3
    v_lshl_add_u32 v4, v2, 3, v4
    buffer_load_dwordx2 v[128:129], v4, s[16:19], s49 offen
    s_add_u32 s49, s49, 896
    buffer_load_dwordx2 v[130:131], v4, s[16:19], s49 offen
    s_add_u32 s49, s49, 896
    buffer_load_dwordx2 v[132:133], v4, s[16:19], s49 offen
    s_add_u32 s49, s49, 896
    buffer_load_dwordx2 v[134:135], v4, s[16:19], s49 offen
    s_add_u32 s49, s49, 896
    buffer_load_dwordx2 v[136:137], v4, s[16:19], s49 offen
    s_add_u32 s49, s49, 896
    buffer_load_dwordx2 v[138:139], v4, s[16:19], s49 offen
    s_add_u32 s49, s49, 896
    buffer_load_dwordx2 v[140:141], v4, s[16:19], s49 offen
    s_add_u32 s49, s49, 896
    buffer_load_dwordx2 v[142:143], v4, s[16:19], s49 offen
    s_branch k1_qkv_kernel_u0_done
k1_qkv_kernel_u0_done:
    s_lshl_b32 s45, s92, 2
    s_add_u32 s45, s45, 1
    s_cmp_ge_u32 s45, 882
    s_cbranch_scc1 k1_qkv_kernel_u1_done
    s_cmp_ge_u32 s45, 784
    s_cbranch_scc1 k1_qkv_kernel_u1_wo
    s_cmp_ge_u32 s45, 392
    s_cbranch_scc1 k1_qkv_kernel_u1_w2
    s_mov_b32 s16, s6
    s_mov_b32 s17, s7
    s_mov_b32 s18, 0x188000
    s_mov_b32 s19, 0x00020000
    s_sub_u32 s46, s45, 0
    s_mul_i32 s47, s46, 4682
    s_lshr_b32 s47, s47, 16
    s_mul_i32 s48, s47, 14
    s_sub_u32 s48, s46, s48
    s_lshl_b32 s49, s46, 12
    s_add_u32 s51, s49, 0x1280000
    s_lshl_b32 s47, s47, 7
    s_lshr_b32 s49, s48, 1
    s_mul_i32 s49, s49, 229376
    s_and_b32 s48, s48, 1
    s_mul_i32 s48, s48, 28672
    s_add_u32 s49, s49, s48
    s_add_u32 s49, s49, s47
    v_mul_u32_u24 v4, 57344, v3
    v_lshl_add_u32 v4, v2, 3, v4
    buffer_load_dwordx2 v[144:145], v4, s[16:19], s49 offen
    s_add_u32 s49, s49, 3584
    buffer_load_dwordx2 v[146:147], v4, s[16:19], s49 offen
    s_add_u32 s49, s49, 3584
    buffer_load_dwordx2 v[148:149], v4, s[16:19], s49 offen
    s_add_u32 s49, s49, 3584
    buffer_load_dwordx2 v[150:151], v4, s[16:19], s49 offen
    s_add_u32 s49, s49, 3584
    buffer_load_dwordx2 v[152:153], v4, s[16:19], s49 offen
    s_add_u32 s49, s49, 3584
    buffer_load_dwordx2 v[154:155], v4, s[16:19], s49 offen
    s_add_u32 s49, s49, 3584
    buffer_load_dwordx2 v[156:157], v4, s[16:19], s49 offen
    s_add_u32 s49, s49, 3584
    buffer_load_dwordx2 v[158:159], v4, s[16:19], s49 offen
    s_branch k1_qkv_kernel_u1_done
k1_qkv_kernel_u1_w2:
    s_mov_b32 s16, s10
    s_mov_b32 s17, s11
    s_mov_b32 s18, 0x188000
    s_mov_b32 s19, 0x00020000
    s_sub_u32 s46, s45, 392
    s_mul_i32 s47, s46, 1171
    s_lshr_b32 s47, s47, 16
    s_mul_i32 s48, s47, 56
    s_sub_u32 s48, s46, s48
    s_lshl_b32 s49, s46, 12
    s_add_u32 s51, s49, 0x1500000
    s_lshl_b32 s47, s47, 7
    s_lshr_b32 s49, s48, 1
    s_mul_i32 s49, s49, 57344
    s_and_b32 s48, s48, 1
    s_mul_i32 s48, s48, 7168
    s_add_u32 s49, s49, s48
    s_add_u32 s49, s49, s47
    v_mul_u32_u24 v4, 14336, v3
    v_lshl_add_u32 v4, v2, 3, v4
    buffer_load_dwordx2 v[144:145], v4, s[16:19], s49 offen
    s_add_u32 s49, s49, 896
    buffer_load_dwordx2 v[146:147], v4, s[16:19], s49 offen
    s_add_u32 s49, s49, 896
    buffer_load_dwordx2 v[148:149], v4, s[16:19], s49 offen
    s_add_u32 s49, s49, 896
    buffer_load_dwordx2 v[150:151], v4, s[16:19], s49 offen
    s_add_u32 s49, s49, 896
    buffer_load_dwordx2 v[152:153], v4, s[16:19], s49 offen
    s_add_u32 s49, s49, 896
    buffer_load_dwordx2 v[154:155], v4, s[16:19], s49 offen
    s_add_u32 s49, s49, 896
    buffer_load_dwordx2 v[156:157], v4, s[16:19], s49 offen
    s_add_u32 s49, s49, 896
    buffer_load_dwordx2 v[158:159], v4, s[16:19], s49 offen
    s_branch k1_qkv_kernel_u1_done
k1_qkv_kernel_u1_wo:
    s_mov_b32 s16, s4
    s_mov_b32 s17, s5
    s_mov_b32 s18, 0x62000
    s_mov_b32 s19, 0x00020000
    s_sub_u32 s46, s45, 784
    s_mul_i32 s47, s46, 4682
    s_lshr_b32 s47, s47, 16
    s_mul_i32 s48, s47, 14
    s_sub_u32 s48, s46, s48
    s_lshl_b32 s49, s46, 12
    s_add_u32 s51, s49, 0x1200000
    s_lshl_b32 s47, s47, 7
    s_mul_i32 s49, s48, 28672
    s_add_u32 s49, s49, s47
    v_mul_u32_u24 v4, 7168, v3
    v_lshl_add_u32 v4, v2, 3, v4
    buffer_load_dwordx2 v[144:145], v4, s[16:19], s49 offen
    s_add_u32 s49, s49, 896
    buffer_load_dwordx2 v[146:147], v4, s[16:19], s49 offen
    s_add_u32 s49, s49, 896
    buffer_load_dwordx2 v[148:149], v4, s[16:19], s49 offen
    s_add_u32 s49, s49, 896
    buffer_load_dwordx2 v[150:151], v4, s[16:19], s49 offen
    s_add_u32 s49, s49, 896
    buffer_load_dwordx2 v[152:153], v4, s[16:19], s49 offen
    s_add_u32 s49, s49, 896
    buffer_load_dwordx2 v[154:155], v4, s[16:19], s49 offen
    s_add_u32 s49, s49, 896
    buffer_load_dwordx2 v[156:157], v4, s[16:19], s49 offen
    s_add_u32 s49, s49, 896
    buffer_load_dwordx2 v[158:159], v4, s[16:19], s49 offen
    s_branch k1_qkv_kernel_u1_done
k1_qkv_kernel_u1_done:
    s_lshl_b32 s45, s92, 2
    s_add_u32 s45, s45, 2
    s_cmp_ge_u32 s45, 882
    s_cbranch_scc1 k1_qkv_kernel_u2_done
    s_cmp_ge_u32 s45, 784
    s_cbranch_scc1 k1_qkv_kernel_u2_wo
    s_cmp_ge_u32 s45, 392
    s_cbranch_scc1 k1_qkv_kernel_u2_w2
    s_mov_b32 s16, s6
    s_mov_b32 s17, s7
    s_mov_b32 s18, 0x188000
    s_mov_b32 s19, 0x00020000
    s_sub_u32 s46, s45, 0
    s_mul_i32 s47, s46, 4682
    s_lshr_b32 s47, s47, 16
    s_mul_i32 s48, s47, 14
    s_sub_u32 s48, s46, s48
    s_lshl_b32 s49, s46, 12
    s_add_u32 s52, s49, 0x1280000
    s_lshl_b32 s47, s47, 7
    s_lshr_b32 s49, s48, 1
    s_mul_i32 s49, s49, 229376
    s_and_b32 s48, s48, 1
    s_mul_i32 s48, s48, 28672
    s_add_u32 s49, s49, s48
    s_add_u32 s49, s49, s47
    v_mul_u32_u24 v4, 57344, v3
    v_lshl_add_u32 v4, v2, 3, v4
    buffer_load_dwordx2 v[160:161], v4, s[16:19], s49 offen
    s_add_u32 s49, s49, 3584
    buffer_load_dwordx2 v[162:163], v4, s[16:19], s49 offen
    s_add_u32 s49, s49, 3584
    buffer_load_dwordx2 v[164:165], v4, s[16:19], s49 offen
    s_add_u32 s49, s49, 3584
    buffer_load_dwordx2 v[166:167], v4, s[16:19], s49 offen
    s_add_u32 s49, s49, 3584
    buffer_load_dwordx2 v[168:169], v4, s[16:19], s49 offen
    s_add_u32 s49, s49, 3584
    buffer_load_dwordx2 v[170:171], v4, s[16:19], s49 offen
    s_add_u32 s49, s49, 3584
    buffer_load_dwordx2 v[172:173], v4, s[16:19], s49 offen
    s_add_u32 s49, s49, 3584
    buffer_load_dwordx2 v[174:175], v4, s[16:19], s49 offen
    s_branch k1_qkv_kernel_u2_done
k1_qkv_kernel_u2_w2:
    s_mov_b32 s16, s10
    s_mov_b32 s17, s11
    s_mov_b32 s18, 0x188000
    s_mov_b32 s19, 0x00020000
    s_sub_u32 s46, s45, 392
    s_mul_i32 s47, s46, 1171
    s_lshr_b32 s47, s47, 16
    s_mul_i32 s48, s47, 56
    s_sub_u32 s48, s46, s48
    s_lshl_b32 s49, s46, 12
    s_add_u32 s52, s49, 0x1500000
    s_lshl_b32 s47, s47, 7
    s_lshr_b32 s49, s48, 1
    s_mul_i32 s49, s49, 57344
    s_and_b32 s48, s48, 1
    s_mul_i32 s48, s48, 7168
    s_add_u32 s49, s49, s48
    s_add_u32 s49, s49, s47
    v_mul_u32_u24 v4, 14336, v3
    v_lshl_add_u32 v4, v2, 3, v4
    buffer_load_dwordx2 v[160:161], v4, s[16:19], s49 offen
    s_add_u32 s49, s49, 896
    buffer_load_dwordx2 v[162:163], v4, s[16:19], s49 offen
    s_add_u32 s49, s49, 896
    buffer_load_dwordx2 v[164:165], v4, s[16:19], s49 offen
    s_add_u32 s49, s49, 896
    buffer_load_dwordx2 v[166:167], v4, s[16:19], s49 offen
    s_add_u32 s49, s49, 896
    buffer_load_dwordx2 v[168:169], v4, s[16:19], s49 offen
    s_add_u32 s49, s49, 896
    buffer_load_dwordx2 v[170:171], v4, s[16:19], s49 offen
    s_add_u32 s49, s49, 896
    buffer_load_dwordx2 v[172:173], v4, s[16:19], s49 offen
    s_add_u32 s49, s49, 896
    buffer_load_dwordx2 v[174:175], v4, s[16:19], s49 offen
    s_branch k1_qkv_kernel_u2_done
k1_qkv_kernel_u2_wo:
    s_mov_b32 s16, s4
    s_mov_b32 s17, s5
    s_mov_b32 s18, 0x62000
    s_mov_b32 s19, 0x00020000
    s_sub_u32 s46, s45, 784
    s_mul_i32 s47, s46, 4682
    s_lshr_b32 s47, s47, 16
    s_mul_i32 s48, s47, 14
    s_sub_u32 s48, s46, s48
    s_lshl_b32 s49, s46, 12
    s_add_u32 s52, s49, 0x1200000
    s_lshl_b32 s47, s47, 7
    s_mul_i32 s49, s48, 28672
    s_add_u32 s49, s49, s47
    v_mul_u32_u24 v4, 7168, v3
    v_lshl_add_u32 v4, v2, 3, v4
    buffer_load_dwordx2 v[160:161], v4, s[16:19], s49 offen
    s_add_u32 s49, s49, 896
    buffer_load_dwordx2 v[162:163], v4, s[16:19], s49 offen
    s_add_u32 s49, s49, 896
    buffer_load_dwordx2 v[164:165], v4, s[16:19], s49 offen
    s_add_u32 s49, s49, 896
    buffer_load_dwordx2 v[166:167], v4, s[16:19], s49 offen
    s_add_u32 s49, s49, 896
    buffer_load_dwordx2 v[168:169], v4, s[16:19], s49 offen
    s_add_u32 s49, s49, 896
    buffer_load_dwordx2 v[170:171], v4, s[16:19], s49 offen
    s_add_u32 s49, s49, 896
    buffer_load_dwordx2 v[172:173], v4, s[16:19], s49 offen
    s_add_u32 s49, s49, 896
    buffer_load_dwordx2 v[174:175], v4, s[16:19], s49 offen
    s_branch k1_qkv_kernel_u2_done
k1_qkv_kernel_u2_done:
    s_lshl_b32 s45, s92, 2
    s_add_u32 s45, s45, 3
    s_cmp_ge_u32 s45, 882
    s_cbranch_scc1 k1_qkv_kernel_u3_done
    s_cmp_ge_u32 s45, 784
    s_cbranch_scc1 k1_qkv_kernel_u3_wo
    s_cmp_ge_u32 s45, 392
    s_cbranch_scc1 k1_qkv_kernel_u3_w2
    s_mov_b32 s16, s6
    s_mov_b32 s17, s7
    s_mov_b32 s18, 0x188000
    s_mov_b32 s19, 0x00020000
    s_sub_u32 s46, s45, 0
    s_mul_i32 s47, s46, 4682
    s_lshr_b32 s47, s47, 16
    s_mul_i32 s48, s47, 14
    s_sub_u32 s48, s46, s48
    s_lshl_b32 s49, s46, 12
    s_add_u32 s53, s49, 0x1280000
    s_lshl_b32 s47, s47, 7
    s_lshr_b32 s49, s48, 1
    s_mul_i32 s49, s49, 229376
    s_and_b32 s48, s48, 1
    s_mul_i32 s48, s48, 28672
    s_add_u32 s49, s49, s48
    s_add_u32 s49, s49, s47
    v_mul_u32_u24 v4, 57344, v3
    v_lshl_add_u32 v4, v2, 3, v4
    buffer_load_dwordx2 v[176:177], v4, s[16:19], s49 offen
    s_add_u32 s49, s49, 3584
    buffer_load_dwordx2 v[178:179], v4, s[16:19], s49 offen
    s_add_u32 s49, s49, 3584
    buffer_load_dwordx2 v[180:181], v4, s[16:19], s49 offen
    s_add_u32 s49, s49, 3584
    buffer_load_dwordx2 v[182:183], v4, s[16:19], s49 offen
    s_add_u32 s49, s49, 3584
    buffer_load_dwordx2 v[184:185], v4, s[16:19], s49 offen
    s_add_u32 s49, s49, 3584
    buffer_load_dwordx2 v[186:187], v4, s[16:19], s49 offen
    s_add_u32 s49, s49, 3584
    buffer_load_dwordx2 v[188:189], v4, s[16:19], s49 offen
    s_add_u32 s49, s49, 3584
    buffer_load_dwordx2 v[190:191], v4, s[16:19], s49 offen
    s_branch k1_qkv_kernel_u3_done
k1_qkv_kernel_u3_w2:
    s_mov_b32 s16, s10
    s_mov_b32 s17, s11
    s_mov_b32 s18, 0x188000
    s_mov_b32 s19, 0x00020000
    s_sub_u32 s46, s45, 392
    s_mul_i32 s47, s46, 1171
    s_lshr_b32 s47, s47, 16
    s_mul_i32 s48, s47, 56
    s_sub_u32 s48, s46, s48
    s_lshl_b32 s49, s46, 12
    s_add_u32 s53, s49, 0x1500000
    s_lshl_b32 s47, s47, 7
    s_lshr_b32 s49, s48, 1
    s_mul_i32 s49, s49, 57344
    s_and_b32 s48, s48, 1
    s_mul_i32 s48, s48, 7168
    s_add_u32 s49, s49, s48
    s_add_u32 s49, s49, s47
    v_mul_u32_u24 v4, 14336, v3
    v_lshl_add_u32 v4, v2, 3, v4
    buffer_load_dwordx2 v[176:177], v4, s[16:19], s49 offen
    s_add_u32 s49, s49, 896
    buffer_load_dwordx2 v[178:179], v4, s[16:19], s49 offen
    s_add_u32 s49, s49, 896
    buffer_load_dwordx2 v[180:181], v4, s[16:19], s49 offen
    s_add_u32 s49, s49, 896
    buffer_load_dwordx2 v[182:183], v4, s[16:19], s49 offen
    s_add_u32 s49, s49, 896
    buffer_load_dwordx2 v[184:185], v4, s[16:19], s49 offen
    s_add_u32 s49, s49, 896
    buffer_load_dwordx2 v[186:187], v4, s[16:19], s49 offen
    s_add_u32 s49, s49, 896
    buffer_load_dwordx2 v[188:189], v4, s[16:19], s49 offen
    s_add_u32 s49, s49, 896
    buffer_load_dwordx2 v[190:191], v4, s[16:19], s49 offen
    s_branch k1_qkv_kernel_u3_done
k1_qkv_kernel_u3_wo:
    s_mov_b32 s16, s4
    s_mov_b32 s17, s5
    s_mov_b32 s18, 0x62000
    s_mov_b32 s19, 0x00020000
    s_sub_u32 s46, s45, 784
    s_mul_i32 s47, s46, 4682
    s_lshr_b32 s47, s47, 16
    s_mul_i32 s48, s47, 14
    s_sub_u32 s48, s46, s48
    s_lshl_b32 s49, s46, 12
    s_add_u32 s53, s49, 0x1200000
    s_lshl_b32 s47, s47, 7
    s_mul_i32 s49, s48, 28672
    s_add_u32 s49, s49, s47
    v_mul_u32_u24 v4, 7168, v3
    v_lshl_add_u32 v4, v2, 3, v4
    buffer_load_dwordx2 v[176:177], v4, s[16:19], s49 offen
    s_add_u32 s49, s49, 896
    buffer_load_dwordx2 v[178:179], v4, s[16:19], s49 offen
    s_add_u32 s49, s49, 896
    buffer_load_dwordx2 v[180:181], v4, s[16:19], s49 offen
    s_add_u32 s49, s49, 896
    buffer_load_dwordx2 v[182:183], v4, s[16:19], s49 offen
    s_add_u32 s49, s49, 896
    buffer_load_dwordx2 v[184:185], v4, s[16:19], s49 offen
    s_add_u32 s49, s49, 896
    buffer_load_dwordx2 v[186:187], v4, s[16:19], s49 offen
    s_add_u32 s49, s49, 896
    buffer_load_dwordx2 v[188:189], v4, s[16:19], s49 offen
    s_add_u32 s49, s49, 896
    buffer_load_dwordx2 v[190:191], v4, s[16:19], s49 offen
    s_branch k1_qkv_kernel_u3_done
k1_qkv_kernel_u3_done:
    s_lshl_b32 s45, s92, 2
    s_add_u32 s45, s45, 0
    s_cmp_ge_u32 s45, 882
    s_cbranch_scc1 k1_qkv_kernel_pfend
    s_waitcnt vmcnt(0)
    v_perm_b32 v64, v130, v128, s28
    v_perm_b32 v65, v134, v132, s28
    v_perm_b32 v66, v138, v136, s28
    v_perm_b32 v67, v142, v140, s28
    v_perm_b32 v68, v130, v128, s29
    v_perm_b32 v69, v134, v132, s29
    v_perm_b32 v70, v138, v136, s29
    v_perm_b32 v71, v142, v140, s29
    v_perm_b32 v72, v131, v129, s28
    v_perm_b32 v73, v135, v133, s28
    v_perm_b32 v74, v139, v137, s28
    v_perm_b32 v75, v143, v141, s28
    v_perm_b32 v76, v131, v129, s29
    v_perm_b32 v77, v135, v133, s29
    v_perm_b32 v78, v139, v137, s29
    v_perm_b32 v79, v143, v141, s29
    s_nop 1
    buffer_store_dwordx4 v[64:67], v22, s[20:23], s50 offen offset:0
    buffer_store_dwordx4 v[68:71], v22, s[20:23], s50 offen offset:1024
    buffer_store_dwordx4 v[72:75], v22, s[20:23], s50 offen offset:2048
    buffer_store_dwordx4 v[76:79], v22, s[20:23], s50 offen offset:3072
    s_lshl_b32 s45, s92, 2
    s_add_u32 s45, s45, 1
    s_cmp_ge_u32 s45, 882
    s_cbranch_scc1 k1_qkv_kernel_pfend
    s_waitcnt vmcnt(4)
    v_perm_b32 v80, v146, v144, s28
    v_perm_b32 v81, v150, v148, s28
    v_perm_b32 v82, v154, v152, s28
    v_perm_b32 v83, v158, v156, s28
    v_perm_b32 v84, v146, v144, s29
    v_perm_b32 v85, v150, v148, s29
    v_perm_b32 v86, v154, v152, s29
    v_perm_b32 v87, v158, v156, s29
    v_perm_b32 v88, v147, v145, s28
    v_perm_b32 v89, v151, v149, s28
    v_perm_b32 v90, v155, v153, s28
    v_perm_b32 v91, v159, v157, s28
    v_perm_b32 v92, v147, v145, s29
    v_perm_b32 v93, v151, v149, s29
    v_perm_b32 v94, v155, v153, s29
    v_perm_b32 v95, v159, v157, s29
    s_nop 1
    buffer_store_dwordx4 v[80:83], v22, s[20:23], s51 offen offset:0
    buffer_store_dwordx4 v[84:87], v22, s[20:23], s51 offen offset:1024
    buffer_store_dwordx4 v[88:91], v22, s[20:23], s51 offen offset:2048
    buffer_store_dwordx4 v[92:95], v22, s[20:23], s51 offen offset:3072
    s_lshl_b32 s45, s92, 2
    s_add_u32 s45, s45, 2
    s_cmp_ge_u32 s45, 882
    s_cbranch_scc1 k1_qkv_kernel_pfend
    s_waitcnt vmcnt(4)
    v_perm_b32 v96, v162, v160, s28
    v_perm_b32 v97, v166, v164, s28
    v_perm_b32 v98, v170, v168, s28
    v_perm_b32 v99, v174, v172, s28
    v_perm_b32 v100, v162, v160, s29
    v_perm_b32 v101, v166, v164, s29
    v_perm_b32 v102, v170, v168, s29
    v_perm_b32 v103, v174, v172, s29
    v_perm_b32 v104, v163, v161, s28
    v_perm_b32 v105, v167, v165, s28
    v_perm_b32 v106, v171, v169, s28
    v_perm_b32 v107, v175, v173, s28
    v_perm_b32 v108, v163, v161, s29
    v_perm_b32 v109, v167, v165, s29
    v_perm_b32 v110, v171, v169, s29
    v_perm_b32 v111, v175, v173, s29
    s_nop 1
    buffer_store_dwordx4 v[96:99], v22, s[20:23], s52 offen offset:0
    buffer_store_dwordx4 v[100:103], v22, s[20:23], s52 offen offset:1024
    buffer_store_dwordx4 v[104:107], v22, s[20:23], s52 offen offset:2048
    buffer_store_dwordx4 v[108:111], v22, s[20:23], s52 offen offset:3072
    s_lshl_b32 s45, s92, 2
    s_add_u32 s45, s45, 3
    s_cmp_ge_u32 s45, 882
    s_cbranch_scc1 k1_qkv_kernel_pfend
    s_waitcnt vmcnt(4)
    v_perm_b32 v112, v178, v176, s28
    v_perm_b32 v113, v182, v180, s28
    v_perm_b32 v114, v186, v184, s28
    v_perm_b32 v115, v190, v188, s28
    v_perm_b32 v116, v178, v176, s29
    v_perm_b32 v117, v182, v180, s29
    v_perm_b32 v118, v186, v184, s29
    v_perm_b32 v119, v190, v188, s29
    v_perm_b32 v120, v179, v177, s28
    v_perm_b32 v121, v183, v181, s28
    v_perm_b32 v122, v187, v185, s28
    v_perm_b32 v123, v191, v189, s28
    v_perm_b32 v124, v179, v177, s29
    v_perm_b32 v125, v183, v181, s29
    v_perm_b32 v126, v187, v185, s29
    v_perm_b32 v127, v191, v189, s29
    s_nop 1
    buffer_store_dwordx4 v[112:115], v22, s[20:23], s53 offen offset:0
    buffer_store_dwordx4 v[116:119], v22, s[20:23], s53 offen offset:1024
    buffer_store_dwordx4 v[120:123], v22, s[20:23], s53 offen offset:2048
    buffer_store_dwordx4 v[124:127], v22, s[20:23], s53 offen offset:3072
k1_qkv_kernel_pfend:
    s_endpgm
.globl k2_attn_kernel
.p2align 8
.type k2_attn_kernel,@function
k2_attn_kernel:
    s_cmp_ge_u32 s2, 256
    s_cbranch_scc1 k2_attn_kernel_end
    s_load_dwordx2 s[8:9], s[0:1], 80
    v_lshrrev_b32 v1, 6, v0
    v_mov_b32 v15, v0
    v_and_b32 v0, 63, v0
    s_and_b32 s35, s2, 7
    s_lshr_b32 s36, s2, 3
    v_readfirstlane_b32 s33, v1
    s_lshr_b32 s37, s36, 4
    s_lshl_b32 s31, s35, 1
    s_add_u32 s31, s31, s37
    s_and_b32 s32, s36, 15
    v_lshlrev_b32 v2, 4, v0
    s_lshl_b32 s38, s31, 17
    s_lshl_b32 s39, s32, 13
    s_add_u32 s39, s39, s38
    s_mul_i32 s40, s33, 32768
    s_add_u32 s40, s40, s38
    s_mov_b32 s42, 0x0fffffff
    s_mov_b32 s43, 0x0fffffff
    v_cmp_gt_u32 vcc, 32, v0
    s_nop 1
    v_cndmask_b32 v3, 0, -1, vcc
    s_mov_b32 s47, 0
    s_getpc_b64 s[94:95]
    s_lshr_b32 s93, s2, 3
    s_lshl_b32 s93, s93, 2
    s_add_u32 s93, s93, s33
    s_lshl_b32 s93, s93, 10
    s_cmp_ge_u32 s93, 29696
    s_cbranch_scc1 k2_attn_kernel_ncp
    s_add_u32 s94, s94, s93
    s_addc_u32 s95, s95, 0
    v_lshlrev_b32 v236, 4, v0
    v_mov_b32 v237, s95
    v_add_co_u32 v236, vcc, s94, v236
    s_nop 1
    v_addc_co_u32 v237, vcc, 0, v237, vcc
    global_load_dwordx4 v[238:241], v[236:237], off
k2_attn_kernel_ncp:
    s_waitcnt lgkmcnt(0)
    s_mul_i32 s37, s36, 37
    s_lshr_b32 s37, s37, 8
    s_mul_i32 s38, s37, 7
    s_sub_u32 s56, s36, s38
    s_lshl_b32 s56, s56, 2
    s_add_u32 s56, s56, s33
    s_mul_i32 s57, s56, 57344
    s_add_u32 s64, s8, 0x1280000
    s_addc_u32 s65, s9, 0
    s_mov_b32 s66, 0x188000
    s_mov_b32 s67, 0x00020000
    s_add_u32 s68, s8, 0x1500000
    s_addc_u32 s69, s9, 0
    s_mov_b32 s70, 0x188000
    s_mov_b32 s71, 0x00020000
    s_lshl_b32 s58, s36, 2
    s_add_u32 s58, s58, s33
    s_mul_i32 s58, s58, 14336
    s_mov_b32 s12, s8
    s_mov_b32 s13, s9
    s_mov_b32 s14, 0x200000
    s_mov_b32 s15, 0x00020000
    s_add_u32 s16, s8, 0x200000
    s_addc_u32 s17, s9, 0
    s_mov_b32 s18, 0x200000
    s_mov_b32 s19, 0x00020000
    s_add_u32 s20, s8, 0x400000
    s_addc_u32 s21, s9, 0
    s_mov_b32 s22, 0x200000
    s_mov_b32 s23, 0x00020000
    s_add_u32 s24, s8, 0x600000
    s_addc_u32 s25, s9, 0
    s_mov_b32 s26, 0x1c0000
    s_mov_b32 s27, 0x00020000
    buffer_load_dwordx4 v[16:19], v2, s[12:15], s39 offen offset:0
    buffer_load_dwordx4 v[20:23], v2, s[12:15], s39 offen offset:1024
    buffer_load_dwordx4 v[24:27], v2, s[12:15], s39 offen offset:2048
    buffer_load_dwordx4 v[28:31], v2, s[12:15], s39 offen offset:3072
    s_add_u32 s39, s39, 4096
    buffer_load_dwordx4 v[32:35], v2, s[12:15], s39 offen offset:0
    buffer_load_dwordx4 v[36:39], v2, s[12:15], s39 offen offset:1024
    buffer_load_dwordx4 v[40:43], v2, s[12:15], s39 offen offset:2048
    buffer_load_dwordx4 v[44:47], v2, s[12:15], s39 offen offset:3072
    v_mov_b32 v192, 0x3f803f80
    v_mov_b32 v193, 0x3f803f80
    v_mov_b32 v194, 0x3f803f80
    v_mov_b32 v195, 0x3f803f80
    v_mov_b32 v196, 0x3f803f80
    v_mov_b32 v197, 0x3f803f80
    v_mov_b32 v198, 0x3f803f80
    v_mov_b32 v199, 0x3f803f80
    v_mov_b32 v200, 0x3f803f80
    v_mov_b32 v201, 0x3f803f80
    v_mov_b32 v202, 0x3f803f80
    v_mov_b32 v203, 0x3f803f80
    v_mov_b32 v204, 0x3f803f80
    v_mov_b32 v205, 0x3f803f80
    v_mov_b32 v206, 0x3f803f80
    v_mov_b32 v207, 0x3f803f80
    v_mov_b32 v208, 0x3f803f80
    v_mov_b32 v209, 0x3f803f80
    v_mov_b32 v210, 0x3f803f80
    v_mov_b32 v211, 0x3f803f80
    v_mov_b32 v212, 0x3f803f80
    v_mov_b32 v213, 0x3f803f80
    v_mov_b32 v214, 0x3f803f80
    v_mov_b32 v215, 0x3f803f80
    v_mov_b32 v216, 0x3f803f80
    v_mov_b32 v217, 0x3f803f80
    v_mov_b32 v218, 0x3f803f80
    v_mov_b32 v219, 0x3f803f80
    v_mov_b32 v220, 0x3f803f80
    v_mov_b32 v221, 0x3f803f80
    v_mov_b32 v222, 0x3f803f80
    v_mov_b32 v223, 0x3f803f80
    s_mov_b32 s41, s40
    buffer_load_dwordx4 v[160:163], v2, s[16:19], s41 offen
    buffer_load_dwordx4 v[164:167], v2, s[16:19], s41 offen offset:1024
    s_mov_b64 exec, s[42:43]
    buffer_load_dwordx4 v[192:195], v2, s[20:23], s41 offen
    buffer_load_dwordx4 v[196:199], v2, s[20:23], s41 offen offset:1024
    s_mov_b64 exec, -1
    s_add_u32 s41, s41, 2048
    buffer_load_dwordx4 v[168:171], v2, s[16:19], s41 offen
    buffer_load_dwordx4 v[172:175], v2, s[16:19], s41 offen offset:1024
    s_mov_b64 exec, s[42:43]
    buffer_load_dwordx4 v[200:203], v2, s[20:23], s41 offen
    buffer_load_dwordx4 v[204:207], v2, s[20:23], s41 offen offset:1024
    s_mov_b64 exec, -1
    s_add_u32 s41, s41, 2048
    buffer_load_dwordx4 v[176:179], v2, s[16:19], s41 offen
    buffer_load_dwordx4 v[180:183], v2, s[16:19], s41 offen offset:1024
    s_mov_b64 exec, s[42:43]
    buffer_load_dwordx4 v[208:211], v2, s[20:23], s41 offen
    buffer_load_dwordx4 v[212:215], v2, s[20:23], s41 offen offset:1024
    s_mov_b64 exec, -1
    s_add_u32 s41, s41, 2048
    v_mov_b32 v48, 0
    v_mov_b32 v49, 0
    v_mov_b32 v50, 0
    v_mov_b32 v51, 0
    v_mov_b32 v52, 0
    v_mov_b32 v53, 0
    v_mov_b32 v54, 0
    v_mov_b32 v55, 0
    v_mov_b32 v56, 0
    v_mov_b32 v57, 0
    v_mov_b32 v58, 0
    v_mov_b32 v59, 0
    v_mov_b32 v60, 0
    v_mov_b32 v61, 0
    v_mov_b32 v62, 0
    v_mov_b32 v63, 0
    v_mov_b32 v64, 0
    v_mov_b32 v65, 0
    v_mov_b32 v66, 0
    v_mov_b32 v67, 0
    v_mov_b32 v68, 0
    v_mov_b32 v69, 0
    v_mov_b32 v70, 0
    v_mov_b32 v71, 0
    v_mov_b32 v72, 0
    v_mov_b32 v73, 0
    v_mov_b32 v74, 0
    v_mov_b32 v75, 0
    v_mov_b32 v76, 0
    v_mov_b32 v77, 0
    v_mov_b32 v78, 0
    v_mov_b32 v79, 0
    v_mov_b32 v80, 0
    v_mov_b32 v81, 0
    v_mov_b32 v82, 0
    v_mov_b32 v83, 0
    v_mov_b32 v84, 0
    v_mov_b32 v85, 0
    v_mov_b32 v86, 0
    v_mov_b32 v87, 0
    v_mov_b32 v88, 0
    v_mov_b32 v89, 0
    v_mov_b32 v90, 0
    v_mov_b32 v91, 0
    v_mov_b32 v92, 0
    v_mov_b32 v93, 0
    v_mov_b32 v94, 0
    v_mov_b32 v95, 0
    v_mov_b32 v96, 0
    v_mov_b32 v97, 0
    v_mov_b32 v98, 0
    v_mov_b32 v99, 0
    v_mov_b32 v100, 0
    v_mov_b32 v101, 0
    v_mov_b32 v102, 0
    v_mov_b32 v103, 0
    v_mov_b32 v104, 0
    v_mov_b32 v105, 0
    v_mov_b32 v106, 0
    v_mov_b32 v107, 0
    v_mov_b32 v108, 0
    v_mov_b32 v109, 0
    v_mov_b32 v110, 0
    v_mov_b32 v111, 0
    v_mov_b32 v144, 0
    v_mov_b32 v145, 0
    v_mov_b32 v146, 0
    v_mov_b32 v147, 0
    v_mov_b32 v148, 0
    v_mov_b32 v149, 0
    v_mov_b32 v150, 0
    v_mov_b32 v151, 0
    v_mov_b32 v152, 0
    v_mov_b32 v153, 0
    v_mov_b32 v154, 0
    v_mov_b32 v155, 0
    v_mov_b32 v156, 0
    v_mov_b32 v157, 0
    v_mov_b32 v158, 0
    v_mov_b32 v159, 0
    s_waitcnt vmcnt(8)
    v_and_b32 v22, v3, v22
    v_and_b32 v23, v3, v23
    v_and_b32 v30, v3, v30
    v_and_b32 v31, v3, v31
    v_and_b32 v38, v3, v38
    v_and_b32 v39, v3, v39
    v_and_b32 v46, v3, v46
    v_and_b32 v47, v3, v47
    v_and_b32 v166, v3, v166
    v_and_b32 v167, v3, v167
    s_nop 1
    v_mfma_f32_32x32x16_bf16 v[112:127], v[160:163], v[16:19], 0
    v_mfma_f32_32x32x16_bf16 v[112:127], v[164:167], v[20:23], v[112:127]
    s_nop 7
    s_nop 3
    v_exp_f32 v112, v112
    v_exp_f32 v113, v113
    v_mfma_f32_32x32x16_bf16 v[128:143], v[160:163], v[24:27], 0
    v_exp_f32 v114, v114
    v_exp_f32 v115, v115
    v_exp_f32 v116, v116
    v_exp_f32 v117, v117
    v_exp_f32 v118, v118
    v_cvt_pk_bf16_f32 v144, v112, v113
    v_cvt_pk_bf16_f32 v145, v114, v115
    v_mfma_f32_32x32x16_bf16 v[128:143], v[164:167], v[28:31], v[128:143]
    v_exp_f32 v119, v119
    v_exp_f32 v120, v120
    v_exp_f32 v121, v121
    v_exp_f32 v122, v122
    v_cvt_pk_bf16_f32 v146, v116, v117
    v_cvt_pk_bf16_f32 v147, v118, v119
    v_cvt_pk_bf16_f32 v148, v120, v121
    v_mfma_f32_32x32x16_bf16 v[96:111], v[216:219], v[152:155], v[96:111]
    v_exp_f32 v123, v123
    v_exp_f32 v124, v124
    v_exp_f32 v125, v125
    v_exp_f32 v126, v126
    v_exp_f32 v127, v127
    v_cvt_pk_bf16_f32 v149, v122, v123
    v_cvt_pk_bf16_f32 v150, v124, v125
    v_mfma_f32_32x32x16_bf16 v[96:111], v[220:223], v[156:159], v[96:111]
    v_cvt_pk_bf16_f32 v151, v126, v127
    v_exp_f32 v128, v128
    v_exp_f32 v129, v129
    v_mfma_f32_32x32x16_bf16 v[112:127], v[160:163], v[32:35], 0
    buffer_load_dwordx4 v[184:187], v2, s[16:19], s41 offen
    buffer_load_dwordx4 v[188:191], v2, s[16:19], s41 offen offset:1024
    s_mov_b64 exec, s[42:43]
    buffer_load_dwordx4 v[216:219], v2, s[20:23], s41 offen
    buffer_load_dwordx4 v[220:223], v2, s[20:23], s41 offen offset:1024
    s_mov_b64 exec, -1
    s_add_u32 s41, s41, 2048
    v_exp_f32 v130, v130
    v_exp_f32 v131, v131
    v_exp_f32 v132, v132
    v_exp_f32 v133, v133
    v_exp_f32 v134, v134
    v_cvt_pk_bf16_f32 v152, v128, v129
    v_cvt_pk_bf16_f32 v153, v130, v131
    v_mfma_f32_32x32x16_bf16 v[112:127], v[164:167], v[36:39], v[112:127]
    v_exp_f32 v135, v135
    v_exp_f32 v136, v136
    v_exp_f32 v137, v137
    v_exp_f32 v138, v138
    v_cvt_pk_bf16_f32 v154, v132, v133
    v_cvt_pk_bf16_f32 v155, v134, v135
    v_cvt_pk_bf16_f32 v156, v136, v137
    v_mfma_f32_32x32x16_bf16 v[48:63], v[192:195], v[144:147], v[48:63]
    v_exp_f32 v139, v139
    v_exp_f32 v140, v140
    v_exp_f32 v141, v141
    v_exp_f32 v142, v142
    v_exp_f32 v143, v143
    v_cvt_pk_bf16_f32 v157, v138, v139
    v_cvt_pk_bf16_f32 v158, v140, v141
    v_mfma_f32_32x32x16_bf16 v[48:63], v[196:199], v[148:151], v[48:63]
    v_cvt_pk_bf16_f32 v159, v142, v143
    v_exp_f32 v112, v112
    v_exp_f32 v113, v113
    v_mfma_f32_32x32x16_bf16 v[128:143], v[160:163], v[40:43], 0
    s_add_u32 s30, s57, 0
    buffer_load_dwordx4 a[0:3], v2, s[64:67], s30 offen offset:0
    buffer_load_dwordx4 a[4:7], v2, s[64:67], s30 offen offset:1024
    buffer_load_dwordx4 a[8:11], v2, s[64:67], s30 offen offset:2048
    buffer_load_dwordx4 a[12:15], v2, s[64:67], s30 offen offset:3072
    v_exp_f32 v114, v114
    v_exp_f32 v115, v115
    v_exp_f32 v116, v116
    v_exp_f32 v117, v117
    v_exp_f32 v118, v118
    v_cvt_pk_bf16_f32 v144, v112, v113
    v_cvt_pk_bf16_f32 v145, v114, v115
    v_mfma_f32_32x32x16_bf16 v[128:143], v[164:167], v[44:47], v[128:143]
    v_exp_f32 v119, v119
    v_exp_f32 v120, v120
    v_exp_f32 v121, v121
    v_exp_f32 v122, v122
    v_cvt_pk_bf16_f32 v146, v116, v117
    v_cvt_pk_bf16_f32 v147, v118, v119
    v_cvt_pk_bf16_f32 v148, v120, v121
    v_mfma_f32_32x32x16_bf16 v[64:79], v[192:195], v[152:155], v[64:79]
    v_exp_f32 v123, v123
    v_exp_f32 v124, v124
    v_exp_f32 v125, v125
    v_exp_f32 v126, v126
    v_exp_f32 v127, v127
    v_cvt_pk_bf16_f32 v149, v122, v123
    v_cvt_pk_bf16_f32 v150, v124, v125
    v_mfma_f32_32x32x16_bf16 v[64:79], v[196:199], v[156:159], v[64:79]
    v_cvt_pk_bf16_f32 v151, v126, v127
    s_waitcnt vmcnt(12)
    v_and_b32 v174, v3, v174
    v_and_b32 v175, v3, v175
    v_exp_f32 v128, v128
    v_exp_f32 v129, v129
    v_mfma_f32_32x32x16_bf16 v[112:127], v[168:171], v[16:19], 0
    v_exp_f32 v130, v130
    v_exp_f32 v131, v131
    v_exp_f32 v132, v132
    v_exp_f32 v133, v133
    v_exp_f32 v134, v134
    v_cvt_pk_bf16_f32 v152, v128, v129
    v_cvt_pk_bf16_f32 v153, v130, v131
    v_mfma_f32_32x32x16_bf16 v[112:127], v[172:175], v[20:23], v[112:127]
    v_exp_f32 v135, v135
    v_exp_f32 v136, v136
    v_exp_f32 v137, v137
    v_exp_f32 v138, v138
    v_cvt_pk_bf16_f32 v154, v132, v133
    v_cvt_pk_bf16_f32 v155, v134, v135
    v_cvt_pk_bf16_f32 v156, v136, v137
    v_mfma_f32_32x32x16_bf16 v[80:95], v[192:195], v[144:147], v[80:95]
    v_exp_f32 v139, v139
    v_exp_f32 v140, v140
    v_exp_f32 v141, v141
    v_exp_f32 v142, v142
    v_exp_f32 v143, v143
    v_cvt_pk_bf16_f32 v157, v138, v139
    v_cvt_pk_bf16_f32 v158, v140, v141
    v_mfma_f32_32x32x16_bf16 v[80:95], v[196:199], v[148:151], v[80:95]
    v_cvt_pk_bf16_f32 v159, v142, v143
    v_exp_f32 v112, v112
    v_exp_f32 v113, v113
    v_mfma_f32_32x32x16_bf16 v[128:143], v[168:171], v[24:27], 0
    v_exp_f32 v114, v114
    v_exp_f32 v115, v115
    v_exp_f32 v116, v116
    v_exp_f32 v117, v117
    v_exp_f32 v118, v118
    v_cvt_pk_bf16_f32 v144, v112, v113
    v_cvt_pk_bf16_f32 v145, v114, v115
    v_mfma_f32_32x32x16_bf16 v[128:143], v[172:175], v[28:31], v[128:143]
    v_exp_f32 v119, v119
    v_exp_f32 v120, v120
    v_exp_f32 v121, v121
    v_exp_f32 v122, v122
    v_cvt_pk_bf16_f32 v146, v116, v117
    v_cvt_pk_bf16_f32 v147, v118, v119
    v_cvt_pk_bf16_f32 v148, v120, v121
    v_mfma_f32_32x32x16_bf16 v[96:111], v[192:195], v[152:155], v[96:111]
    v_exp_f32 v123, v123
    v_exp_f32 v124, v124
    v_exp_f32 v125, v125
    v_exp_f32 v126, v126
    v_exp_f32 v127, v127
    v_cvt_pk_bf16_f32 v149, v122, v123
    v_cvt_pk_bf16_f32 v150, v124, v125
    v_mfma_f32_32x32x16_bf16 v[96:111], v[196:199], v[156:159], v[96:111]
    v_cvt_pk_bf16_f32 v151, v126, v127
    v_exp_f32 v128, v128
    v_exp_f32 v129, v129
    v_mfma_f32_32x32x16_bf16 v[112:127], v[168:171], v[32:35], 0
    buffer_load_dwordx4 v[160:163], v2, s[16:19], s41 offen
    buffer_load_dwordx4 v[164:167], v2, s[16:19], s41 offen offset:1024
    s_mov_b64 exec, s[42:43]
    buffer_load_dwordx4 v[192:195], v2, s[20:23], s41 offen
    buffer_load_dwordx4 v[196:199], v2, s[20:23], s41 offen offset:1024
    s_mov_b64 exec, -1
    s_add_u32 s41, s41, 2048
    v_exp_f32 v130, v130
    v_exp_f32 v131, v131
    v_exp_f32 v132, v132
    v_exp_f32 v133, v133
    v_exp_f32 v134, v134
    v_cvt_pk_bf16_f32 v152, v128, v129
    v_cvt_pk_bf16_f32 v153, v130, v131
    v_mfma_f32_32x32x16_bf16 v[112:127], v[172:175], v[36:39], v[112:127]
    v_exp_f32 v135, v135
    v_exp_f32 v136, v136
    v_exp_f32 v137, v137
    v_exp_f32 v138, v138
    v_cvt_pk_bf16_f32 v154, v132, v133
    v_cvt_pk_bf16_f32 v155, v134, v135
    v_cvt_pk_bf16_f32 v156, v136, v137
    v_mfma_f32_32x32x16_bf16 v[48:63], v[200:203], v[144:147], v[48:63]
    v_exp_f32 v139, v139
    v_exp_f32 v140, v140
    v_exp_f32 v141, v141
    v_exp_f32 v142, v142
    v_exp_f32 v143, v143
    v_cvt_pk_bf16_f32 v157, v138, v139
    v_cvt_pk_bf16_f32 v158, v140, v141
    v_mfma_f32_32x32x16_bf16 v[48:63], v[204:207], v[148:151], v[48:63]
    v_cvt_pk_bf16_f32 v159, v142, v143
    v_exp_f32 v112, v112
    v_exp_f32 v113, v113
    v_mfma_f32_32x32x16_bf16 v[128:143], v[168:171], v[40:43], 0
    s_add_u32 s30, s57, 4096
    buffer_load_dwordx4 a[16:19], v2, s[64:67], s30 offen offset:0
    buffer_load_dwordx4 a[20:23], v2, s[64:67], s30 offen offset:1024
    buffer_load_dwordx4 a[24:27], v2, s[64:67], s30 offen offset:2048
    buffer_load_dwordx4 a[28:31], v2, s[64:67], s30 offen offset:3072
    v_exp_f32 v114, v114
    v_exp_f32 v115, v115
    v_exp_f32 v116, v116
    v_exp_f32 v117, v117
    v_exp_f32 v118, v118
    v_cvt_pk_bf16_f32 v144, v112, v113
    v_cvt_pk_bf16_f32 v145, v114, v115
    v_mfma_f32_32x32x16_bf16 v[128:143], v[172:175], v[44:47], v[128:143]
    v_exp_f32 v119, v119
    v_exp_f32 v120, v120
    v_exp_f32 v121, v121
    v_exp_f32 v122, v122
    v_cvt_pk_bf16_f32 v146, v116, v117
    v_cvt_pk_bf16_f32 v147, v118, v119
    v_cvt_pk_bf16_f32 v148, v120, v121
    v_mfma_f32_32x32x16_bf16 v[64:79], v[200:203], v[152:155], v[64:79]
    v_exp_f32 v123, v123
    v_exp_f32 v124, v124
    v_exp_f32 v125, v125
    v_exp_f32 v126, v126
    v_exp_f32 v127, v127
    v_cvt_pk_bf16_f32 v149, v122, v123
    v_cvt_pk_bf16_f32 v150, v124, v125
    v_mfma_f32_32x32x16_bf16 v[64:79], v[204:207], v[156:159], v[64:79]
    v_cvt_pk_bf16_f32 v151, v126, v127
    s_waitcnt vmcnt(16)
    v_and_b32 v182, v3, v182
    v_and_b32 v183, v3, v183
    v_exp_f32 v128, v128
    v_exp_f32 v129, v129
    v_mfma_f32_32x32x16_bf16 v[112:127], v[176:179], v[16:19], 0
    v_exp_f32 v130, v130
    v_exp_f32 v131, v131
    v_exp_f32 v132, v132
    v_exp_f32 v133, v133
    v_exp_f32 v134, v134
    v_cvt_pk_bf16_f32 v152, v128, v129
    v_cvt_pk_bf16_f32 v153, v130, v131
    v_mfma_f32_32x32x16_bf16 v[112:127], v[180:183], v[20:23], v[112:127]
    v_exp_f32 v135, v135
    v_exp_f32 v136, v136
    v_exp_f32 v137, v137
    v_exp_f32 v138, v138
    v_cvt_pk_bf16_f32 v154, v132, v133
    v_cvt_pk_bf16_f32 v155, v134, v135
    v_cvt_pk_bf16_f32 v156, v136, v137
    v_mfma_f32_32x32x16_bf16 v[80:95], v[200:203], v[144:147], v[80:95]
    v_exp_f32 v139, v139
    v_exp_f32 v140, v140
    v_exp_f32 v141, v141
    v_exp_f32 v142, v142
    v_exp_f32 v143, v143
    v_cvt_pk_bf16_f32 v157, v138, v139
    v_cvt_pk_bf16_f32 v158, v140, v141
    v_mfma_f32_32x32x16_bf16 v[80:95], v[204:207], v[148:151], v[80:95]
    v_cvt_pk_bf16_f32 v159, v142, v143
    v_exp_f32 v112, v112
    v_exp_f32 v113, v113
    v_mfma_f32_32x32x16_bf16 v[128:143], v[176:179], v[24:27], 0
    v_exp_f32 v114, v114
    v_exp_f32 v115, v115
    v_exp_f32 v116, v116
    v_exp_f32 v117, v117
    v_exp_f32 v118, v118
    v_cvt_pk_bf16_f32 v144, v112, v113
    v_cvt_pk_bf16_f32 v145, v114, v115
    v_mfma_f32_32x32x16_bf16 v[128:143], v[180:183], v[28:31], v[128:143]
    v_exp_f32 v119, v119
    v_exp_f32 v120, v120
    v_exp_f32 v121, v121
    v_exp_f32 v122, v122
    v_cvt_pk_bf16_f32 v146, v116, v117
    v_cvt_pk_bf16_f32 v147, v118, v119
    v_cvt_pk_bf16_f32 v148, v120, v121
    v_mfma_f32_32x32x16_bf16 v[96:111], v[200:203], v[152:155], v[96:111]
    v_exp_f32 v123, v123
    v_exp_f32 v124, v124
    v_exp_f32 v125, v125
    v_exp_f32 v126, v126
    v_exp_f32 v127, v127
    v_cvt_pk_bf16_f32 v149, v122, v123
    v_cvt_pk_bf16_f32 v150, v124, v125
    v_mfma_f32_32x32x16_bf16 v[96:111], v[204:207], v[156:159], v[96:111]
    v_cvt_pk_bf16_f32 v151, v126, v127
    v_exp_f32 v128, v128
    v_exp_f32 v129, v129
    v_mfma_f32_32x32x16_bf16 v[112:127], v[176:179], v[32:35], 0
    buffer_load_dwordx4 v[168:171], v2, s[16:19], s41 offen
    buffer_load_dwordx4 v[172:175], v2, s[16:19], s41 offen offset:1024
    s_mov_b64 exec, s[42:43]
    buffer_load_dwordx4 v[200:203], v2, s[20:23], s41 offen
    buffer_load_dwordx4 v[204:207], v2, s[20:23], s41 offen offset:1024
    s_mov_b64 exec, -1
    s_add_u32 s41, s41, 2048
    v_exp_f32 v130, v130
    v_exp_f32 v131, v131
    v_exp_f32 v132, v132
    v_exp_f32 v133, v133
    v_exp_f32 v134, v134
    v_cvt_pk_bf16_f32 v152, v128, v129
    v_cvt_pk_bf16_f32 v153, v130, v131
    v_mfma_f32_32x32x16_bf16 v[112:127], v[180:183], v[36:39], v[112:127]
    v_exp_f32 v135, v135
    v_exp_f32 v136, v136
    v_exp_f32 v137, v137
    v_exp_f32 v138, v138
    v_cvt_pk_bf16_f32 v154, v132, v133
    v_cvt_pk_bf16_f32 v155, v134, v135
    v_cvt_pk_bf16_f32 v156, v136, v137
    v_mfma_f32_32x32x16_bf16 v[48:63], v[208:211], v[144:147], v[48:63]
    v_exp_f32 v139, v139
    v_exp_f32 v140, v140
    v_exp_f32 v141, v141
    v_exp_f32 v142, v142
    v_exp_f32 v143, v143
    v_cvt_pk_bf16_f32 v157, v138, v139
    v_cvt_pk_bf16_f32 v158, v140, v141
    v_mfma_f32_32x32x16_bf16 v[48:63], v[212:215], v[148:151], v[48:63]
    v_cvt_pk_bf16_f32 v159, v142, v143
    v_exp_f32 v112, v112
    v_exp_f32 v113, v113
    v_mfma_f32_32x32x16_bf16 v[128:143], v[176:179], v[40:43], 0
    s_add_u32 s30, s57, 8192
    buffer_load_dwordx4 a[32:35], v2, s[64:67], s30 offen offset:0
    buffer_load_dwordx4 a[36:39], v2, s[64:67], s30 offen offset:1024
    buffer_load_dwordx4 a[40:43], v2, s[64:67], s30 offen offset:2048
    buffer_load_dwordx4 a[44:47], v2, s[64:67], s30 offen offset:3072
    v_exp_f32 v114, v114
    v_exp_f32 v115, v115
    v_exp_f32 v116, v116
    v_exp_f32 v117, v117
    v_exp_f32 v118, v118
    v_cvt_pk_bf16_f32 v144, v112, v113
    v_cvt_pk_bf16_f32 v145, v114, v115
    v_mfma_f32_32x32x16_bf16 v[128:143], v[180:183], v[44:47], v[128:143]
    v_exp_f32 v119, v119
    v_exp_f32 v120, v120
    v_exp_f32 v121, v121
    v_exp_f32 v122, v122
    v_cvt_pk_bf16_f32 v146, v116, v117
    v_cvt_pk_bf16_f32 v147, v118, v119
    v_cvt_pk_bf16_f32 v148, v120, v121
    v_mfma_f32_32x32x16_bf16 v[64:79], v[208:211], v[152:155], v[64:79]
    v_exp_f32 v123, v123
    v_exp_f32 v124, v124
    v_exp_f32 v125, v125
    v_exp_f32 v126, v126
    v_exp_f32 v127, v127
    v_cvt_pk_bf16_f32 v149, v122, v123
    v_cvt_pk_bf16_f32 v150, v124, v125
    v_mfma_f32_32x32x16_bf16 v[64:79], v[212:215], v[156:159], v[64:79]
    v_cvt_pk_bf16_f32 v151, v126, v127
    s_waitcnt vmcnt(20)
    v_and_b32 v190, v3, v190
    v_and_b32 v191, v3, v191
    v_exp_f32 v128, v128
    v_exp_f32 v129, v129
    v_mfma_f32_32x32x16_bf16 v[112:127], v[184:187], v[16:19], 0
    v_exp_f32 v130, v130
    v_exp_f32 v131, v131
    v_exp_f32 v132, v132
    v_exp_f32 v133, v133
    v_exp_f32 v134, v134
    v_cvt_pk_bf16_f32 v152, v128, v129
    v_cvt_pk_bf16_f32 v153, v130, v131
    v_mfma_f32_32x32x16_bf16 v[112:127], v[188:191], v[20:23], v[112:127]
    v_exp_f32 v135, v135
    v_exp_f32 v136, v136
    v_exp_f32 v137, v137
    v_exp_f32 v138, v138
    v_cvt_pk_bf16_f32 v154, v132, v133
    v_cvt_pk_bf16_f32 v155, v134, v135
    v_cvt_pk_bf16_f32 v156, v136, v137
    v_mfma_f32_32x32x16_bf16 v[80:95], v[208:211], v[144:147], v[80:95]
    v_exp_f32 v139, v139
    v_exp_f32 v140, v140
    v_exp_f32 v141, v141
    v_exp_f32 v142, v142
    v_exp_f32 v143, v143
    v_cvt_pk_bf16_f32 v157, v138, v139
    v_cvt_pk_bf16_f32 v158, v140, v141
    v_mfma_f32_32x32x16_bf16 v[80:95], v[212:215], v[148:151], v[80:95]
    v_cvt_pk_bf16_f32 v159, v142, v143
    v_exp_f32 v112, v112
    v_exp_f32 v113, v113
    v_mfma_f32_32x32x16_bf16 v[128:143], v[184:187], v[24:27], 0
    v_exp_f32 v114, v114
    v_exp_f32 v115, v115
    v_exp_f32 v116, v116
    v_exp_f32 v117, v117
    v_exp_f32 v118, v118
    v_cvt_pk_bf16_f32 v144, v112, v113
    v_cvt_pk_bf16_f32 v145, v114, v115
    v_mfma_f32_32x32x16_bf16 v[128:143], v[188:191], v[28:31], v[128:143]
    v_exp_f32 v119, v119
    v_exp_f32 v120, v120
    v_exp_f32 v121, v121
    v_exp_f32 v122, v122
    v_cvt_pk_bf16_f32 v146, v116, v117
    v_cvt_pk_bf16_f32 v147, v118, v119
    v_cvt_pk_bf16_f32 v148, v120, v121
    v_mfma_f32_32x32x16_bf16 v[96:111], v[208:211], v[152:155], v[96:111]
    v_exp_f32 v123, v123
    v_exp_f32 v124, v124
    v_exp_f32 v125, v125
    v_exp_f32 v126, v126
    v_exp_f32 v127, v127
    v_cvt_pk_bf16_f32 v149, v122, v123
    v_cvt_pk_bf16_f32 v150, v124, v125
    v_mfma_f32_32x32x16_bf16 v[96:111], v[212:215], v[156:159], v[96:111]
    v_cvt_pk_bf16_f32 v151, v126, v127
    v_exp_f32 v128, v128
    v_exp_f32 v129, v129
    v_mfma_f32_32x32x16_bf16 v[112:127], v[184:187], v[32:35], 0
    buffer_load_dwordx4 v[176:179], v2, s[16:19], s41 offen
    buffer_load_dwordx4 v[180:183], v2, s[16:19], s41 offen offset:1024
    s_mov_b64 exec, s[42:43]
    buffer_load_dwordx4 v[208:211], v2, s[20:23], s41 offen
    buffer_load_dwordx4 v[212:215], v2, s[20:23], s41 offen offset:1024
    s_mov_b64 exec, -1
    s_add_u32 s41, s41, 2048
    v_exp_f32 v130, v130
    v_exp_f32 v131, v131
    v_exp_f32 v132, v132
    v_exp_f32 v133, v133
    v_exp_f32 v134, v134
    v_cvt_pk_bf16_f32 v152, v128, v129
    v_cvt_pk_bf16_f32 v153, v130, v131
    v_mfma_f32_32x32x16_bf16 v[112:127], v[188:191], v[36:39], v[112:127]
    v_exp_f32 v135, v135
    v_exp_f32 v136, v136
    v_exp_f32 v137, v137
    v_exp_f32 v138, v138
    v_cvt_pk_bf16_f32 v154, v132, v133
    v_cvt_pk_bf16_f32 v155, v134, v135
    v_cvt_pk_bf16_f32 v156, v136, v137
    v_mfma_f32_32x32x16_bf16 v[48:63], v[216:219], v[144:147], v[48:63]
    v_exp_f32 v139, v139
    v_exp_f32 v140, v140
    v_exp_f32 v141, v141
    v_exp_f32 v142, v142
    v_exp_f32 v143, v143
    v_cvt_pk_bf16_f32 v157, v138, v139
    v_cvt_pk_bf16_f32 v158, v140, v141
    v_mfma_f32_32x32x16_bf16 v[48:63], v[220:223], v[148:151], v[48:63]
    v_cvt_pk_bf16_f32 v159, v142, v143
    v_exp_f32 v112, v112
    v_exp_f32 v113, v113
    v_mfma_f32_32x32x16_bf16 v[128:143], v[184:187], v[40:43], 0
    s_add_u32 s30, s57, 12288
    buffer_load_dwordx4 a[48:51], v2, s[64:67], s30 offen offset:0
    buffer_load_dwordx4 a[52:55], v2, s[64:67], s30 offen offset:1024
    buffer_load_dwordx4 a[56:59], v2, s[64:67], s30 offen offset:2048
    buffer_load_dwordx4 a[60:63], v2, s[64:67], s30 offen offset:3072
    v_exp_f32 v114, v114
    v_exp_f32 v115, v115
    v_exp_f32 v116, v116
    v_exp_f32 v117, v117
    v_exp_f32 v118, v118
    v_cvt_pk_bf16_f32 v144, v112, v113
    v_cvt_pk_bf16_f32 v145, v114, v115
    v_mfma_f32_32x32x16_bf16 v[128:143], v[188:191], v[44:47], v[128:143]
    v_exp_f32 v119, v119
    v_exp_f32 v120, v120
    v_exp_f32 v121, v121
    v_exp_f32 v122, v122
    v_cvt_pk_bf16_f32 v146, v116, v117
    v_cvt_pk_bf16_f32 v147, v118, v119
    v_cvt_pk_bf16_f32 v148, v120, v121
    v_mfma_f32_32x32x16_bf16 v[64:79], v[216:219], v[152:155], v[64:79]
    v_exp_f32 v123, v123
    v_exp_f32 v124, v124
    v_exp_f32 v125, v125
    v_exp_f32 v126, v126
    v_exp_f32 v127, v127
    v_cvt_pk_bf16_f32 v149, v122, v123
    v_cvt_pk_bf16_f32 v150, v124, v125
    v_mfma_f32_32x32x16_bf16 v[64:79], v[220:223], v[156:159], v[64:79]
    v_cvt_pk_bf16_f32 v151, v126, v127
    s_waitcnt vmcnt(20)
    v_and_b32 v166, v3, v166
    v_and_b32 v167, v3, v167
    v_exp_f32 v128, v128
    v_exp_f32 v129, v129
    v_mfma_f32_32x32x16_bf16 v[112:127], v[160:163], v[16:19], 0
    v_exp_f32 v130, v130
    v_exp_f32 v131, v131
    v_exp_f32 v132, v132
    v_exp_f32 v133, v133
    v_exp_f32 v134, v134
    v_cvt_pk_bf16_f32 v152, v128, v129
    v_cvt_pk_bf16_f32 v153, v130, v131
    v_mfma_f32_32x32x16_bf16 v[112:127], v[164:167], v[20:23], v[112:127]
    v_exp_f32 v135, v135
    v_exp_f32 v136, v136
    v_exp_f32 v137, v137
    v_exp_f32 v138, v138
    v_cvt_pk_bf16_f32 v154, v132, v133
    v_cvt_pk_bf16_f32 v155, v134, v135
    v_cvt_pk_bf16_f32 v156, v136, v137
    v_mfma_f32_32x32x16_bf16 v[80:95], v[216:219], v[144:147], v[80:95]
    v_exp_f32 v139, v139
    v_exp_f32 v140, v140
    v_exp_f32 v141, v141
    v_exp_f32 v142, v142
    v_exp_f32 v143, v143
    v_cvt_pk_bf16_f32 v157, v138, v139
    v_cvt_pk_bf16_f32 v158, v140, v141
    v_mfma_f32_32x32x16_bf16 v[80:95], v[220:223], v[148:151], v[80:95]
    v_cvt_pk_bf16_f32 v159, v142, v143
    v_exp_f32 v112, v112
    v_exp_f32 v113, v113
    v_mfma_f32_32x32x16_bf16 v[128:143], v[160:163], v[24:27], 0
    v_exp_f32 v114, v114
    v_exp_f32 v115, v115
    v_exp_f32 v116, v116
    v_exp_f32 v117, v117
    v_exp_f32 v118, v118
    v_cvt_pk_bf16_f32 v144, v112, v113
    v_cvt_pk_bf16_f32 v145, v114, v115
    v_mfma_f32_32x32x16_bf16 v[128:143], v[164:167], v[28:31], v[128:143]
    v_exp_f32 v119, v119
    v_exp_f32 v120, v120
    v_exp_f32 v121, v121
    v_exp_f32 v122, v122
    v_cvt_pk_bf16_f32 v146, v116, v117
    v_cvt_pk_bf16_f32 v147, v118, v119
    v_cvt_pk_bf16_f32 v148, v120, v121
    v_mfma_f32_32x32x16_bf16 v[96:111], v[216:219], v[152:155], v[96:111]
    v_exp_f32 v123, v123
    v_exp_f32 v124, v124
    v_exp_f32 v125, v125
    v_exp_f32 v126, v126
    v_exp_f32 v127, v127
    v_cvt_pk_bf16_f32 v149, v122, v123
    v_cvt_pk_bf16_f32 v150, v124, v125
    v_mfma_f32_32x32x16_bf16 v[96:111], v[220:223], v[156:159], v[96:111]
    v_cvt_pk_bf16_f32 v151, v126, v127
    v_exp_f32 v128, v128
    v_exp_f32 v129, v129
    v_mfma_f32_32x32x16_bf16 v[112:127], v[160:163], v[32:35], 0
    buffer_load_dwordx4 v[184:187], v2, s[16:19], s41 offen
    buffer_load_dwordx4 v[188:191], v2, s[16:19], s41 offen offset:1024
    s_mov_b64 exec, s[42:43]
    buffer_load_dwordx4 v[216:219], v2, s[20:23], s41 offen
    buffer_load_dwordx4 v[220:223], v2, s[20:23], s41 offen offset:1024
    s_mov_b64 exec, -1
    s_add_u32 s41, s41, 2048
    v_exp_f32 v130, v130
    v_exp_f32 v131, v131
    v_exp_f32 v132, v132
    v_exp_f32 v133, v133
    v_exp_f32 v134, v134
    v_cvt_pk_bf16_f32 v152, v128, v129
    v_cvt_pk_bf16_f32 v153, v130, v131
    v_mfma_f32_32x32x16_bf16 v[112:127], v[164:167], v[36:39], v[112:127]
    v_exp_f32 v135, v135
    v_exp_f32 v136, v136
    v_exp_f32 v137, v137
    v_exp_f32 v138, v138
    v_cvt_pk_bf16_f32 v154, v132, v133
    v_cvt_pk_bf16_f32 v155, v134, v135
    v_cvt_pk_bf16_f32 v156, v136, v137
    v_mfma_f32_32x32x16_bf16 v[48:63], v[192:195], v[144:147], v[48:63]
    v_exp_f32 v139, v139
    v_exp_f32 v140, v140
    v_exp_f32 v141, v141
    v_exp_f32 v142, v142
    v_exp_f32 v143, v143
    v_cvt_pk_bf16_f32 v157, v138, v139
    v_cvt_pk_bf16_f32 v158, v140, v141
    v_mfma_f32_32x32x16_bf16 v[48:63], v[196:199], v[148:151], v[48:63]
    v_cvt_pk_bf16_f32 v159, v142, v143
    v_exp_f32 v112, v112
    v_exp_f32 v113, v113
    v_mfma_f32_32x32x16_bf16 v[128:143], v[160:163], v[40:43], 0
    s_add_u32 s30, s57, 16384
    buffer_load_dwordx4 a[64:67], v2, s[64:67], s30 offen offset:0
    buffer_load_dwordx4 a[68:71], v2, s[64:67], s30 offen offset:1024
    buffer_load_dwordx4 a[72:75], v2, s[64:67], s30 offen offset:2048
    buffer_load_dwordx4 a[76:79], v2, s[64:67], s30 offen offset:3072
    v_exp_f32 v114, v114
    v_exp_f32 v115, v115
    v_exp_f32 v116, v116
    v_exp_f32 v117, v117
    v_exp_f32 v118, v118
    v_cvt_pk_bf16_f32 v144, v112, v113
    v_cvt_pk_bf16_f32 v145, v114, v115
    v_mfma_f32_32x32x16_bf16 v[128:143], v[164:167], v[44:47], v[128:143]
    v_exp_f32 v119, v119
    v_exp_f32 v120, v120
    v_exp_f32 v121, v121
    v_exp_f32 v122, v122
    v_cvt_pk_bf16_f32 v146, v116, v117
    v_cvt_pk_bf16_f32 v147, v118, v119
    v_cvt_pk_bf16_f32 v148, v120, v121
    v_mfma_f32_32x32x16_bf16 v[64:79], v[192:195], v[152:155], v[64:79]
    v_exp_f32 v123, v123
    v_exp_f32 v124, v124
    v_exp_f32 v125, v125
    v_exp_f32 v126, v126
    v_exp_f32 v127, v127
    v_cvt_pk_bf16_f32 v149, v122, v123
    v_cvt_pk_bf16_f32 v150, v124, v125
    v_mfma_f32_32x32x16_bf16 v[64:79], v[196:199], v[156:159], v[64:79]
    v_cvt_pk_bf16_f32 v151, v126, v127
    s_waitcnt vmcnt(20)
    v_and_b32 v174, v3, v174
    v_and_b32 v175, v3, v175
    v_exp_f32 v128, v128
    v_exp_f32 v129, v129
    v_mfma_f32_32x32x16_bf16 v[112:127], v[168:171], v[16:19], 0
    v_exp_f32 v130, v130
    v_exp_f32 v131, v131
    v_exp_f32 v132, v132
    v_exp_f32 v133, v133
    v_exp_f32 v134, v134
    v_cvt_pk_bf16_f32 v152, v128, v129
    v_cvt_pk_bf16_f32 v153, v130, v131
    v_mfma_f32_32x32x16_bf16 v[112:127], v[172:175], v[20:23], v[112:127]
    v_exp_f32 v135, v135
    v_exp_f32 v136, v136
    v_exp_f32 v137, v137
    v_exp_f32 v138, v138
    v_cvt_pk_bf16_f32 v154, v132, v133
    v_cvt_pk_bf16_f32 v155, v134, v135
    v_cvt_pk_bf16_f32 v156, v136, v137
    v_mfma_f32_32x32x16_bf16 v[80:95], v[192:195], v[144:147], v[80:95]
    v_exp_f32 v139, v139
    v_exp_f32 v140, v140
    v_exp_f32 v141, v141
    v_exp_f32 v142, v142
    v_exp_f32 v143, v143
    v_cvt_pk_bf16_f32 v157, v138, v139
    v_cvt_pk_bf16_f32 v158, v140, v141
    v_mfma_f32_32x32x16_bf16 v[80:95], v[196:199], v[148:151], v[80:95]
    v_cvt_pk_bf16_f32 v159, v142, v143
    v_exp_f32 v112, v112
    v_exp_f32 v113, v113
    v_mfma_f32_32x32x16_bf16 v[128:143], v[168:171], v[24:27], 0
    v_exp_f32 v114, v114
    v_exp_f32 v115, v115
    v_exp_f32 v116, v116
    v_exp_f32 v117, v117
    v_exp_f32 v118, v118
    v_cvt_pk_bf16_f32 v144, v112, v113
    v_cvt_pk_bf16_f32 v145, v114, v115
    v_mfma_f32_32x32x16_bf16 v[128:143], v[172:175], v[28:31], v[128:143]
    v_exp_f32 v119, v119
    v_exp_f32 v120, v120
    v_exp_f32 v121, v121
    v_exp_f32 v122, v122
    v_cvt_pk_bf16_f32 v146, v116, v117
    v_cvt_pk_bf16_f32 v147, v118, v119
    v_cvt_pk_bf16_f32 v148, v120, v121
    v_mfma_f32_32x32x16_bf16 v[96:111], v[192:195], v[152:155], v[96:111]
    v_exp_f32 v123, v123
    v_exp_f32 v124, v124
    v_exp_f32 v125, v125
    v_exp_f32 v126, v126
    v_exp_f32 v127, v127
    v_cvt_pk_bf16_f32 v149, v122, v123
    v_cvt_pk_bf16_f32 v150, v124, v125
    v_mfma_f32_32x32x16_bf16 v[96:111], v[196:199], v[156:159], v[96:111]
    v_cvt_pk_bf16_f32 v151, v126, v127
    v_exp_f32 v128, v128
    v_exp_f32 v129, v129
    v_mfma_f32_32x32x16_bf16 v[112:127], v[168:171], v[32:35], 0
    buffer_load_dwordx4 v[160:163], v2, s[16:19], s41 offen
    buffer_load_dwordx4 v[164:167], v2, s[16:19], s41 offen offset:1024
    s_mov_b64 exec, s[42:43]
    buffer_load_dwordx4 v[192:195], v2, s[20:23], s41 offen
    buffer_load_dwordx4 v[196:199], v2, s[20:23], s41 offen offset:1024
    s_mov_b64 exec, -1
    s_add_u32 s41, s41, 2048
    v_exp_f32 v130, v130
    v_exp_f32 v131, v131
    v_exp_f32 v132, v132
    v_exp_f32 v133, v133
    v_exp_f32 v134, v134
    v_cvt_pk_bf16_f32 v152, v128, v129
    v_cvt_pk_bf16_f32 v153, v130, v131
    v_mfma_f32_32x32x16_bf16 v[112:127], v[172:175], v[36:39], v[112:127]
    v_exp_f32 v135, v135
    v_exp_f32 v136, v136
    v_exp_f32 v137, v137
    v_exp_f32 v138, v138
    v_cvt_pk_bf16_f32 v154, v132, v133
    v_cvt_pk_bf16_f32 v155, v134, v135
    v_cvt_pk_bf16_f32 v156, v136, v137
    v_mfma_f32_32x32x16_bf16 v[48:63], v[200:203], v[144:147], v[48:63]
    v_exp_f32 v139, v139
    v_exp_f32 v140, v140
    v_exp_f32 v141, v141
    v_exp_f32 v142, v142
    v_exp_f32 v143, v143
    v_cvt_pk_bf16_f32 v157, v138, v139
    v_cvt_pk_bf16_f32 v158, v140, v141
    v_mfma_f32_32x32x16_bf16 v[48:63], v[204:207], v[148:151], v[48:63]
    v_cvt_pk_bf16_f32 v159, v142, v143
    v_exp_f32 v112, v112
    v_exp_f32 v113, v113
    v_mfma_f32_32x32x16_bf16 v[128:143], v[168:171], v[40:43], 0
    s_add_u32 s30, s57, 20480
    buffer_load_dwordx4 a[80:83], v2, s[64:67], s30 offen offset:0
    buffer_load_dwordx4 a[84:87], v2, s[64:67], s30 offen offset:1024
    buffer_load_dwordx4 a[88:91], v2, s[64:67], s30 offen offset:2048
    buffer_load_dwordx4 a[92:95], v2, s[64:67], s30 offen offset:3072
    v_exp_f32 v114, v114
    v_exp_f32 v115, v115
    v_exp_f32 v116, v116
    v_exp_f32 v117, v117
    v_exp_f32 v118, v118
    v_cvt_pk_bf16_f32 v144, v112, v113
    v_cvt_pk_bf16_f32 v145, v114, v115
    v_mfma_f32_32x32x16_bf16 v[128:143], v[172:175], v[44:47], v[128:143]
    v_exp_f32 v119, v119
    v_exp_f32 v120, v120
    v_exp_f32 v121, v121
    v_exp_f32 v122, v122
    v_cvt_pk_bf16_f32 v146, v116, v117
    v_cvt_pk_bf16_f32 v147, v118, v119
    v_cvt_pk_bf16_f32 v148, v120, v121
    v_mfma_f32_32x32x16_bf16 v[64:79], v[200:203], v[152:155], v[64:79]
    v_exp_f32 v123, v123
    v_exp_f32 v124, v124
    v_exp_f32 v125, v125
    v_exp_f32 v126, v126
    v_exp_f32 v127, v127
    v_cvt_pk_bf16_f32 v149, v122, v123
    v_cvt_pk_bf16_f32 v150, v124, v125
    v_mfma_f32_32x32x16_bf16 v[64:79], v[204:207], v[156:159], v[64:79]
    v_cvt_pk_bf16_f32 v151, v126, v127
    s_waitcnt vmcnt(20)
    v_and_b32 v182, v3, v182
    v_and_b32 v183, v3, v183
    v_exp_f32 v128, v128
    v_exp_f32 v129, v129
    v_mfma_f32_32x32x16_bf16 v[112:127], v[176:179], v[16:19], 0
    v_exp_f32 v130, v130
    v_exp_f32 v131, v131
    v_exp_f32 v132, v132
    v_exp_f32 v133, v133
    v_exp_f32 v134, v134
    v_cvt_pk_bf16_f32 v152, v128, v129
    v_cvt_pk_bf16_f32 v153, v130, v131
    v_mfma_f32_32x32x16_bf16 v[112:127], v[180:183], v[20:23], v[112:127]
    v_exp_f32 v135, v135
    v_exp_f32 v136, v136
    v_exp_f32 v137, v137
    v_exp_f32 v138, v138
    v_cvt_pk_bf16_f32 v154, v132, v133
    v_cvt_pk_bf16_f32 v155, v134, v135
    v_cvt_pk_bf16_f32 v156, v136, v137
    v_mfma_f32_32x32x16_bf16 v[80:95], v[200:203], v[144:147], v[80:95]
    v_exp_f32 v139, v139
    v_exp_f32 v140, v140
    v_exp_f32 v141, v141
    v_exp_f32 v142, v142
    v_exp_f32 v143, v143
    v_cvt_pk_bf16_f32 v157, v138, v139
    v_cvt_pk_bf16_f32 v158, v140, v141
    v_mfma_f32_32x32x16_bf16 v[80:95], v[204:207], v[148:151], v[80:95]
    v_cvt_pk_bf16_f32 v159, v142, v143
    v_exp_f32 v112, v112
    v_exp_f32 v113, v113
    v_mfma_f32_32x32x16_bf16 v[128:143], v[176:179], v[24:27], 0
    v_exp_f32 v114, v114
    v_exp_f32 v115, v115
    v_exp_f32 v116, v116
    v_exp_f32 v117, v117
    v_exp_f32 v118, v118
    v_cvt_pk_bf16_f32 v144, v112, v113
    v_cvt_pk_bf16_f32 v145, v114, v115
    v_mfma_f32_32x32x16_bf16 v[128:143], v[180:183], v[28:31], v[128:143]
    v_exp_f32 v119, v119
    v_exp_f32 v120, v120
    v_exp_f32 v121, v121
    v_exp_f32 v122, v122
    v_cvt_pk_bf16_f32 v146, v116, v117
    v_cvt_pk_bf16_f32 v147, v118, v119
    v_cvt_pk_bf16_f32 v148, v120, v121
    v_mfma_f32_32x32x16_bf16 v[96:111], v[200:203], v[152:155], v[96:111]
    v_exp_f32 v123, v123
    v_exp_f32 v124, v124
    v_exp_f32 v125, v125
    v_exp_f32 v126, v126
    v_exp_f32 v127, v127
    v_cvt_pk_bf16_f32 v149, v122, v123
    v_cvt_pk_bf16_f32 v150, v124, v125
    v_mfma_f32_32x32x16_bf16 v[96:111], v[204:207], v[156:159], v[96:111]
    v_cvt_pk_bf16_f32 v151, v126, v127
    v_exp_f32 v128, v128
    v_exp_f32 v129, v129
    v_mfma_f32_32x32x16_bf16 v[112:127], v[176:179], v[32:35], 0
    buffer_load_dwordx4 v[168:171], v2, s[16:19], s41 offen
    buffer_load_dwordx4 v[172:175], v2, s[16:19], s41 offen offset:1024
    s_mov_b64 exec, s[42:43]
    buffer_load_dwordx4 v[200:203], v2, s[20:23], s41 offen
    buffer_load_dwordx4 v[204:207], v2, s[20:23], s41 offen offset:1024
    s_mov_b64 exec, -1
    s_add_u32 s41, s41, 2048
    v_exp_f32 v130, v130
    v_exp_f32 v131, v131
    v_exp_f32 v132, v132
    v_exp_f32 v133, v133
    v_exp_f32 v134, v134
    v_cvt_pk_bf16_f32 v152, v128, v129
    v_cvt_pk_bf16_f32 v153, v130, v131
    v_mfma_f32_32x32x16_bf16 v[112:127], v[180:183], v[36:39], v[112:127]
    v_exp_f32 v135, v135
    v_exp_f32 v136, v136
    v_exp_f32 v137, v137
    v_exp_f32 v138, v138
    v_cvt_pk_bf16_f32 v154, v132, v133
    v_cvt_pk_bf16_f32 v155, v134, v135
    v_cvt_pk_bf16_f32 v156, v136, v137
    v_mfma_f32_32x32x16_bf16 v[48:63], v[208:211], v[144:147], v[48:63]
    v_exp_f32 v139, v139
    v_exp_f32 v140, v140
    v_exp_f32 v141, v141
    v_exp_f32 v142, v142
    v_exp_f32 v143, v143
    v_cvt_pk_bf16_f32 v157, v138, v139
    v_cvt_pk_bf16_f32 v158, v140, v141
    v_mfma_f32_32x32x16_bf16 v[48:63], v[212:215], v[148:151], v[48:63]
    v_cvt_pk_bf16_f32 v159, v142, v143
    v_exp_f32 v112, v112
    v_exp_f32 v113, v113
    v_mfma_f32_32x32x16_bf16 v[128:143], v[176:179], v[40:43], 0
    s_add_u32 s30, s57, 24576
    buffer_load_dwordx4 a[96:99], v2, s[64:67], s30 offen offset:0
    buffer_load_dwordx4 a[100:103], v2, s[64:67], s30 offen offset:1024
    buffer_load_dwordx4 a[104:107], v2, s[64:67], s30 offen offset:2048
    buffer_load_dwordx4 a[108:111], v2, s[64:67], s30 offen offset:3072
    v_exp_f32 v114, v114
    v_exp_f32 v115, v115
    v_exp_f32 v116, v116
    v_exp_f32 v117, v117
    v_exp_f32 v118, v118
    v_cvt_pk_bf16_f32 v144, v112, v113
    v_cvt_pk_bf16_f32 v145, v114, v115
    v_mfma_f32_32x32x16_bf16 v[128:143], v[180:183], v[44:47], v[128:143]
    v_exp_f32 v119, v119
    v_exp_f32 v120, v120
    v_exp_f32 v121, v121
    v_exp_f32 v122, v122
    v_cvt_pk_bf16_f32 v146, v116, v117
    v_cvt_pk_bf16_f32 v147, v118, v119
    v_cvt_pk_bf16_f32 v148, v120, v121
    v_mfma_f32_32x32x16_bf16 v[64:79], v[208:211], v[152:155], v[64:79]
    v_exp_f32 v123, v123
    v_exp_f32 v124, v124
    v_exp_f32 v125, v125
    v_exp_f32 v126, v126
    v_exp_f32 v127, v127
    v_cvt_pk_bf16_f32 v149, v122, v123
    v_cvt_pk_bf16_f32 v150, v124, v125
    v_mfma_f32_32x32x16_bf16 v[64:79], v[212:215], v[156:159], v[64:79]
    v_cvt_pk_bf16_f32 v151, v126, v127
    s_waitcnt vmcnt(20)
    v_and_b32 v190, v3, v190
    v_and_b32 v191, v3, v191
    v_exp_f32 v128, v128
    v_exp_f32 v129, v129
    v_mfma_f32_32x32x16_bf16 v[112:127], v[184:187], v[16:19], 0
    v_exp_f32 v130, v130
    v_exp_f32 v131, v131
    v_exp_f32 v132, v132
    v_exp_f32 v133, v133
    v_exp_f32 v134, v134
    v_cvt_pk_bf16_f32 v152, v128, v129
    v_cvt_pk_bf16_f32 v153, v130, v131
    v_mfma_f32_32x32x16_bf16 v[112:127], v[188:191], v[20:23], v[112:127]
    v_exp_f32 v135, v135
    v_exp_f32 v136, v136
    v_exp_f32 v137, v137
    v_exp_f32 v138, v138
    v_cvt_pk_bf16_f32 v154, v132, v133
    v_cvt_pk_bf16_f32 v155, v134, v135
    v_cvt_pk_bf16_f32 v156, v136, v137
    v_mfma_f32_32x32x16_bf16 v[80:95], v[208:211], v[144:147], v[80:95]
    v_exp_f32 v139, v139
    v_exp_f32 v140, v140
    v_exp_f32 v141, v141
    v_exp_f32 v142, v142
    v_exp_f32 v143, v143
    v_cvt_pk_bf16_f32 v157, v138, v139
    v_cvt_pk_bf16_f32 v158, v140, v141
    v_mfma_f32_32x32x16_bf16 v[80:95], v[212:215], v[148:151], v[80:95]
    v_cvt_pk_bf16_f32 v159, v142, v143
    v_exp_f32 v112, v112
    v_exp_f32 v113, v113
    v_mfma_f32_32x32x16_bf16 v[128:143], v[184:187], v[24:27], 0
    v_exp_f32 v114, v114
    v_exp_f32 v115, v115
    v_exp_f32 v116, v116
    v_exp_f32 v117, v117
    v_exp_f32 v118, v118
    v_cvt_pk_bf16_f32 v144, v112, v113
    v_cvt_pk_bf16_f32 v145, v114, v115
    v_mfma_f32_32x32x16_bf16 v[128:143], v[188:191], v[28:31], v[128:143]
    v_exp_f32 v119, v119
    v_exp_f32 v120, v120
    v_exp_f32 v121, v121
    v_exp_f32 v122, v122
    v_cvt_pk_bf16_f32 v146, v116, v117
    v_cvt_pk_bf16_f32 v147, v118, v119
    v_cvt_pk_bf16_f32 v148, v120, v121
    v_mfma_f32_32x32x16_bf16 v[96:111], v[208:211], v[152:155], v[96:111]
    v_exp_f32 v123, v123
    v_exp_f32 v124, v124
    v_exp_f32 v125, v125
    v_exp_f32 v126, v126
    v_exp_f32 v127, v127
    v_cvt_pk_bf16_f32 v149, v122, v123
    v_cvt_pk_bf16_f32 v150, v124, v125
    v_mfma_f32_32x32x16_bf16 v[96:111], v[212:215], v[156:159], v[96:111]
    v_cvt_pk_bf16_f32 v151, v126, v127
    v_exp_f32 v128, v128
    v_exp_f32 v129, v129
    v_mfma_f32_32x32x16_bf16 v[112:127], v[184:187], v[32:35], 0
    buffer_load_dwordx4 v[176:179], v2, s[16:19], s41 offen
    buffer_load_dwordx4 v[180:183], v2, s[16:19], s41 offen offset:1024
    s_mov_b64 exec, s[42:43]
    buffer_load_dwordx4 v[208:211], v2, s[20:23], s41 offen
    buffer_load_dwordx4 v[212:215], v2, s[20:23], s41 offen offset:1024
    s_mov_b64 exec, -1
    s_add_u32 s41, s41, 2048
    v_exp_f32 v130, v130
    v_exp_f32 v131, v131
    v_exp_f32 v132, v132
    v_exp_f32 v133, v133
    v_exp_f32 v134, v134
    v_cvt_pk_bf16_f32 v152, v128, v129
    v_cvt_pk_bf16_f32 v153, v130, v131
    v_mfma_f32_32x32x16_bf16 v[112:127], v[188:191], v[36:39], v[112:127]
    v_exp_f32 v135, v135
    v_exp_f32 v136, v136
    v_exp_f32 v137, v137
    v_exp_f32 v138, v138
    v_cvt_pk_bf16_f32 v154, v132, v133
    v_cvt_pk_bf16_f32 v155, v134, v135
    v_cvt_pk_bf16_f32 v156, v136, v137
    v_mfma_f32_32x32x16_bf16 v[48:63], v[216:219], v[144:147], v[48:63]
    v_exp_f32 v139, v139
    v_exp_f32 v140, v140
    v_exp_f32 v141, v141
    v_exp_f32 v142, v142
    v_exp_f32 v143, v143
    v_cvt_pk_bf16_f32 v157, v138, v139
    v_cvt_pk_bf16_f32 v158, v140, v141
    v_mfma_f32_32x32x16_bf16 v[48:63], v[220:223], v[148:151], v[48:63]
    v_cvt_pk_bf16_f32 v159, v142, v143
    v_exp_f32 v112, v112
    v_exp_f32 v113, v113
    v_mfma_f32_32x32x16_bf16 v[128:143], v[184:187], v[40:43], 0
    s_add_u32 s30, s57, 28672
    buffer_load_dwordx4 a[112:115], v2, s[64:67], s30 offen offset:0
    buffer_load_dwordx4 a[116:119], v2, s[64:67], s30 offen offset:1024
    buffer_load_dwordx4 a[120:123], v2, s[64:67], s30 offen offset:2048
    buffer_load_dwordx4 a[124:127], v2, s[64:67], s30 offen offset:3072
    v_exp_f32 v114, v114
    v_exp_f32 v115, v115
    v_exp_f32 v116, v116
    v_exp_f32 v117, v117
    v_exp_f32 v118, v118
    v_cvt_pk_bf16_f32 v144, v112, v113
    v_cvt_pk_bf16_f32 v145, v114, v115
    v_mfma_f32_32x32x16_bf16 v[128:143], v[188:191], v[44:47], v[128:143]
    v_exp_f32 v119, v119
    v_exp_f32 v120, v120
    v_exp_f32 v121, v121
    v_exp_f32 v122, v122
    v_cvt_pk_bf16_f32 v146, v116, v117
    v_cvt_pk_bf16_f32 v147, v118, v119
    v_cvt_pk_bf16_f32 v148, v120, v121
    v_mfma_f32_32x32x16_bf16 v[64:79], v[216:219], v[152:155], v[64:79]
    v_exp_f32 v123, v123
    v_exp_f32 v124, v124
    v_exp_f32 v125, v125
    v_exp_f32 v126, v126
    v_exp_f32 v127, v127
    v_cvt_pk_bf16_f32 v149, v122, v123
    v_cvt_pk_bf16_f32 v150, v124, v125
    v_mfma_f32_32x32x16_bf16 v[64:79], v[220:223], v[156:159], v[64:79]
    v_cvt_pk_bf16_f32 v151, v126, v127
    s_waitcnt vmcnt(20)
    v_and_b32 v166, v3, v166
    v_and_b32 v167, v3, v167
    v_exp_f32 v128, v128
    v_exp_f32 v129, v129
    v_mfma_f32_32x32x16_bf16 v[112:127], v[160:163], v[16:19], 0
    v_exp_f32 v130, v130
    v_exp_f32 v131, v131
    v_exp_f32 v132, v132
    v_exp_f32 v133, v133
    v_exp_f32 v134, v134
    v_cvt_pk_bf16_f32 v152, v128, v129
    v_cvt_pk_bf16_f32 v153, v130, v131
    v_mfma_f32_32x32x16_bf16 v[112:127], v[164:167], v[20:23], v[112:127]
    v_exp_f32 v135, v135
    v_exp_f32 v136, v136
    v_exp_f32 v137, v137
    v_exp_f32 v138, v138
    v_cvt_pk_bf16_f32 v154, v132, v133
    v_cvt_pk_bf16_f32 v155, v134, v135
    v_cvt_pk_bf16_f32 v156, v136, v137
    v_mfma_f32_32x32x16_bf16 v[80:95], v[216:219], v[144:147], v[80:95]
    v_exp_f32 v139, v139
    v_exp_f32 v140, v140
    v_exp_f32 v141, v141
    v_exp_f32 v142, v142
    v_exp_f32 v143, v143
    v_cvt_pk_bf16_f32 v157, v138, v139
    v_cvt_pk_bf16_f32 v158, v140, v141
    v_mfma_f32_32x32x16_bf16 v[80:95], v[220:223], v[148:151], v[80:95]
    v_cvt_pk_bf16_f32 v159, v142, v143
    v_exp_f32 v112, v112
    v_exp_f32 v113, v113
    v_mfma_f32_32x32x16_bf16 v[128:143], v[160:163], v[24:27], 0
    v_exp_f32 v114, v114
    v_exp_f32 v115, v115
    v_exp_f32 v116, v116
    v_exp_f32 v117, v117
    v_exp_f32 v118, v118
    v_cvt_pk_bf16_f32 v144, v112, v113
    v_cvt_pk_bf16_f32 v145, v114, v115
    v_mfma_f32_32x32x16_bf16 v[128:143], v[164:167], v[28:31], v[128:143]
    v_exp_f32 v119, v119
    v_exp_f32 v120, v120
    v_exp_f32 v121, v121
    v_exp_f32 v122, v122
    v_cvt_pk_bf16_f32 v146, v116, v117
    v_cvt_pk_bf16_f32 v147, v118, v119
    v_cvt_pk_bf16_f32 v148, v120, v121
    v_mfma_f32_32x32x16_bf16 v[96:111], v[216:219], v[152:155], v[96:111]
    v_exp_f32 v123, v123
    v_exp_f32 v124, v124
    v_exp_f32 v125, v125
    v_exp_f32 v126, v126
    v_exp_f32 v127, v127
    v_cvt_pk_bf16_f32 v149, v122, v123
    v_cvt_pk_bf16_f32 v150, v124, v125
    v_mfma_f32_32x32x16_bf16 v[96:111], v[220:223], v[156:159], v[96:111]
    v_cvt_pk_bf16_f32 v151, v126, v127
    v_exp_f32 v128, v128
    v_exp_f32 v129, v129
    v_mfma_f32_32x32x16_bf16 v[112:127], v[160:163], v[32:35], 0
    buffer_load_dwordx4 v[184:187], v2, s[16:19], s41 offen
    buffer_load_dwordx4 v[188:191], v2, s[16:19], s41 offen offset:1024
    s_mov_b64 exec, s[42:43]
    buffer_load_dwordx4 v[216:219], v2, s[20:23], s41 offen
    buffer_load_dwordx4 v[220:223], v2, s[20:23], s41 offen offset:1024
    s_mov_b64 exec, -1
    s_add_u32 s41, s41, 2048
    v_exp_f32 v130, v130
    v_exp_f32 v131, v131
    v_exp_f32 v132, v132
    v_exp_f32 v133, v133
    v_exp_f32 v134, v134
    v_cvt_pk_bf16_f32 v152, v128, v129
    v_cvt_pk_bf16_f32 v153, v130, v131
    v_mfma_f32_32x32x16_bf16 v[112:127], v[164:167], v[36:39], v[112:127]
    v_exp_f32 v135, v135
    v_exp_f32 v136, v136
    v_exp_f32 v137, v137
    v_exp_f32 v138, v138
    v_cvt_pk_bf16_f32 v154, v132, v133
    v_cvt_pk_bf16_f32 v155, v134, v135
    v_cvt_pk_bf16_f32 v156, v136, v137
    v_mfma_f32_32x32x16_bf16 v[48:63], v[192:195], v[144:147], v[48:63]
    v_exp_f32 v139, v139
    v_exp_f32 v140, v140
    v_exp_f32 v141, v141
    v_exp_f32 v142, v142
    v_exp_f32 v143, v143
    v_cvt_pk_bf16_f32 v157, v138, v139
    v_cvt_pk_bf16_f32 v158, v140, v141
    v_mfma_f32_32x32x16_bf16 v[48:63], v[196:199], v[148:151], v[48:63]
    v_cvt_pk_bf16_f32 v159, v142, v143
    v_exp_f32 v112, v112
    v_exp_f32 v113, v113
    v_mfma_f32_32x32x16_bf16 v[128:143], v[160:163], v[40:43], 0
    s_add_u32 s30, s57, 32768
    buffer_load_dwordx4 a[128:131], v2, s[64:67], s30 offen offset:0
    buffer_load_dwordx4 a[132:135], v2, s[64:67], s30 offen offset:1024
    buffer_load_dwordx4 a[136:139], v2, s[64:67], s30 offen offset:2048
    buffer_load_dwordx4 a[140:143], v2, s[64:67], s30 offen offset:3072
    v_exp_f32 v114, v114
    v_exp_f32 v115, v115
    v_exp_f32 v116, v116
    v_exp_f32 v117, v117
    v_exp_f32 v118, v118
    v_cvt_pk_bf16_f32 v144, v112, v113
    v_cvt_pk_bf16_f32 v145, v114, v115
    v_mfma_f32_32x32x16_bf16 v[128:143], v[164:167], v[44:47], v[128:143]
    v_exp_f32 v119, v119
    v_exp_f32 v120, v120
    v_exp_f32 v121, v121
    v_exp_f32 v122, v122
    v_cvt_pk_bf16_f32 v146, v116, v117
    v_cvt_pk_bf16_f32 v147, v118, v119
    v_cvt_pk_bf16_f32 v148, v120, v121
    v_mfma_f32_32x32x16_bf16 v[64:79], v[192:195], v[152:155], v[64:79]
    v_exp_f32 v123, v123
    v_exp_f32 v124, v124
    v_exp_f32 v125, v125
    v_exp_f32 v126, v126
    v_exp_f32 v127, v127
    v_cvt_pk_bf16_f32 v149, v122, v123
    v_cvt_pk_bf16_f32 v150, v124, v125
    v_mfma_f32_32x32x16_bf16 v[64:79], v[196:199], v[156:159], v[64:79]
    v_cvt_pk_bf16_f32 v151, v126, v127
    s_waitcnt vmcnt(20)
    v_and_b32 v174, v3, v174
    v_and_b32 v175, v3, v175
    v_exp_f32 v128, v128
    v_exp_f32 v129, v129
    v_mfma_f32_32x32x16_bf16 v[112:127], v[168:171], v[16:19], 0
    v_exp_f32 v130, v130
    v_exp_f32 v131, v131
    v_exp_f32 v132, v132
    v_exp_f32 v133, v133
    v_exp_f32 v134, v134
    v_cvt_pk_bf16_f32 v152, v128, v129
    v_cvt_pk_bf16_f32 v153, v130, v131
    v_mfma_f32_32x32x16_bf16 v[112:127], v[172:175], v[20:23], v[112:127]
    v_exp_f32 v135, v135
    v_exp_f32 v136, v136
    v_exp_f32 v137, v137
    v_exp_f32 v138, v138
    v_cvt_pk_bf16_f32 v154, v132, v133
    v_cvt_pk_bf16_f32 v155, v134, v135
    v_cvt_pk_bf16_f32 v156, v136, v137
    v_mfma_f32_32x32x16_bf16 v[80:95], v[192:195], v[144:147], v[80:95]
    v_exp_f32 v139, v139
    v_exp_f32 v140, v140
    v_exp_f32 v141, v141
    v_exp_f32 v142, v142
    v_exp_f32 v143, v143
    v_cvt_pk_bf16_f32 v157, v138, v139
    v_cvt_pk_bf16_f32 v158, v140, v141
    v_mfma_f32_32x32x16_bf16 v[80:95], v[196:199], v[148:151], v[80:95]
    v_cvt_pk_bf16_f32 v159, v142, v143
    v_exp_f32 v112, v112
    v_exp_f32 v113, v113
    v_mfma_f32_32x32x16_bf16 v[128:143], v[168:171], v[24:27], 0
    v_exp_f32 v114, v114
    v_exp_f32 v115, v115
    v_exp_f32 v116, v116
    v_exp_f32 v117, v117
    v_exp_f32 v118, v118
    v_cvt_pk_bf16_f32 v144, v112, v113
    v_cvt_pk_bf16_f32 v145, v114, v115
    v_mfma_f32_32x32x16_bf16 v[128:143], v[172:175], v[28:31], v[128:143]
    v_exp_f32 v119, v119
    v_exp_f32 v120, v120
    v_exp_f32 v121, v121
    v_exp_f32 v122, v122
    v_cvt_pk_bf16_f32 v146, v116, v117
    v_cvt_pk_bf16_f32 v147, v118, v119
    v_cvt_pk_bf16_f32 v148, v120, v121
    v_mfma_f32_32x32x16_bf16 v[96:111], v[192:195], v[152:155], v[96:111]
    v_exp_f32 v123, v123
    v_exp_f32 v124, v124
    v_exp_f32 v125, v125
    v_exp_f32 v126, v126
    v_exp_f32 v127, v127
    v_cvt_pk_bf16_f32 v149, v122, v123
    v_cvt_pk_bf16_f32 v150, v124, v125
    v_mfma_f32_32x32x16_bf16 v[96:111], v[196:199], v[156:159], v[96:111]
    v_cvt_pk_bf16_f32 v151, v126, v127
    v_exp_f32 v128, v128
    v_exp_f32 v129, v129
    v_mfma_f32_32x32x16_bf16 v[112:127], v[168:171], v[32:35], 0
    buffer_load_dwordx4 v[160:163], v2, s[16:19], s41 offen
    buffer_load_dwordx4 v[164:167], v2, s[16:19], s41 offen offset:1024
    s_mov_b64 exec, s[42:43]
    buffer_load_dwordx4 v[192:195], v2, s[20:23], s41 offen
    buffer_load_dwordx4 v[196:199], v2, s[20:23], s41 offen offset:1024
    s_mov_b64 exec, -1
    s_add_u32 s41, s41, 2048
    v_exp_f32 v130, v130
    v_exp_f32 v131, v131
    v_exp_f32 v132, v132
    v_exp_f32 v133, v133
    v_exp_f32 v134, v134
    v_cvt_pk_bf16_f32 v152, v128, v129
    v_cvt_pk_bf16_f32 v153, v130, v131
    v_mfma_f32_32x32x16_bf16 v[112:127], v[172:175], v[36:39], v[112:127]
    v_exp_f32 v135, v135
    v_exp_f32 v136, v136
    v_exp_f32 v137, v137
    v_exp_f32 v138, v138
    v_cvt_pk_bf16_f32 v154, v132, v133
    v_cvt_pk_bf16_f32 v155, v134, v135
    v_cvt_pk_bf16_f32 v156, v136, v137
    v_mfma_f32_32x32x16_bf16 v[48:63], v[200:203], v[144:147], v[48:63]
    v_exp_f32 v139, v139
    v_exp_f32 v140, v140
    v_exp_f32 v141, v141
    v_exp_f32 v142, v142
    v_exp_f32 v143, v143
    v_cvt_pk_bf16_f32 v157, v138, v139
    v_cvt_pk_bf16_f32 v158, v140, v141
    v_mfma_f32_32x32x16_bf16 v[48:63], v[204:207], v[148:151], v[48:63]
    v_cvt_pk_bf16_f32 v159, v142, v143
    v_exp_f32 v112, v112
    v_exp_f32 v113, v113
    v_mfma_f32_32x32x16_bf16 v[128:143], v[168:171], v[40:43], 0
    s_add_u32 s30, s57, 36864
    buffer_load_dwordx4 a[144:147], v2, s[64:67], s30 offen offset:0
    buffer_load_dwordx4 a[148:151], v2, s[64:67], s30 offen offset:1024
    buffer_load_dwordx4 a[152:155], v2, s[64:67], s30 offen offset:2048
    buffer_load_dwordx4 a[156:159], v2, s[64:67], s30 offen offset:3072
    v_exp_f32 v114, v114
    v_exp_f32 v115, v115
    v_exp_f32 v116, v116
    v_exp_f32 v117, v117
    v_exp_f32 v118, v118
    v_cvt_pk_bf16_f32 v144, v112, v113
    v_cvt_pk_bf16_f32 v145, v114, v115
    v_mfma_f32_32x32x16_bf16 v[128:143], v[172:175], v[44:47], v[128:143]
    v_exp_f32 v119, v119
    v_exp_f32 v120, v120
    v_exp_f32 v121, v121
    v_exp_f32 v122, v122
    v_cvt_pk_bf16_f32 v146, v116, v117
    v_cvt_pk_bf16_f32 v147, v118, v119
    v_cvt_pk_bf16_f32 v148, v120, v121
    v_mfma_f32_32x32x16_bf16 v[64:79], v[200:203], v[152:155], v[64:79]
    v_exp_f32 v123, v123
    v_exp_f32 v124, v124
    v_exp_f32 v125, v125
    v_exp_f32 v126, v126
    v_exp_f32 v127, v127
    v_cvt_pk_bf16_f32 v149, v122, v123
    v_cvt_pk_bf16_f32 v150, v124, v125
    v_mfma_f32_32x32x16_bf16 v[64:79], v[204:207], v[156:159], v[64:79]
    v_cvt_pk_bf16_f32 v151, v126, v127
    s_waitcnt vmcnt(20)
    v_and_b32 v182, v3, v182
    v_and_b32 v183, v3, v183
    v_exp_f32 v128, v128
    v_exp_f32 v129, v129
    v_mfma_f32_32x32x16_bf16 v[112:127], v[176:179], v[16:19], 0
    v_exp_f32 v130, v130
    v_exp_f32 v131, v131
    v_exp_f32 v132, v132
    v_exp_f32 v133, v133
    v_exp_f32 v134, v134
    v_cvt_pk_bf16_f32 v152, v128, v129
    v_cvt_pk_bf16_f32 v153, v130, v131
    v_mfma_f32_32x32x16_bf16 v[112:127], v[180:183], v[20:23], v[112:127]
    v_exp_f32 v135, v135
    v_exp_f32 v136, v136
    v_exp_f32 v137, v137
    v_exp_f32 v138, v138
    v_cvt_pk_bf16_f32 v154, v132, v133
    v_cvt_pk_bf16_f32 v155, v134, v135
    v_cvt_pk_bf16_f32 v156, v136, v137
    v_mfma_f32_32x32x16_bf16 v[80:95], v[200:203], v[144:147], v[80:95]
    v_exp_f32 v139, v139
    v_exp_f32 v140, v140
    v_exp_f32 v141, v141
    v_exp_f32 v142, v142
    v_exp_f32 v143, v143
    v_cvt_pk_bf16_f32 v157, v138, v139
    v_cvt_pk_bf16_f32 v158, v140, v141
    v_mfma_f32_32x32x16_bf16 v[80:95], v[204:207], v[148:151], v[80:95]
    v_cvt_pk_bf16_f32 v159, v142, v143
    v_exp_f32 v112, v112
    v_exp_f32 v113, v113
    v_mfma_f32_32x32x16_bf16 v[128:143], v[176:179], v[24:27], 0
    v_exp_f32 v114, v114
    v_exp_f32 v115, v115
    v_exp_f32 v116, v116
    v_exp_f32 v117, v117
    v_exp_f32 v118, v118
    v_cvt_pk_bf16_f32 v144, v112, v113
    v_cvt_pk_bf16_f32 v145, v114, v115
    v_mfma_f32_32x32x16_bf16 v[128:143], v[180:183], v[28:31], v[128:143]
    v_exp_f32 v119, v119
    v_exp_f32 v120, v120
    v_exp_f32 v121, v121
    v_exp_f32 v122, v122
    v_cvt_pk_bf16_f32 v146, v116, v117
    v_cvt_pk_bf16_f32 v147, v118, v119
    v_cvt_pk_bf16_f32 v148, v120, v121
    v_mfma_f32_32x32x16_bf16 v[96:111], v[200:203], v[152:155], v[96:111]
    v_exp_f32 v123, v123
    v_exp_f32 v124, v124
    v_exp_f32 v125, v125
    v_exp_f32 v126, v126
    v_exp_f32 v127, v127
    v_cvt_pk_bf16_f32 v149, v122, v123
    v_cvt_pk_bf16_f32 v150, v124, v125
    v_mfma_f32_32x32x16_bf16 v[96:111], v[204:207], v[156:159], v[96:111]
    v_cvt_pk_bf16_f32 v151, v126, v127
    v_exp_f32 v128, v128
    v_exp_f32 v129, v129
    v_mfma_f32_32x32x16_bf16 v[112:127], v[176:179], v[32:35], 0
    buffer_load_dwordx4 v[168:171], v2, s[16:19], s41 offen
    buffer_load_dwordx4 v[172:175], v2, s[16:19], s41 offen offset:1024
    s_mov_b64 exec, s[42:43]
    buffer_load_dwordx4 v[200:203], v2, s[20:23], s41 offen
    buffer_load_dwordx4 v[204:207], v2, s[20:23], s41 offen offset:1024
    s_mov_b64 exec, -1
    s_add_u32 s41, s41, 2048
    v_exp_f32 v130, v130
    v_exp_f32 v131, v131
    v_exp_f32 v132, v132
    v_exp_f32 v133, v133
    v_exp_f32 v134, v134
    v_cvt_pk_bf16_f32 v152, v128, v129
    v_cvt_pk_bf16_f32 v153, v130, v131
    v_mfma_f32_32x32x16_bf16 v[112:127], v[180:183], v[36:39], v[112:127]
    v_exp_f32 v135, v135
    v_exp_f32 v136, v136
    v_exp_f32 v137, v137
    v_exp_f32 v138, v138
    v_cvt_pk_bf16_f32 v154, v132, v133
    v_cvt_pk_bf16_f32 v155, v134, v135
    v_cvt_pk_bf16_f32 v156, v136, v137
    v_mfma_f32_32x32x16_bf16 v[48:63], v[208:211], v[144:147], v[48:63]
    v_exp_f32 v139, v139
    v_exp_f32 v140, v140
    v_exp_f32 v141, v141
    v_exp_f32 v142, v142
    v_exp_f32 v143, v143
    v_cvt_pk_bf16_f32 v157, v138, v139
    v_cvt_pk_bf16_f32 v158, v140, v141
    v_mfma_f32_32x32x16_bf16 v[48:63], v[212:215], v[148:151], v[48:63]
    v_cvt_pk_bf16_f32 v159, v142, v143
    v_exp_f32 v112, v112
    v_exp_f32 v113, v113
    v_mfma_f32_32x32x16_bf16 v[128:143], v[176:179], v[40:43], 0
    s_add_u32 s30, s57, 40960
    buffer_load_dwordx4 a[160:163], v2, s[64:67], s30 offen offset:0
    buffer_load_dwordx4 a[164:167], v2, s[64:67], s30 offen offset:1024
    buffer_load_dwordx4 a[168:171], v2, s[64:67], s30 offen offset:2048
    buffer_load_dwordx4 a[172:175], v2, s[64:67], s30 offen offset:3072
    v_exp_f32 v114, v114
    v_exp_f32 v115, v115
    v_exp_f32 v116, v116
    v_exp_f32 v117, v117
    v_exp_f32 v118, v118
    v_cvt_pk_bf16_f32 v144, v112, v113
    v_cvt_pk_bf16_f32 v145, v114, v115
    v_mfma_f32_32x32x16_bf16 v[128:143], v[180:183], v[44:47], v[128:143]
    v_exp_f32 v119, v119
    v_exp_f32 v120, v120
    v_exp_f32 v121, v121
    v_exp_f32 v122, v122
    v_cvt_pk_bf16_f32 v146, v116, v117
    v_cvt_pk_bf16_f32 v147, v118, v119
    v_cvt_pk_bf16_f32 v148, v120, v121
    v_mfma_f32_32x32x16_bf16 v[64:79], v[208:211], v[152:155], v[64:79]
    v_exp_f32 v123, v123
    v_exp_f32 v124, v124
    v_exp_f32 v125, v125
    v_exp_f32 v126, v126
    v_exp_f32 v127, v127
    v_cvt_pk_bf16_f32 v149, v122, v123
    v_cvt_pk_bf16_f32 v150, v124, v125
    v_mfma_f32_32x32x16_bf16 v[64:79], v[212:215], v[156:159], v[64:79]
    v_cvt_pk_bf16_f32 v151, v126, v127
    s_waitcnt vmcnt(20)
    v_and_b32 v190, v3, v190
    v_and_b32 v191, v3, v191
    v_exp_f32 v128, v128
    v_exp_f32 v129, v129
    v_mfma_f32_32x32x16_bf16 v[112:127], v[184:187], v[16:19], 0
    v_exp_f32 v130, v130
    v_exp_f32 v131, v131
    v_exp_f32 v132, v132
    v_exp_f32 v133, v133
    v_exp_f32 v134, v134
    v_cvt_pk_bf16_f32 v152, v128, v129
    v_cvt_pk_bf16_f32 v153, v130, v131
    v_mfma_f32_32x32x16_bf16 v[112:127], v[188:191], v[20:23], v[112:127]
    v_exp_f32 v135, v135
    v_exp_f32 v136, v136
    v_exp_f32 v137, v137
    v_exp_f32 v138, v138
    v_cvt_pk_bf16_f32 v154, v132, v133
    v_cvt_pk_bf16_f32 v155, v134, v135
    v_cvt_pk_bf16_f32 v156, v136, v137
    v_mfma_f32_32x32x16_bf16 v[80:95], v[208:211], v[144:147], v[80:95]
    v_exp_f32 v139, v139
    v_exp_f32 v140, v140
    v_exp_f32 v141, v141
    v_exp_f32 v142, v142
    v_exp_f32 v143, v143
    v_cvt_pk_bf16_f32 v157, v138, v139
    v_cvt_pk_bf16_f32 v158, v140, v141
    v_mfma_f32_32x32x16_bf16 v[80:95], v[212:215], v[148:151], v[80:95]
    v_cvt_pk_bf16_f32 v159, v142, v143
    v_exp_f32 v112, v112
    v_exp_f32 v113, v113
    v_mfma_f32_32x32x16_bf16 v[128:143], v[184:187], v[24:27], 0
    v_exp_f32 v114, v114
    v_exp_f32 v115, v115
    v_exp_f32 v116, v116
    v_exp_f32 v117, v117
    v_exp_f32 v118, v118
    v_cvt_pk_bf16_f32 v144, v112, v113
    v_cvt_pk_bf16_f32 v145, v114, v115
    v_mfma_f32_32x32x16_bf16 v[128:143], v[188:191], v[28:31], v[128:143]
    v_exp_f32 v119, v119
    v_exp_f32 v120, v120
    v_exp_f32 v121, v121
    v_exp_f32 v122, v122
    v_cvt_pk_bf16_f32 v146, v116, v117
    v_cvt_pk_bf16_f32 v147, v118, v119
    v_cvt_pk_bf16_f32 v148, v120, v121
    v_mfma_f32_32x32x16_bf16 v[96:111], v[208:211], v[152:155], v[96:111]
    v_exp_f32 v123, v123
    v_exp_f32 v124, v124
    v_exp_f32 v125, v125
    v_exp_f32 v126, v126
    v_exp_f32 v127, v127
    v_cvt_pk_bf16_f32 v149, v122, v123
    v_cvt_pk_bf16_f32 v150, v124, v125
    v_mfma_f32_32x32x16_bf16 v[96:111], v[212:215], v[156:159], v[96:111]
    v_cvt_pk_bf16_f32 v151, v126, v127
    v_exp_f32 v128, v128
    v_exp_f32 v129, v129
    v_mfma_f32_32x32x16_bf16 v[112:127], v[184:187], v[32:35], 0
    buffer_load_dwordx4 v[176:179], v2, s[16:19], s41 offen
    buffer_load_dwordx4 v[180:183], v2, s[16:19], s41 offen offset:1024
    s_mov_b64 exec, s[42:43]
    buffer_load_dwordx4 v[208:211], v2, s[20:23], s41 offen
    buffer_load_dwordx4 v[212:215], v2, s[20:23], s41 offen offset:1024
    s_mov_b64 exec, -1
    s_add_u32 s41, s41, 2048
    v_exp_f32 v130, v130
    v_exp_f32 v131, v131
    v_exp_f32 v132, v132
    v_exp_f32 v133, v133
    v_exp_f32 v134, v134
    v_cvt_pk_bf16_f32 v152, v128, v129
    v_cvt_pk_bf16_f32 v153, v130, v131
    v_mfma_f32_32x32x16_bf16 v[112:127], v[188:191], v[36:39], v[112:127]
    v_exp_f32 v135, v135
    v_exp_f32 v136, v136
    v_exp_f32 v137, v137
    v_exp_f32 v138, v138
    v_cvt_pk_bf16_f32 v154, v132, v133
    v_cvt_pk_bf16_f32 v155, v134, v135
    v_cvt_pk_bf16_f32 v156, v136, v137
    v_mfma_f32_32x32x16_bf16 v[48:63], v[216:219], v[144:147], v[48:63]
    v_exp_f32 v139, v139
    v_exp_f32 v140, v140
    v_exp_f32 v141, v141
    v_exp_f32 v142, v142
    v_exp_f32 v143, v143
    v_cvt_pk_bf16_f32 v157, v138, v139
    v_cvt_pk_bf16_f32 v158, v140, v141
    v_mfma_f32_32x32x16_bf16 v[48:63], v[220:223], v[148:151], v[48:63]
    v_cvt_pk_bf16_f32 v159, v142, v143
    v_exp_f32 v112, v112
    v_exp_f32 v113, v113
    v_mfma_f32_32x32x16_bf16 v[128:143], v[184:187], v[40:43], 0
    s_add_u32 s30, s57, 45056
    buffer_load_dwordx4 a[176:179], v2, s[64:67], s30 offen offset:0
    buffer_load_dwordx4 a[180:183], v2, s[64:67], s30 offen offset:1024
    buffer_load_dwordx4 a[184:187], v2, s[64:67], s30 offen offset:2048
    buffer_load_dwordx4 a[188:191], v2, s[64:67], s30 offen offset:3072
    v_exp_f32 v114, v114
    v_exp_f32 v115, v115
    v_exp_f32 v116, v116
    v_exp_f32 v117, v117
    v_exp_f32 v118, v118
    v_cvt_pk_bf16_f32 v144, v112, v113
    v_cvt_pk_bf16_f32 v145, v114, v115
    v_mfma_f32_32x32x16_bf16 v[128:143], v[188:191], v[44:47], v[128:143]
    v_exp_f32 v119, v119
    v_exp_f32 v120, v120
    v_exp_f32 v121, v121
    v_exp_f32 v122, v122
    v_cvt_pk_bf16_f32 v146, v116, v117
    v_cvt_pk_bf16_f32 v147, v118, v119
    v_cvt_pk_bf16_f32 v148, v120, v121
    v_mfma_f32_32x32x16_bf16 v[64:79], v[216:219], v[152:155], v[64:79]
    v_exp_f32 v123, v123
    v_exp_f32 v124, v124
    v_exp_f32 v125, v125
    v_exp_f32 v126, v126
    v_exp_f32 v127, v127
    v_cvt_pk_bf16_f32 v149, v122, v123
    v_cvt_pk_bf16_f32 v150, v124, v125
    v_mfma_f32_32x32x16_bf16 v[64:79], v[220:223], v[156:159], v[64:79]
    v_cvt_pk_bf16_f32 v151, v126, v127
    s_waitcnt vmcnt(20)
    v_and_b32 v166, v3, v166
    v_and_b32 v167, v3, v167
    v_exp_f32 v128, v128
    v_exp_f32 v129, v129
    v_mfma_f32_32x32x16_bf16 v[112:127], v[160:163], v[16:19], 0
    v_exp_f32 v130, v130
    v_exp_f32 v131, v131
    v_exp_f32 v132, v132
    v_exp_f32 v133, v133
    v_exp_f32 v134, v134
    v_cvt_pk_bf16_f32 v152, v128, v129
    v_cvt_pk_bf16_f32 v153, v130, v131
    v_mfma_f32_32x32x16_bf16 v[112:127], v[164:167], v[20:23], v[112:127]
    v_exp_f32 v135, v135
    v_exp_f32 v136, v136
    v_exp_f32 v137, v137
    v_exp_f32 v138, v138
    v_cvt_pk_bf16_f32 v154, v132, v133
    v_cvt_pk_bf16_f32 v155, v134, v135
    v_cvt_pk_bf16_f32 v156, v136, v137
    v_mfma_f32_32x32x16_bf16 v[80:95], v[216:219], v[144:147], v[80:95]
    v_exp_f32 v139, v139
    v_exp_f32 v140, v140
    v_exp_f32 v141, v141
    v_exp_f32 v142, v142
    v_exp_f32 v143, v143
    v_cvt_pk_bf16_f32 v157, v138, v139
    v_cvt_pk_bf16_f32 v158, v140, v141
    v_mfma_f32_32x32x16_bf16 v[80:95], v[220:223], v[148:151], v[80:95]
    v_cvt_pk_bf16_f32 v159, v142, v143
    v_exp_f32 v112, v112
    v_exp_f32 v113, v113
    v_mfma_f32_32x32x16_bf16 v[128:143], v[160:163], v[24:27], 0
    v_exp_f32 v114, v114
    v_exp_f32 v115, v115
    v_exp_f32 v116, v116
    v_exp_f32 v117, v117
    v_exp_f32 v118, v118
    v_cvt_pk_bf16_f32 v144, v112, v113
    v_cvt_pk_bf16_f32 v145, v114, v115
    v_mfma_f32_32x32x16_bf16 v[128:143], v[164:167], v[28:31], v[128:143]
    v_exp_f32 v119, v119
    v_exp_f32 v120, v120
    v_exp_f32 v121, v121
    v_exp_f32 v122, v122
    v_cvt_pk_bf16_f32 v146, v116, v117
    v_cvt_pk_bf16_f32 v147, v118, v119
    v_cvt_pk_bf16_f32 v148, v120, v121
    v_mfma_f32_32x32x16_bf16 v[96:111], v[216:219], v[152:155], v[96:111]
    v_exp_f32 v123, v123
    v_exp_f32 v124, v124
    v_exp_f32 v125, v125
    v_exp_f32 v126, v126
    v_exp_f32 v127, v127
    v_cvt_pk_bf16_f32 v149, v122, v123
    v_cvt_pk_bf16_f32 v150, v124, v125
    v_mfma_f32_32x32x16_bf16 v[96:111], v[220:223], v[156:159], v[96:111]
    v_cvt_pk_bf16_f32 v151, v126, v127
    v_exp_f32 v128, v128
    v_exp_f32 v129, v129
    v_mfma_f32_32x32x16_bf16 v[112:127], v[160:163], v[32:35], 0
    buffer_load_dwordx4 v[184:187], v2, s[16:19], s41 offen
    buffer_load_dwordx4 v[188:191], v2, s[16:19], s41 offen offset:1024
    s_mov_b64 exec, s[42:43]
    buffer_load_dwordx4 v[216:219], v2, s[20:23], s41 offen
    buffer_load_dwordx4 v[220:223], v2, s[20:23], s41 offen offset:1024
    s_mov_b64 exec, -1
    s_add_u32 s41, s41, 2048
    v_exp_f32 v130, v130
    v_exp_f32 v131, v131
    v_exp_f32 v132, v132
    v_exp_f32 v133, v133
    v_exp_f32 v134, v134
    v_cvt_pk_bf16_f32 v152, v128, v129
    v_cvt_pk_bf16_f32 v153, v130, v131
    v_mfma_f32_32x32x16_bf16 v[112:127], v[164:167], v[36:39], v[112:127]
    v_exp_f32 v135, v135
    v_exp_f32 v136, v136
    v_exp_f32 v137, v137
    v_exp_f32 v138, v138
    v_cvt_pk_bf16_f32 v154, v132, v133
    v_cvt_pk_bf16_f32 v155, v134, v135
    v_cvt_pk_bf16_f32 v156, v136, v137
    v_mfma_f32_32x32x16_bf16 v[48:63], v[192:195], v[144:147], v[48:63]
    v_exp_f32 v139, v139
    v_exp_f32 v140, v140
    v_exp_f32 v141, v141
    v_exp_f32 v142, v142
    v_exp_f32 v143, v143
    v_cvt_pk_bf16_f32 v157, v138, v139
    v_cvt_pk_bf16_f32 v158, v140, v141
    v_mfma_f32_32x32x16_bf16 v[48:63], v[196:199], v[148:151], v[48:63]
    v_cvt_pk_bf16_f32 v159, v142, v143
    v_exp_f32 v112, v112
    v_exp_f32 v113, v113
    v_mfma_f32_32x32x16_bf16 v[128:143], v[160:163], v[40:43], 0
    s_add_u32 s30, s57, 49152
    buffer_load_dwordx4 a[192:195], v2, s[64:67], s30 offen offset:0
    buffer_load_dwordx4 a[196:199], v2, s[64:67], s30 offen offset:1024
    buffer_load_dwordx4 a[200:203], v2, s[64:67], s30 offen offset:2048
    buffer_load_dwordx4 a[204:207], v2, s[64:67], s30 offen offset:3072
    v_exp_f32 v114, v114
    v_exp_f32 v115, v115
    v_exp_f32 v116, v116
    v_exp_f32 v117, v117
    v_exp_f32 v118, v118
    v_cvt_pk_bf16_f32 v144, v112, v113
    v_cvt_pk_bf16_f32 v145, v114, v115
    v_mfma_f32_32x32x16_bf16 v[128:143], v[164:167], v[44:47], v[128:143]
    v_exp_f32 v119, v119
    v_exp_f32 v120, v120
    v_exp_f32 v121, v121
    v_exp_f32 v122, v122
    v_cvt_pk_bf16_f32 v146, v116, v117
    v_cvt_pk_bf16_f32 v147, v118, v119
    v_cvt_pk_bf16_f32 v148, v120, v121
    v_mfma_f32_32x32x16_bf16 v[64:79], v[192:195], v[152:155], v[64:79]
    v_exp_f32 v123, v123
    v_exp_f32 v124, v124
    v_exp_f32 v125, v125
    v_exp_f32 v126, v126
    v_exp_f32 v127, v127
    v_cvt_pk_bf16_f32 v149, v122, v123
    v_cvt_pk_bf16_f32 v150, v124, v125
    v_mfma_f32_32x32x16_bf16 v[64:79], v[196:199], v[156:159], v[64:79]
    v_cvt_pk_bf16_f32 v151, v126, v127
    s_waitcnt vmcnt(20)
    v_and_b32 v174, v3, v174
    v_and_b32 v175, v3, v175
    v_exp_f32 v128, v128
    v_exp_f32 v129, v129
    v_mfma_f32_32x32x16_bf16 v[112:127], v[168:171], v[16:19], 0
    v_exp_f32 v130, v130
    v_exp_f32 v131, v131
    v_exp_f32 v132, v132
    v_exp_f32 v133, v133
    v_exp_f32 v134, v134
    v_cvt_pk_bf16_f32 v152, v128, v129
    v_cvt_pk_bf16_f32 v153, v130, v131
    v_mfma_f32_32x32x16_bf16 v[112:127], v[172:175], v[20:23], v[112:127]
    v_exp_f32 v135, v135
    v_exp_f32 v136, v136
    v_exp_f32 v137, v137
    v_exp_f32 v138, v138
    v_cvt_pk_bf16_f32 v154, v132, v133
    v_cvt_pk_bf16_f32 v155, v134, v135
    v_cvt_pk_bf16_f32 v156, v136, v137
    v_mfma_f32_32x32x16_bf16 v[80:95], v[192:195], v[144:147], v[80:95]
    v_exp_f32 v139, v139
    v_exp_f32 v140, v140
    v_exp_f32 v141, v141
    v_exp_f32 v142, v142
    v_exp_f32 v143, v143
    v_cvt_pk_bf16_f32 v157, v138, v139
    v_cvt_pk_bf16_f32 v158, v140, v141
    v_mfma_f32_32x32x16_bf16 v[80:95], v[196:199], v[148:151], v[80:95]
    v_cvt_pk_bf16_f32 v159, v142, v143
    v_exp_f32 v112, v112
    v_exp_f32 v113, v113
    v_mfma_f32_32x32x16_bf16 v[128:143], v[168:171], v[24:27], 0
    v_exp_f32 v114, v114
    v_exp_f32 v115, v115
    v_exp_f32 v116, v116
    v_exp_f32 v117, v117
    v_exp_f32 v118, v118
    v_cvt_pk_bf16_f32 v144, v112, v113
    v_cvt_pk_bf16_f32 v145, v114, v115
    v_mfma_f32_32x32x16_bf16 v[128:143], v[172:175], v[28:31], v[128:143]
    v_exp_f32 v119, v119
    v_exp_f32 v120, v120
    v_exp_f32 v121, v121
    v_exp_f32 v122, v122
    v_cvt_pk_bf16_f32 v146, v116, v117
    v_cvt_pk_bf16_f32 v147, v118, v119
    v_cvt_pk_bf16_f32 v148, v120, v121
    v_mfma_f32_32x32x16_bf16 v[96:111], v[192:195], v[152:155], v[96:111]
    v_exp_f32 v123, v123
    v_exp_f32 v124, v124
    v_exp_f32 v125, v125
    v_exp_f32 v126, v126
    v_exp_f32 v127, v127
    v_cvt_pk_bf16_f32 v149, v122, v123
    v_cvt_pk_bf16_f32 v150, v124, v125
    v_mfma_f32_32x32x16_bf16 v[96:111], v[196:199], v[156:159], v[96:111]
    v_cvt_pk_bf16_f32 v151, v126, v127
    v_exp_f32 v128, v128
    v_exp_f32 v129, v129
    v_mfma_f32_32x32x16_bf16 v[112:127], v[168:171], v[32:35], 0
    v_exp_f32 v130, v130
    v_exp_f32 v131, v131
    v_exp_f32 v132, v132
    v_exp_f32 v133, v133
    v_exp_f32 v134, v134
    v_cvt_pk_bf16_f32 v152, v128, v129
    v_cvt_pk_bf16_f32 v153, v130, v131
    v_mfma_f32_32x32x16_bf16 v[112:127], v[172:175], v[36:39], v[112:127]
    v_exp_f32 v135, v135
    v_exp_f32 v136, v136
    v_exp_f32 v137, v137
    v_exp_f32 v138, v138
    v_cvt_pk_bf16_f32 v154, v132, v133
    v_cvt_pk_bf16_f32 v155, v134, v135
    v_cvt_pk_bf16_f32 v156, v136, v137
    v_mfma_f32_32x32x16_bf16 v[48:63], v[200:203], v[144:147], v[48:63]
    v_exp_f32 v139, v139
    v_exp_f32 v140, v140
    v_exp_f32 v141, v141
    v_exp_f32 v142, v142
    v_exp_f32 v143, v143
    v_cvt_pk_bf16_f32 v157, v138, v139
    v_cvt_pk_bf16_f32 v158, v140, v141
    v_mfma_f32_32x32x16_bf16 v[48:63], v[204:207], v[148:151], v[48:63]
    v_cvt_pk_bf16_f32 v159, v142, v143
    v_exp_f32 v112, v112
    v_exp_f32 v113, v113
    v_mfma_f32_32x32x16_bf16 v[128:143], v[168:171], v[40:43], 0
    s_add_u32 s30, s57, 53248
    buffer_load_dwordx4 a[208:211], v2, s[64:67], s30 offen offset:0
    buffer_load_dwordx4 a[212:215], v2, s[64:67], s30 offen offset:1024
    buffer_load_dwordx4 a[216:219], v2, s[64:67], s30 offen offset:2048
    buffer_load_dwordx4 a[220:223], v2, s[64:67], s30 offen offset:3072
    v_exp_f32 v114, v114
    v_exp_f32 v115, v115
    v_exp_f32 v116, v116
    v_exp_f32 v117, v117
    v_exp_f32 v118, v118
    v_cvt_pk_bf16_f32 v144, v112, v113
    v_cvt_pk_bf16_f32 v145, v114, v115
    v_mfma_f32_32x32x16_bf16 v[128:143], v[172:175], v[44:47], v[128:143]
    v_exp_f32 v119, v119
    v_exp_f32 v120, v120
    v_exp_f32 v121, v121
    v_exp_f32 v122, v122
    v_cvt_pk_bf16_f32 v146, v116, v117
    v_cvt_pk_bf16_f32 v147, v118, v119
    v_cvt_pk_bf16_f32 v148, v120, v121
    v_mfma_f32_32x32x16_bf16 v[64:79], v[200:203], v[152:155], v[64:79]
    v_exp_f32 v123, v123
    v_exp_f32 v124, v124
    v_exp_f32 v125, v125
    v_exp_f32 v126, v126
    v_exp_f32 v127, v127
    v_cvt_pk_bf16_f32 v149, v122, v123
    v_cvt_pk_bf16_f32 v150, v124, v125
    v_mfma_f32_32x32x16_bf16 v[64:79], v[204:207], v[156:159], v[64:79]
    v_cvt_pk_bf16_f32 v151, v126, v127
    s_waitcnt vmcnt(16)
    v_and_b32 v182, v3, v182
    v_and_b32 v183, v3, v183
    v_exp_f32 v128, v128
    v_exp_f32 v129, v129
    v_mfma_f32_32x32x16_bf16 v[112:127], v[176:179], v[16:19], 0
    v_exp_f32 v130, v130
    v_exp_f32 v131, v131
    v_exp_f32 v132, v132
    v_exp_f32 v133, v133
    v_exp_f32 v134, v134
    v_cvt_pk_bf16_f32 v152, v128, v129
    v_cvt_pk_bf16_f32 v153, v130, v131
    v_mfma_f32_32x32x16_bf16 v[112:127], v[180:183], v[20:23], v[112:127]
    v_exp_f32 v135, v135
    v_exp_f32 v136, v136
    v_exp_f32 v137, v137
    v_exp_f32 v138, v138
    v_cvt_pk_bf16_f32 v154, v132, v133
    v_cvt_pk_bf16_f32 v155, v134, v135
    v_cvt_pk_bf16_f32 v156, v136, v137
    v_mfma_f32_32x32x16_bf16 v[80:95], v[200:203], v[144:147], v[80:95]
    v_exp_f32 v139, v139
    v_exp_f32 v140, v140
    v_exp_f32 v141, v141
    v_exp_f32 v142, v142
    v_exp_f32 v143, v143
    v_cvt_pk_bf16_f32 v157, v138, v139
    v_cvt_pk_bf16_f32 v158, v140, v141
    v_mfma_f32_32x32x16_bf16 v[80:95], v[204:207], v[148:151], v[80:95]
    v_cvt_pk_bf16_f32 v159, v142, v143
    v_exp_f32 v112, v112
    v_exp_f32 v113, v113
    v_mfma_f32_32x32x16_bf16 v[128:143], v[176:179], v[24:27], 0
    v_exp_f32 v114, v114
    v_exp_f32 v115, v115
    v_exp_f32 v116, v116
    v_exp_f32 v117, v117
    v_exp_f32 v118, v118
    v_cvt_pk_bf16_f32 v144, v112, v113
    v_cvt_pk_bf16_f32 v145, v114, v115
    v_mfma_f32_32x32x16_bf16 v[128:143], v[180:183], v[28:31], v[128:143]
    v_exp_f32 v119, v119
    v_exp_f32 v120, v120
    v_exp_f32 v121, v121
    v_exp_f32 v122, v122
    v_cvt_pk_bf16_f32 v146, v116, v117
    v_cvt_pk_bf16_f32 v147, v118, v119
    v_cvt_pk_bf16_f32 v148, v120, v121
    v_mfma_f32_32x32x16_bf16 v[96:111], v[200:203], v[152:155], v[96:111]
    v_exp_f32 v123, v123
    v_exp_f32 v124, v124
    v_exp_f32 v125, v125
    v_exp_f32 v126, v126
    v_exp_f32 v127, v127
    v_cvt_pk_bf16_f32 v149, v122, v123
    v_cvt_pk_bf16_f32 v150, v124, v125
    v_mfma_f32_32x32x16_bf16 v[96:111], v[204:207], v[156:159], v[96:111]
    v_cvt_pk_bf16_f32 v151, v126, v127
    v_exp_f32 v128, v128
    v_exp_f32 v129, v129
    v_mfma_f32_32x32x16_bf16 v[112:127], v[176:179], v[32:35], 0
    v_exp_f32 v130, v130
    v_exp_f32 v131, v131
    v_exp_f32 v132, v132
    v_exp_f32 v133, v133
    v_exp_f32 v134, v134
    v_cvt_pk_bf16_f32 v152, v128, v129
    v_cvt_pk_bf16_f32 v153, v130, v131
    v_mfma_f32_32x32x16_bf16 v[112:127], v[180:183], v[36:39], v[112:127]
    v_exp_f32 v135, v135
    v_exp_f32 v136, v136
    v_exp_f32 v137, v137
    v_exp_f32 v138, v138
    v_cvt_pk_bf16_f32 v154, v132, v133
    v_cvt_pk_bf16_f32 v155, v134, v135
    v_cvt_pk_bf16_f32 v156, v136, v137
    v_mfma_f32_32x32x16_bf16 v[48:63], v[208:211], v[144:147], v[48:63]
    v_exp_f32 v139, v139
    v_exp_f32 v140, v140
    v_exp_f32 v141, v141
    v_exp_f32 v142, v142
    v_exp_f32 v143, v143
    v_cvt_pk_bf16_f32 v157, v138, v139
    v_cvt_pk_bf16_f32 v158, v140, v141
    v_mfma_f32_32x32x16_bf16 v[48:63], v[212:215], v[148:151], v[48:63]
    v_cvt_pk_bf16_f32 v159, v142, v143
    v_exp_f32 v112, v112
    v_exp_f32 v113, v113
    v_mfma_f32_32x32x16_bf16 v[128:143], v[176:179], v[40:43], 0
    v_exp_f32 v114, v114
    v_exp_f32 v115, v115
    v_exp_f32 v116, v116
    v_exp_f32 v117, v117
    v_exp_f32 v118, v118
    v_cvt_pk_bf16_f32 v144, v112, v113
    v_cvt_pk_bf16_f32 v145, v114, v115
    v_mfma_f32_32x32x16_bf16 v[128:143], v[180:183], v[44:47], v[128:143]
    v_exp_f32 v119, v119
    v_exp_f32 v120, v120
    v_exp_f32 v121, v121
    v_exp_f32 v122, v122
    v_cvt_pk_bf16_f32 v146, v116, v117
    v_cvt_pk_bf16_f32 v147, v118, v119
    v_cvt_pk_bf16_f32 v148, v120, v121
    v_mfma_f32_32x32x16_bf16 v[64:79], v[208:211], v[152:155], v[64:79]
    v_exp_f32 v123, v123
    v_exp_f32 v124, v124
    v_exp_f32 v125, v125
    v_exp_f32 v126, v126
    v_exp_f32 v127, v127
    v_cvt_pk_bf16_f32 v149, v122, v123
    v_cvt_pk_bf16_f32 v150, v124, v125
    v_mfma_f32_32x32x16_bf16 v[64:79], v[212:215], v[156:159], v[64:79]
    v_cvt_pk_bf16_f32 v151, v126, v127
    s_waitcnt vmcnt(8)
    v_and_b32 v190, v3, v190
    v_and_b32 v191, v3, v191
    v_exp_f32 v128, v128
    v_exp_f32 v129, v129
    v_mfma_f32_32x32x16_bf16 v[112:127], v[184:187], v[16:19], 0
    v_exp_f32 v130, v130
    v_exp_f32 v131, v131
    v_exp_f32 v132, v132
    v_exp_f32 v133, v133
    v_exp_f32 v134, v134
    v_cvt_pk_bf16_f32 v152, v128, v129
    v_cvt_pk_bf16_f32 v153, v130, v131
    v_mfma_f32_32x32x16_bf16 v[112:127], v[188:191], v[20:23], v[112:127]
    v_exp_f32 v135, v135
    v_exp_f32 v136, v136
    v_exp_f32 v137, v137
    v_exp_f32 v138, v138
    v_cvt_pk_bf16_f32 v154, v132, v133
    v_cvt_pk_bf16_f32 v155, v134, v135
    v_cvt_pk_bf16_f32 v156, v136, v137
    v_mfma_f32_32x32x16_bf16 v[80:95], v[208:211], v[144:147], v[80:95]
    v_exp_f32 v139, v139
    v_exp_f32 v140, v140
    v_exp_f32 v141, v141
    v_exp_f32 v142, v142
    v_exp_f32 v143, v143
    v_cvt_pk_bf16_f32 v157, v138, v139
    v_cvt_pk_bf16_f32 v158, v140, v141
    v_mfma_f32_32x32x16_bf16 v[80:95], v[212:215], v[148:151], v[80:95]
    v_cvt_pk_bf16_f32 v159, v142, v143
    v_exp_f32 v112, v112
    v_exp_f32 v113, v113
    v_mfma_f32_32x32x16_bf16 v[128:143], v[184:187], v[24:27], 0
    v_exp_f32 v114, v114
    v_exp_f32 v115, v115
    v_exp_f32 v116, v116
    v_exp_f32 v117, v117
    v_exp_f32 v118, v118
    v_cvt_pk_bf16_f32 v144, v112, v113
    v_cvt_pk_bf16_f32 v145, v114, v115
    v_mfma_f32_32x32x16_bf16 v[128:143], v[188:191], v[28:31], v[128:143]
    v_exp_f32 v119, v119
    v_exp_f32 v120, v120
    v_exp_f32 v121, v121
    v_exp_f32 v122, v122
    v_cvt_pk_bf16_f32 v146, v116, v117
    v_cvt_pk_bf16_f32 v147, v118, v119
    v_cvt_pk_bf16_f32 v148, v120, v121
    v_mfma_f32_32x32x16_bf16 v[96:111], v[208:211], v[152:155], v[96:111]
    v_exp_f32 v123, v123
    v_exp_f32 v124, v124
    v_exp_f32 v125, v125
    v_exp_f32 v126, v126
    v_exp_f32 v127, v127
    v_cvt_pk_bf16_f32 v149, v122, v123
    v_cvt_pk_bf16_f32 v150, v124, v125
    v_mfma_f32_32x32x16_bf16 v[96:111], v[212:215], v[156:159], v[96:111]
    v_cvt_pk_bf16_f32 v151, v126, v127
    v_exp_f32 v128, v128
    v_exp_f32 v129, v129
    v_mfma_f32_32x32x16_bf16 v[112:127], v[184:187], v[32:35], 0
    v_exp_f32 v130, v130
    v_exp_f32 v131, v131
    v_exp_f32 v132, v132
    v_exp_f32 v133, v133
    v_exp_f32 v134, v134
    v_cvt_pk_bf16_f32 v152, v128, v129
    v_cvt_pk_bf16_f32 v153, v130, v131
    v_mfma_f32_32x32x16_bf16 v[112:127], v[188:191], v[36:39], v[112:127]
    v_exp_f32 v135, v135
    v_exp_f32 v136, v136
    v_exp_f32 v137, v137
    v_exp_f32 v138, v138
    v_cvt_pk_bf16_f32 v154, v132, v133
    v_cvt_pk_bf16_f32 v155, v134, v135
    v_cvt_pk_bf16_f32 v156, v136, v137
    v_mfma_f32_32x32x16_bf16 v[48:63], v[216:219], v[144:147], v[48:63]
    v_exp_f32 v139, v139
    v_exp_f32 v140, v140
    v_exp_f32 v141, v141
    v_exp_f32 v142, v142
    v_exp_f32 v143, v143
    v_cvt_pk_bf16_f32 v157, v138, v139
    v_cvt_pk_bf16_f32 v158, v140, v141
    v_mfma_f32_32x32x16_bf16 v[48:63], v[220:223], v[148:151], v[48:63]
    v_cvt_pk_bf16_f32 v159, v142, v143
    v_exp_f32 v112, v112
    v_exp_f32 v113, v113
    v_mfma_f32_32x32x16_bf16 v[128:143], v[184:187], v[40:43], 0
    v_exp_f32 v114, v114
    v_exp_f32 v115, v115
    v_exp_f32 v116, v116
    v_exp_f32 v117, v117
    v_exp_f32 v118, v118
    v_cvt_pk_bf16_f32 v144, v112, v113
    v_cvt_pk_bf16_f32 v145, v114, v115
    v_mfma_f32_32x32x16_bf16 v[128:143], v[188:191], v[44:47], v[128:143]
    v_exp_f32 v119, v119
    v_exp_f32 v120, v120
    v_exp_f32 v121, v121
    v_exp_f32 v122, v122
    v_cvt_pk_bf16_f32 v146, v116, v117
    v_cvt_pk_bf16_f32 v147, v118, v119
    v_cvt_pk_bf16_f32 v148, v120, v121
    v_mfma_f32_32x32x16_bf16 v[64:79], v[216:219], v[152:155], v[64:79]
    v_exp_f32 v123, v123
    v_exp_f32 v124, v124
    v_exp_f32 v125, v125
    v_exp_f32 v126, v126
    v_exp_f32 v127, v127
    v_cvt_pk_bf16_f32 v149, v122, v123
    v_cvt_pk_bf16_f32 v150, v124, v125
    v_mfma_f32_32x32x16_bf16 v[64:79], v[220:223], v[156:159], v[64:79]
    v_cvt_pk_bf16_f32 v151, v126, v127
    v_exp_f32 v128, v128
    v_exp_f32 v129, v129
    s_nop 0
    v_exp_f32 v130, v130
    v_exp_f32 v131, v131
    v_exp_f32 v132, v132
    v_exp_f32 v133, v133
    v_exp_f32 v134, v134
    v_cvt_pk_bf16_f32 v152, v128, v129
    v_cvt_pk_bf16_f32 v153, v130, v131
    s_nop 0
    v_exp_f32 v135, v135
    v_exp_f32 v136, v136
    v_exp_f32 v137, v137
    v_exp_f32 v138, v138
    v_cvt_pk_bf16_f32 v154, v132, v133
    v_cvt_pk_bf16_f32 v155, v134, v135
    v_cvt_pk_bf16_f32 v156, v136, v137
    v_mfma_f32_32x32x16_bf16 v[80:95], v[216:219], v[144:147], v[80:95]
    v_exp_f32 v139, v139
    v_exp_f32 v140, v140
    v_exp_f32 v141, v141
    v_exp_f32 v142, v142
    v_exp_f32 v143, v143
    v_cvt_pk_bf16_f32 v157, v138, v139
    v_cvt_pk_bf16_f32 v158, v140, v141
    v_mfma_f32_32x32x16_bf16 v[80:95], v[220:223], v[148:151], v[80:95]
    v_cvt_pk_bf16_f32 v159, v142, v143
    s_nop 1
    v_mfma_f32_32x32x16_bf16 v[96:111], v[216:219], v[152:155], v[96:111]
    v_mfma_f32_32x32x16_bf16 v[96:111], v[220:223], v[156:159], v[96:111]
k2_attn_kernel_comb:
    v_lshrrev_b32 v4, 5, v0
    v_and_b32 v5, 31, v0
    v_lshlrev_b32 v4, 11, v4
    v_lshl_add_u32 v4, v5, 4, v4
    s_lshl_b32 s45, s33, 14
    v_add_u32 v4, s45, v4
    s_nop 7
    s_nop 7
    ds_write_b128 v4, v[48:51] offset:0
    ds_write_b128 v4, v[52:55] offset:4096
    ds_write_b128 v4, v[56:59] offset:8192
    ds_write_b128 v4, v[60:63] offset:12288
    ds_write_b128 v4, v[64:67] offset:512
    ds_write_b128 v4, v[68:71] offset:4608
    ds_write_b128 v4, v[72:75] offset:8704
    ds_write_b128 v4, v[76:79] offset:12800
    ds_write_b128 v4, v[80:83] offset:1024
    ds_write_b128 v4, v[84:87] offset:5120
    ds_write_b128 v4, v[88:91] offset:9216
    ds_write_b128 v4, v[92:95] offset:13312
    ds_write_b128 v4, v[96:99] offset:1536
    ds_write_b128 v4, v[100:103] offset:5632
    ds_write_b128 v4, v[104:107] offset:9728
    ds_write_b128 v4, v[108:111] offset:13824
    v_and_b32 v5, 127, v15
    v_lshlrev_b32 v6, 4, v5
    v_xor_b32 v7, 1024, v6
    v_add_u32 v12, 0x10000, v6
    v_add_u32 v13, 0x10000, v7
    s_waitcnt lgkmcnt(0)
    s_barrier
    ds_read_b32 v112, v6 offset:14336
    ds_read_b32 v113, v6 offset:30720
    ds_read_b32 v114, v6 offset:47104
    ds_read_b32 v115, v6 offset:63488
    ds_read_b32 v128, v7 offset:14336
    ds_read_b32 v129, v7 offset:30720
    ds_read_b32 v130, v7 offset:47104
    ds_read_b32 v131, v7 offset:63488
    s_lshr_b32 s46, s33, 1
    s_lshl_b32 s45, s46, 11
    v_add_u32 v6, s45, v6
    v_add_u32 v12, s45, v12
    s_waitcnt lgkmcnt(0)
    ds_read_b128 v[160:163], v6 offset:0
    ds_read_b128 v[164:167], v6 offset:16384
    ds_read_b128 v[168:171], v6 offset:32768
    ds_read_b128 v[172:175], v6 offset:49152
    ds_read_b128 v[176:179], v6 offset:4096
    ds_read_b128 v[180:183], v6 offset:20480
    ds_read_b128 v[184:187], v6 offset:36864
    ds_read_b128 v[188:191], v6 offset:53248
    ds_read_b128 v[192:195], v6 offset:8192
    ds_read_b128 v[196:199], v6 offset:24576
    ds_read_b128 v[200:203], v6 offset:40960
    ds_read_b128 v[204:207], v6 offset:57344
    ds_read_b128 v[208:211], v6 offset:12288
    ds_read_b128 v[212:215], v6 offset:28672
    ds_read_b128 v[216:219], v6 offset:45056
    ds_read_b128 v[220:223], v6 offset:61440
    v_add_f32 v112, v112, v113
    v_add_f32 v128, v128, v129
    v_add_f32 v112, v112, v114
    v_add_f32 v128, v128, v130
    v_add_f32 v112, v112, v115
    v_add_f32 v128, v128, v131
    v_mov_b32 v8, v112
    v_mov_b32 v112, v128
    s_cmp_lg_u32 s47, 0
    s_cbranch_scc1 k2_attn_kernel_ok
    v_mov_b32 v9, 0x21800000
    v_mov_b32 v10, 0x5d800000
    v_cmp_ge_f32 s[48:49], v8, v9
    v_cmp_le_f32 s[50:51], v8, v10
    v_cmp_ge_f32 s[52:53], v112, v9
    v_cmp_le_f32 s[54:55], v112, v10
    s_and_b64 s[48:49], s[48:49], s[50:51]
    s_and_b64 s[52:53], s[52:53], s[54:55]
    s_and_b64 s[48:49], s[48:49], s[52:53]
    s_cmp_eq_u64 s[48:49], -1
    s_cbranch_scc0 k2_attn_kernel_slow
k2_attn_kernel_ok:
    v_rcp_f32 v8, v8
    v_lshrrev_b32 v9, 4, v5
    v_mul_u32_u24 v9, 14336, v9
    v_and_b32 v10, 15, v5
    v_lshl_add_u32 v9, v10, 4, v9
    s_mul_i32 s48, s32, 114688
    s_mul_i32 s49, s31, 7
    s_add_u32 s49, s49, s46
    s_waitcnt lgkmcnt(0)
    v_pk_add_f32 v[160:161], v[160:161], v[164:165]
    v_pk_add_f32 v[162:163], v[162:163], v[166:167]
    v_pk_add_f32 v[160:161], v[160:161], v[168:169]
    v_pk_add_f32 v[162:163], v[162:163], v[170:171]
    v_pk_add_f32 v[160:161], v[160:161], v[172:173]
    v_pk_add_f32 v[162:163], v[162:163], v[174:175]
    v_mul_f32 v160, v8, v160
    v_mul_f32 v161, v8, v161
    v_mul_f32 v162, v8, v162
    v_mul_f32 v163, v8, v163
    v_cvt_pk_bf16_f32 v164, v160, v161
    v_cvt_pk_bf16_f32 v165, v162, v163
    s_lshr_b32 s50, s49, 3
    s_lshl_b32 s50, s50, 10
    s_bfe_u32 s51, s49, 0x20001
    s_lshl_b32 s51, s51, 8
    s_and_b32 s52, s49, 1
    s_lshl_b32 s52, s52, 3
    s_add_u32 s50, s50, s51
    s_add_u32 s50, s50, s52
    s_add_u32 s50, s50, s48
    buffer_store_dwordx2 v[164:165], v9, s[24:27], s50 offen sc1
    s_add_u32 s49, s49, 2
    v_pk_add_f32 v[176:177], v[176:177], v[180:181]
    v_pk_add_f32 v[178:179], v[178:179], v[182:183]
    v_pk_add_f32 v[176:177], v[176:177], v[184:185]
    v_pk_add_f32 v[178:179], v[178:179], v[186:187]
    v_pk_add_f32 v[176:177], v[176:177], v[188:189]
    v_pk_add_f32 v[178:179], v[178:179], v[190:191]
    v_mul_f32 v176, v8, v176
    v_mul_f32 v177, v8, v177
    v_mul_f32 v178, v8, v178
    v_mul_f32 v179, v8, v179
    v_cvt_pk_bf16_f32 v180, v176, v177
    v_cvt_pk_bf16_f32 v181, v178, v179
    s_lshr_b32 s50, s49, 3
    s_lshl_b32 s50, s50, 10
    s_bfe_u32 s51, s49, 0x20001
    s_lshl_b32 s51, s51, 8
    s_and_b32 s52, s49, 1
    s_lshl_b32 s52, s52, 3
    s_add_u32 s50, s50, s51
    s_add_u32 s50, s50, s52
    s_add_u32 s50, s50, s48
    buffer_store_dwordx2 v[180:181], v9, s[24:27], s50 offen sc1
    s_add_u32 s49, s49, 2
    v_pk_add_f32 v[192:193], v[192:193], v[196:197]
    v_pk_add_f32 v[194:195], v[194:195], v[198:199]
    v_pk_add_f32 v[192:193], v[192:193], v[200:201]
    v_pk_add_f32 v[194:195], v[194:195], v[202:203]
    v_pk_add_f32 v[192:193], v[192:193], v[204:205]
    v_pk_add_f32 v[194:195], v[194:195], v[206:207]
    v_mul_f32 v192, v8, v192
    v_mul_f32 v193, v8, v193
    v_mul_f32 v194, v8, v194
    v_mul_f32 v195, v8, v195
    v_cvt_pk_bf16_f32 v196, v192, v193
    v_cvt_pk_bf16_f32 v197, v194, v195
    s_lshr_b32 s50, s49, 3
    s_lshl_b32 s50, s50, 10
    s_bfe_u32 s51, s49, 0x20001
    s_lshl_b32 s51, s51, 8
    s_and_b32 s52, s49, 1
    s_lshl_b32 s52, s52, 3
    s_add_u32 s50, s50, s51
    s_add_u32 s50, s50, s52
    s_add_u32 s50, s50, s48
    buffer_store_dwordx2 v[196:197], v9, s[24:27], s50 offen sc1
    s_add_u32 s49, s49, 2
    s_cmp_eq_u32 s46, 1
    s_cbranch_scc1 k2_attn_kernel_pub
    v_pk_add_f32 v[208:209], v[208:209], v[212:213]
    v_pk_add_f32 v[210:211], v[210:211], v[214:215]
    v_pk_add_f32 v[208:209], v[208:209], v[216:217]
    v_pk_add_f32 v[210:211], v[210:211], v[218:219]
    v_pk_add_f32 v[208:209], v[208:209], v[220:221]
    v_pk_add_f32 v[210:211], v[210:211], v[222:223]
    v_mul_f32 v208, v8, v208
    v_mul_f32 v209, v8, v209
    v_mul_f32 v210, v8, v210
    v_mul_f32 v211, v8, v211
    v_cvt_pk_bf16_f32 v212, v208, v209
    v_cvt_pk_bf16_f32 v213, v210, v211
    s_lshr_b32 s50, s49, 3
    s_lshl_b32 s50, s50, 10
    s_bfe_u32 s51, s49, 0x20001
    s_lshl_b32 s51, s51, 8
    s_and_b32 s52, s49, 1
    s_lshl_b32 s52, s52, 3
    s_add_u32 s50, s50, s51
    s_add_u32 s50, s50, s52
    s_add_u32 s50, s50, s48
    buffer_store_dwordx2 v[212:213], v9, s[24:27], s50 offen sc1
    s_add_u32 s49, s49, 2
    s_branch k2_attn_kernel_pub
k2_attn_kernel_slow:
    s_waitcnt lgkmcnt(0) vmcnt(0)
    s_barrier
    s_mov_b32 s47, 1
    s_mov_b32 s41, s40
    s_mov_b32 s44, 0
    v_mov_b32 v48, 0
    v_mov_b32 v49, 0
    v_mov_b32 v50, 0
    v_mov_b32 v51, 0
    v_mov_b32 v52, 0
    v_mov_b32 v53, 0
    v_mov_b32 v54, 0
    v_mov_b32 v55, 0
    v_mov_b32 v56, 0
    v_mov_b32 v57, 0
    v_mov_b32 v58, 0
    v_mov_b32 v59, 0
    v_mov_b32 v60, 0
    v_mov_b32 v61, 0
    v_mov_b32 v62, 0
    v_mov_b32 v63, 0
    v_mov_b32 v64, 0
    v_mov_b32 v65, 0
    v_mov_b32 v66, 0
    v_mov_b32 v67, 0
    v_mov_b32 v68, 0
    v_mov_b32 v69, 0
    v_mov_b32 v70, 0
    v_mov_b32 v71, 0
    v_mov_b32 v72, 0
    v_mov_b32 v73, 0
    v_mov_b32 v74, 0
    v_mov_b32 v75, 0
    v_mov_b32 v76, 0
    v_mov_b32 v77, 0
    v_mov_b32 v78, 0
    v_mov_b32 v79, 0
    v_mov_b32 v80, 0
    v_mov_b32 v81, 0
    v_mov_b32 v82, 0
    v_mov_b32 v83, 0
    v_mov_b32 v84, 0
    v_mov_b32 v85, 0
    v_mov_b32 v86, 0
    v_mov_b32 v87, 0
    v_mov_b32 v88, 0
    v_mov_b32 v89, 0
    v_mov_b32 v90, 0
    v_mov_b32 v91, 0
    v_mov_b32 v92, 0
    v_mov_b32 v93, 0
    v_mov_b32 v94, 0
    v_mov_b32 v95, 0
    v_mov_b32 v96, 0
    v_mov_b32 v97, 0
    v_mov_b32 v98, 0
    v_mov_b32 v99, 0
    v_mov_b32 v100, 0
    v_mov_b32 v101, 0
    v_mov_b32 v102, 0
    v_mov_b32 v103, 0
    v_mov_b32 v104, 0
    v_mov_b32 v105, 0
    v_mov_b32 v106, 0
    v_mov_b32 v107, 0
    v_mov_b32 v108, 0
    v_mov_b32 v109, 0
    v_mov_b32 v110, 0
    v_mov_b32 v111, 0
    v_mov_b32 v192, 0x3f803f80
    v_mov_b32 v193, 0x3f803f80
    v_mov_b32 v194, 0x3f803f80
    v_mov_b32 v195, 0x3f803f80
    v_mov_b32 v196, 0x3f803f80
    v_mov_b32 v197, 0x3f803f80
    v_mov_b32 v198, 0x3f803f80
    v_mov_b32 v199, 0x3f803f80
    v_mov_b32 v200, 0x3f803f80
    v_mov_b32 v201, 0x3f803f80
    v_mov_b32 v202, 0x3f803f80
    v_mov_b32 v203, 0x3f803f80
    v_mov_b32 v204, 0x3f803f80
    v_mov_b32 v205, 0x3f803f80
    v_mov_b32 v206, 0x3f803f80
    v_mov_b32 v207, 0x3f803f80
    v_mov_b32 v208, 0x3f803f80
    v_mov_b32 v209, 0x3f803f80
    v_mov_b32 v210, 0x3f803f80
    v_mov_b32 v211, 0x3f803f80
    v_mov_b32 v212, 0x3f803f80
    v_mov_b32 v213, 0x3f803f80
    v_mov_b32 v214, 0x3f803f80
    v_mov_b32 v215, 0x3f803f80
    v_mov_b32 v216, 0x3f803f80
    v_mov_b32 v217, 0x3f803f80
    v_mov_b32 v218, 0x3f803f80
    v_mov_b32 v219, 0x3f803f80
    v_mov_b32 v220, 0x3f803f80
    v_mov_b32 v221, 0x3f803f80
    v_mov_b32 v222, 0x3f803f80
    v_mov_b32 v223, 0x3f803f80
    v_mov_b32 v224, 0xff61b1e6
    v_mov_b32 v225, 0xff61b1e6
    v_mov_b32 v226, 0xff61b1e6
    v_mov_b32 v227, 0xff61b1e6
k2_attn_kernel_sloop:
    buffer_load_dwordx4 v[160:163], v2, s[16:19], s41 offen
    buffer_load_dwordx4 v[164:167], v2, s[16:19], s41 offen offset:1024
    s_mov_b64 exec, s[42:43]
    buffer_load_dwordx4 v[192:195], v2, s[20:23], s41 offen
    buffer_load_dwordx4 v[196:199], v2, s[20:23], s41 offen offset:1024
    s_mov_b64 exec, -1
    s_add_u32 s41, s41, 2048
    s_waitcnt vmcnt(0)
    v_and_b32 v166, v3, v166
    v_and_b32 v167, v3, v167
    s_nop 1
    v_mfma_f32_32x32x16_bf16 v[112:127], v[160:163], v[16:19], 0
    v_mfma_f32_32x32x16_bf16 v[112:127], v[164:167], v[20:23], v[112:127]
    s_nop 7
    s_nop 7
    v_max_f32 v4, v112, v113
    v_max3_f32 v4, v4, v114, v115
    v_max3_f32 v4, v4, v116, v117
    v_max3_f32 v4, v4, v118, v119
    v_max3_f32 v4, v4, v120, v121
    v_max3_f32 v4, v4, v122, v123
    v_max3_f32 v4, v4, v124, v125
    v_max3_f32 v4, v4, v126, v127
    v_mov_b32 v5, v4
    s_nop 1
    v_permlane32_swap_b32 v5, v4
    s_nop 1
    v_max3_f32 v4, v4, v5, v224
    v_sub_f32 v5, v224, v4
    v_exp_f32 v5, v5
    v_mov_b32 v224, v4
    v_mul_f32 v48, v5, v48
    v_mul_f32 v49, v5, v49
    v_mul_f32 v50, v5, v50
    v_mul_f32 v51, v5, v51
    v_mul_f32 v52, v5, v52
    v_mul_f32 v53, v5, v53
    v_mul_f32 v54, v5, v54
    v_mul_f32 v55, v5, v55
    v_mul_f32 v56, v5, v56
    v_mul_f32 v57, v5, v57
    v_mul_f32 v58, v5, v58
    v_mul_f32 v59, v5, v59
    v_mul_f32 v60, v5, v60
    v_mul_f32 v61, v5, v61
    v_mul_f32 v62, v5, v62
    v_mul_f32 v63, v5, v63
    v_sub_f32 v112, v112, v4
    v_sub_f32 v113, v113, v4
    v_sub_f32 v114, v114, v4
    v_sub_f32 v115, v115, v4
    v_sub_f32 v116, v116, v4
    v_sub_f32 v117, v117, v4
    v_sub_f32 v118, v118, v4
    v_sub_f32 v119, v119, v4
    v_sub_f32 v120, v120, v4
    v_sub_f32 v121, v121, v4
    v_sub_f32 v122, v122, v4
    v_sub_f32 v123, v123, v4
    v_sub_f32 v124, v124, v4
    v_sub_f32 v125, v125, v4
    v_sub_f32 v126, v126, v4
    v_sub_f32 v127, v127, v4
    v_exp_f32 v112, v112
    v_exp_f32 v113, v113
    v_exp_f32 v114, v114
    v_exp_f32 v115, v115
    v_exp_f32 v116, v116
    v_exp_f32 v117, v117
    v_exp_f32 v118, v118
    v_exp_f32 v119, v119
    v_exp_f32 v120, v120
    v_exp_f32 v121, v121
    v_exp_f32 v122, v122
    v_exp_f32 v123, v123
    v_exp_f32 v124, v124
    v_exp_f32 v125, v125
    v_exp_f32 v126, v126
    v_exp_f32 v127, v127
    s_nop 0
    v_cvt_pk_bf16_f32 v144, v112, v113
    v_cvt_pk_bf16_f32 v145, v114, v115
    v_cvt_pk_bf16_f32 v146, v116, v117
    v_cvt_pk_bf16_f32 v147, v118, v119
    v_cvt_pk_bf16_f32 v148, v120, v121
    v_cvt_pk_bf16_f32 v149, v122, v123
    v_cvt_pk_bf16_f32 v150, v124, v125
    v_cvt_pk_bf16_f32 v151, v126, v127
    s_nop 1
    v_mfma_f32_32x32x16_bf16 v[48:63], v[192:195], v[144:147], v[48:63]
    v_mfma_f32_32x32x16_bf16 v[48:63], v[196:199], v[148:151], v[48:63]
    s_nop 7
    s_nop 7
    s_nop 1
    v_mfma_f32_32x32x16_bf16 v[112:127], v[160:163], v[24:27], 0
    v_mfma_f32_32x32x16_bf16 v[112:127], v[164:167], v[28:31], v[112:127]
    s_nop 7
    s_nop 7
    v_max_f32 v4, v112, v113
    v_max3_f32 v4, v4, v114, v115
    v_max3_f32 v4, v4, v116, v117
    v_max3_f32 v4, v4, v118, v119
    v_max3_f32 v4, v4, v120, v121
    v_max3_f32 v4, v4, v122, v123
    v_max3_f32 v4, v4, v124, v125
    v_max3_f32 v4, v4, v126, v127
    v_mov_b32 v5, v4
    s_nop 1
    v_permlane32_swap_b32 v5, v4
    s_nop 1
    v_max3_f32 v4, v4, v5, v225
    v_sub_f32 v5, v225, v4
    v_exp_f32 v5, v5
    v_mov_b32 v225, v4
    v_mul_f32 v64, v5, v64
    v_mul_f32 v65, v5, v65
    v_mul_f32 v66, v5, v66
    v_mul_f32 v67, v5, v67
    v_mul_f32 v68, v5, v68
    v_mul_f32 v69, v5, v69
    v_mul_f32 v70, v5, v70
    v_mul_f32 v71, v5, v71
    v_mul_f32 v72, v5, v72
    v_mul_f32 v73, v5, v73
    v_mul_f32 v74, v5, v74
    v_mul_f32 v75, v5, v75
    v_mul_f32 v76, v5, v76
    v_mul_f32 v77, v5, v77
    v_mul_f32 v78, v5, v78
    v_mul_f32 v79, v5, v79
    v_sub_f32 v112, v112, v4
    v_sub_f32 v113, v113, v4
    v_sub_f32 v114, v114, v4
    v_sub_f32 v115, v115, v4
    v_sub_f32 v116, v116, v4
    v_sub_f32 v117, v117, v4
    v_sub_f32 v118, v118, v4
    v_sub_f32 v119, v119, v4
    v_sub_f32 v120, v120, v4
    v_sub_f32 v121, v121, v4
    v_sub_f32 v122, v122, v4
    v_sub_f32 v123, v123, v4
    v_sub_f32 v124, v124, v4
    v_sub_f32 v125, v125, v4
    v_sub_f32 v126, v126, v4
    v_sub_f32 v127, v127, v4
    v_exp_f32 v112, v112
    v_exp_f32 v113, v113
    v_exp_f32 v114, v114
    v_exp_f32 v115, v115
    v_exp_f32 v116, v116
    v_exp_f32 v117, v117
    v_exp_f32 v118, v118
    v_exp_f32 v119, v119
    v_exp_f32 v120, v120
    v_exp_f32 v121, v121
    v_exp_f32 v122, v122
    v_exp_f32 v123, v123
    v_exp_f32 v124, v124
    v_exp_f32 v125, v125
    v_exp_f32 v126, v126
    v_exp_f32 v127, v127
    s_nop 0
    v_cvt_pk_bf16_f32 v144, v112, v113
    v_cvt_pk_bf16_f32 v145, v114, v115
    v_cvt_pk_bf16_f32 v146, v116, v117
    v_cvt_pk_bf16_f32 v147, v118, v119
    v_cvt_pk_bf16_f32 v148, v120, v121
    v_cvt_pk_bf16_f32 v149, v122, v123
    v_cvt_pk_bf16_f32 v150, v124, v125
    v_cvt_pk_bf16_f32 v151, v126, v127
    s_nop 1
    v_mfma_f32_32x32x16_bf16 v[64:79], v[192:195], v[144:147], v[64:79]
    v_mfma_f32_32x32x16_bf16 v[64:79], v[196:199], v[148:151], v[64:79]
    s_nop 7
    s_nop 7
    s_nop 1
    v_mfma_f32_32x32x16_bf16 v[112:127], v[160:163], v[32:35], 0
    v_mfma_f32_32x32x16_bf16 v[112:127], v[164:167], v[36:39], v[112:127]
    s_nop 7
    s_nop 7
    v_max_f32 v4, v112, v113
    v_max3_f32 v4, v4, v114, v115
    v_max3_f32 v4, v4, v116, v117
    v_max3_f32 v4, v4, v118, v119
    v_max3_f32 v4, v4, v120, v121
    v_max3_f32 v4, v4, v122, v123
    v_max3_f32 v4, v4, v124, v125
    v_max3_f32 v4, v4, v126, v127
    v_mov_b32 v5, v4
    s_nop 1
    v_permlane32_swap_b32 v5, v4
    s_nop 1
    v_max3_f32 v4, v4, v5, v226
    v_sub_f32 v5, v226, v4
    v_exp_f32 v5, v5
    v_mov_b32 v226, v4
    v_mul_f32 v80, v5, v80
    v_mul_f32 v81, v5, v81
    v_mul_f32 v82, v5, v82
    v_mul_f32 v83, v5, v83
    v_mul_f32 v84, v5, v84
    v_mul_f32 v85, v5, v85
    v_mul_f32 v86, v5, v86
    v_mul_f32 v87, v5, v87
    v_mul_f32 v88, v5, v88
    v_mul_f32 v89, v5, v89
    v_mul_f32 v90, v5, v90
    v_mul_f32 v91, v5, v91
    v_mul_f32 v92, v5, v92
    v_mul_f32 v93, v5, v93
    v_mul_f32 v94, v5, v94
    v_mul_f32 v95, v5, v95
    v_sub_f32 v112, v112, v4
    v_sub_f32 v113, v113, v4
    v_sub_f32 v114, v114, v4
    v_sub_f32 v115, v115, v4
    v_sub_f32 v116, v116, v4
    v_sub_f32 v117, v117, v4
    v_sub_f32 v118, v118, v4
    v_sub_f32 v119, v119, v4
    v_sub_f32 v120, v120, v4
    v_sub_f32 v121, v121, v4
    v_sub_f32 v122, v122, v4
    v_sub_f32 v123, v123, v4
    v_sub_f32 v124, v124, v4
    v_sub_f32 v125, v125, v4
    v_sub_f32 v126, v126, v4
    v_sub_f32 v127, v127, v4
    v_exp_f32 v112, v112
    v_exp_f32 v113, v113
    v_exp_f32 v114, v114
    v_exp_f32 v115, v115
    v_exp_f32 v116, v116
    v_exp_f32 v117, v117
    v_exp_f32 v118, v118
    v_exp_f32 v119, v119
    v_exp_f32 v120, v120
    v_exp_f32 v121, v121
    v_exp_f32 v122, v122
    v_exp_f32 v123, v123
    v_exp_f32 v124, v124
    v_exp_f32 v125, v125
    v_exp_f32 v126, v126
    v_exp_f32 v127, v127
    s_nop 0
    v_cvt_pk_bf16_f32 v144, v112, v113
    v_cvt_pk_bf16_f32 v145, v114, v115
    v_cvt_pk_bf16_f32 v146, v116, v117
    v_cvt_pk_bf16_f32 v147, v118, v119
    v_cvt_pk_bf16_f32 v148, v120, v121
    v_cvt_pk_bf16_f32 v149, v122, v123
    v_cvt_pk_bf16_f32 v150, v124, v125
    v_cvt_pk_bf16_f32 v151, v126, v127
    s_nop 1
    v_mfma_f32_32x32x16_bf16 v[80:95], v[192:195], v[144:147], v[80:95]
    v_mfma_f32_32x32x16_bf16 v[80:95], v[196:199], v[148:151], v[80:95]
    s_nop 7
    s_nop 7
    s_nop 1
    v_mfma_f32_32x32x16_bf16 v[112:127], v[160:163], v[40:43], 0
    v_mfma_f32_32x32x16_bf16 v[112:127], v[164:167], v[44:47], v[112:127]
    s_nop 7
    s_nop 7
    v_max_f32 v4, v112, v113
    v_max3_f32 v4, v4, v114, v115
    v_max3_f32 v4, v4, v116, v117
    v_max3_f32 v4, v4, v118, v119
    v_max3_f32 v4, v4, v120, v121
    v_max3_f32 v4, v4, v122, v123
    v_max3_f32 v4, v4, v124, v125
    v_max3_f32 v4, v4, v126, v127
    v_mov_b32 v5, v4
    s_nop 1
    v_permlane32_swap_b32 v5, v4
    s_nop 1
    v_max3_f32 v4, v4, v5, v227
    v_sub_f32 v5, v227, v4
    v_exp_f32 v5, v5
    v_mov_b32 v227, v4
    v_mul_f32 v96, v5, v96
    v_mul_f32 v97, v5, v97
    v_mul_f32 v98, v5, v98
    v_mul_f32 v99, v5, v99
    v_mul_f32 v100, v5, v100
    v_mul_f32 v101, v5, v101
    v_mul_f32 v102, v5, v102
    v_mul_f32 v103, v5, v103
    v_mul_f32 v104, v5, v104
    v_mul_f32 v105, v5, v105
    v_mul_f32 v106, v5, v106
    v_mul_f32 v107, v5, v107
    v_mul_f32 v108, v5, v108
    v_mul_f32 v109, v5, v109
    v_mul_f32 v110, v5, v110
    v_mul_f32 v111, v5, v111
    v_sub_f32 v112, v112, v4
    v_sub_f32 v113, v113, v4
    v_sub_f32 v114, v114, v4
    v_sub_f32 v115, v115, v4
    v_sub_f32 v116, v116, v4
    v_sub_f32 v117, v117, v4
    v_sub_f32 v118, v118, v4
    v_sub_f32 v119, v119, v4
    v_sub_f32 v120, v120, v4
    v_sub_f32 v121, v121, v4
    v_sub_f32 v122, v122, v4
    v_sub_f32 v123, v123, v4
    v_sub_f32 v124, v124, v4
    v_sub_f32 v125, v125, v4
    v_sub_f32 v126, v126, v4
    v_sub_f32 v127, v127, v4
    v_exp_f32 v112, v112
    v_exp_f32 v113, v113
    v_exp_f32 v114, v114
    v_exp_f32 v115, v115
    v_exp_f32 v116, v116
    v_exp_f32 v117, v117
    v_exp_f32 v118, v118
    v_exp_f32 v119, v119
    v_exp_f32 v120, v120
    v_exp_f32 v121, v121
    v_exp_f32 v122, v122
    v_exp_f32 v123, v123
    v_exp_f32 v124, v124
    v_exp_f32 v125, v125
    v_exp_f32 v126, v126
    v_exp_f32 v127, v127
    s_nop 0
    v_cvt_pk_bf16_f32 v144, v112, v113
    v_cvt_pk_bf16_f32 v145, v114, v115
    v_cvt_pk_bf16_f32 v146, v116, v117
    v_cvt_pk_bf16_f32 v147, v118, v119
    v_cvt_pk_bf16_f32 v148, v120, v121
    v_cvt_pk_bf16_f32 v149, v122, v123
    v_cvt_pk_bf16_f32 v150, v124, v125
    v_cvt_pk_bf16_f32 v151, v126, v127
    s_nop 1
    v_mfma_f32_32x32x16_bf16 v[96:111], v[192:195], v[144:147], v[96:111]
    v_mfma_f32_32x32x16_bf16 v[96:111], v[196:199], v[148:151], v[96:111]
    s_nop 7
    s_nop 7
    s_add_u32 s44, s44, 1
    s_cmp_lt_u32 s44, 16
    s_cbranch_scc1 k2_attn_kernel_sloop
    v_and_b32 v5, 31, v0
    v_lshlrev_b32 v5, 2, v5
    v_add_u32 v5, 65536, v5
    s_lshl_b32 s45, s33, 9
    v_add_u32 v4, s45, v5
    ds_write_b32 v4, v224 offset:0
    ds_write_b32 v4, v225 offset:128
    ds_write_b32 v4, v226 offset:256
    ds_write_b32 v4, v227 offset:384
    s_waitcnt lgkmcnt(0)
    s_barrier
    ds_read_b32 v160, v5 offset:0
    ds_read_b32 v161, v5 offset:512
    ds_read_b32 v162, v5 offset:1024
    ds_read_b32 v163, v5 offset:1536
    ds_read_b32 v164, v5 offset:128
    ds_read_b32 v165, v5 offset:640
    ds_read_b32 v166, v5 offset:1152
    ds_read_b32 v167, v5 offset:1664
    ds_read_b32 v168, v5 offset:256
    ds_read_b32 v169, v5 offset:768
    ds_read_b32 v170, v5 offset:1280
    ds_read_b32 v171, v5 offset:1792
    ds_read_b32 v172, v5 offset:384
    ds_read_b32 v173, v5 offset:896
    ds_read_b32 v174, v5 offset:1408
    ds_read_b32 v175, v5 offset:1920
    s_waitcnt lgkmcnt(0)
    s_barrier
    v_max_f32 v4, v160, v161
    v_max3_f32 v4, v4, v162, v163
    v_sub_f32 v4, v224, v4
    v_exp_f32 v4, v4
    s_nop 0
    v_mul_f32 v48, v4, v48
    v_mul_f32 v49, v4, v49
    v_mul_f32 v50, v4, v50
    v_mul_f32 v51, v4, v51
    v_mul_f32 v52, v4, v52
    v_mul_f32 v53, v4, v53
    v_mul_f32 v54, v4, v54
    v_mul_f32 v55, v4, v55
    v_mul_f32 v56, v4, v56
    v_mul_f32 v57, v4, v57
    v_mul_f32 v58, v4, v58
    v_mul_f32 v59, v4, v59
    v_mul_f32 v60, v4, v60
    v_mul_f32 v61, v4, v61
    v_mul_f32 v62, v4, v62
    v_mul_f32 v63, v4, v63
    v_max_f32 v4, v164, v165
    v_max3_f32 v4, v4, v166, v167
    v_sub_f32 v4, v225, v4
    v_exp_f32 v4, v4
    s_nop 0
    v_mul_f32 v64, v4, v64
    v_mul_f32 v65, v4, v65
    v_mul_f32 v66, v4, v66
    v_mul_f32 v67, v4, v67
    v_mul_f32 v68, v4, v68
    v_mul_f32 v69, v4, v69
    v_mul_f32 v70, v4, v70
    v_mul_f32 v71, v4, v71
    v_mul_f32 v72, v4, v72
    v_mul_f32 v73, v4, v73
    v_mul_f32 v74, v4, v74
    v_mul_f32 v75, v4, v75
    v_mul_f32 v76, v4, v76
    v_mul_f32 v77, v4, v77
    v_mul_f32 v78, v4, v78
    v_mul_f32 v79, v4, v79
    v_max_f32 v4, v168, v169
    v_max3_f32 v4, v4, v170, v171
    v_sub_f32 v4, v226, v4
    v_exp_f32 v4, v4
    s_nop 0
    v_mul_f32 v80, v4, v80
    v_mul_f32 v81, v4, v81
    v_mul_f32 v82, v4, v82
    v_mul_f32 v83, v4, v83
    v_mul_f32 v84, v4, v84
    v_mul_f32 v85, v4, v85
    v_mul_f32 v86, v4, v86
    v_mul_f32 v87, v4, v87
    v_mul_f32 v88, v4, v88
    v_mul_f32 v89, v4, v89
    v_mul_f32 v90, v4, v90
    v_mul_f32 v91, v4, v91
    v_mul_f32 v92, v4, v92
    v_mul_f32 v93, v4, v93
    v_mul_f32 v94, v4, v94
    v_mul_f32 v95, v4, v95
    v_max_f32 v4, v172, v173
    v_max3_f32 v4, v4, v174, v175
    v_sub_f32 v4, v227, v4
    v_exp_f32 v4, v4
    s_nop 0
    v_mul_f32 v96, v4, v96
    v_mul_f32 v97, v4, v97
    v_mul_f32 v98, v4, v98
    v_mul_f32 v99, v4, v99
    v_mul_f32 v100, v4, v100
    v_mul_f32 v101, v4, v101
    v_mul_f32 v102, v4, v102
    v_mul_f32 v103, v4, v103
    v_mul_f32 v104, v4, v104
    v_mul_f32 v105, v4, v105
    v_mul_f32 v106, v4, v106
    v_mul_f32 v107, v4, v107
    v_mul_f32 v108, v4, v108
    v_mul_f32 v109, v4, v109
    v_mul_f32 v110, v4, v110
    v_mul_f32 v111, v4, v111
    s_branch k2_attn_kernel_comb
k2_attn_kernel_pub:
    s_add_u32 s4, s8, 0x1700000
    s_addc_u32 s5, s9, 0
    s_mov_b32 s6, 0x3000
    s_mov_b32 s7, 0x00020000
    s_waitcnt vmcnt(0)
    s_barrier
    s_cmp_lg_u32 s33, 0
    s_cbranch_scc1 k2_attn_kernel_pub2
    s_lshl_b32 s42, s32, 7
    s_add_u32 s42, s42, 8192
    v_mov_b32 v4, 1
    v_mov_b32 v5, 0
    s_mov_b64 exec, 1
    buffer_atomic_add v4, v5, s[4:7], s42 offen sc1
    s_mov_b64 exec, -1
k2_attn_kernel_pub2:
    s_cmp_ge_u32 s36, 28
    s_cbranch_scc1 k2_attn_kernel_end
    s_load_dwordx2 s[4:5], s[0:1], 0
    s_load_dwordx2 s[6:7], s[0:1], 40
    s_load_dwordx2 s[8:9], s[0:1], 80
    s_load_dwordx2 s[60:61], s[0:1], 56
    s_load_dwordx2 s[62:63], s[0:1], 64
    s_mul_i32 s37, s36, 37
    s_lshr_b32 s37, s37, 8
    s_mul_i32 s38, s37, 7
    s_sub_u32 s32, s36, s38
    s_lshl_b32 s31, s35, 2
    s_add_u32 s31, s31, s37
    v_and_b32 v2, 15, v0
    v_lshrrev_b32 v3, 4, v0
    v_lshlrev_b32 v22, 4, v0
    s_lshl_b32 s39, s32, 7
    s_lshl_b32 s40, s33, 2
    s_cmp_eq_u32 s33, 3
    s_cselect_b32 s41, 1, 0
    s_sub_u32 s40, s40, s41
    s_lshl_b32 s45, s31, 2
    s_add_u32 s42, s33, 0
    s_and_b32 s42, s42, 3
    s_lshl_b32 s52, s42, 14
    s_add_u32 s42, s42, s45
    s_mul_i32 s43, s42, 14
    s_add_u32 s43, s43, s40
    s_lshl_b32 s43, s43, 10
    v_add_u32 v16, s43, v22
    s_mul_i32 s43, s42, 56
    s_mul_i32 s44, s33, 14
    s_add_u32 s43, s43, s44
    s_lshl_b32 s43, s43, 10
    v_add_u32 v8, s43, v22
    s_add_u32 s42, s33, 1
    s_and_b32 s42, s42, 3
    s_lshl_b32 s53, s42, 14
    s_add_u32 s42, s42, s45
    s_mul_i32 s43, s42, 14
    s_add_u32 s43, s43, s40
    s_lshl_b32 s43, s43, 10
    v_add_u32 v17, s43, v22
    s_mul_i32 s43, s42, 56
    s_mul_i32 s44, s33, 14
    s_add_u32 s43, s43, s44
    s_lshl_b32 s43, s43, 10
    v_add_u32 v9, s43, v22
    s_add_u32 s42, s33, 2
    s_and_b32 s42, s42, 3
    s_lshl_b32 s54, s42, 14
    s_add_u32 s42, s42, s45
    s_mul_i32 s43, s42, 14
    s_add_u32 s43, s43, s40
    s_lshl_b32 s43, s43, 10
    v_add_u32 v18, s43, v22
    s_mul_i32 s43, s42, 56
    s_mul_i32 s44, s33, 14
    s_add_u32 s43, s43, s44
    s_lshl_b32 s43, s43, 10
    v_add_u32 v10, s43, v22
    s_add_u32 s42, s33, 3
    s_and_b32 s42, s42, 3
    s_lshl_b32 s55, s42, 14
    s_add_u32 s42, s42, s45
    s_mul_i32 s43, s42, 14
    s_add_u32 s43, s43, s40
    s_lshl_b32 s43, s43, 10
    v_add_u32 v19, s43, v22
    s_mul_i32 s43, s42, 56
    s_mul_i32 s44, s33, 14
    s_add_u32 s43, s43, s44
    s_lshl_b32 s43, s43, 10
    v_add_u32 v11, s43, v22
    s_mul_i32 s44, s32, 14
    s_add_u32 s44, s44, s40
    s_lshl_b32 s44, s44, 12
    s_add_u32 s45, s45, s33
    s_mul_i32 s46, s45, 14336
    s_lshl_b32 s47, s32, 11
    s_add_u32 s56, s46, s47
    s_lshl_b32 s48, s45, 4
    v_add_u32 v21, s48, v2
    v_mul_u32_u24 v21, 896, v21
    v_lshl_add_u32 v21, v3, 5, v21
    v_add_u32 v21, s39, v21
    s_lshl_b32 s34, s32, 2
    s_add_u32 s34, s34, s33
    s_mul_i32 s57, s34, 57344
    s_mul_i32 s58, s32, 56
    s_mul_i32 s59, s33, 14
    s_add_u32 s58, s58, s59
    s_lshl_b32 s58, s58, 12
    s_waitcnt lgkmcnt(0)
    s_add_u32 s12, s8, 0x600000
    s_addc_u32 s13, s9, 0
    s_mov_b32 s14, 0x1c0000
    s_mov_b32 s15, 0x00020000
    s_add_u32 s16, s8, 0x1200000
    s_addc_u32 s17, s9, 0
    s_mov_b32 s18, 0x62000
    s_mov_b32 s19, 0x00020000
    s_add_u32 s20, s8, 0x800000
    s_addc_u32 s21, s9, 0
    s_mov_b32 s22, 0x1c0000
    s_mov_b32 s23, 0x00020000
    s_mov_b32 s24, s4
    s_mov_b32 s25, s5
    s_mov_b32 s26, 0x1c0000
    s_mov_b32 s27, 0x00020000
    s_add_u32 s64, s8, 0x1280000
    s_addc_u32 s65, s9, 0
    s_mov_b32 s66, 0x188000
    s_mov_b32 s67, 0x00020000
    s_add_u32 s68, s8, 0x1500000
    s_addc_u32 s69, s9, 0
    s_mov_b32 s70, 0x188000
    s_mov_b32 s71, 0x00020000
    s_add_u32 s72, s8, 0xa00000
    s_addc_u32 s73, s9, 0
    s_mov_b32 s74, 0x700000
    s_mov_b32 s75, 0x00020000
    s_mov_b32 s76, s6
    s_mov_b32 s77, s7
    s_mov_b32 s78, 0xe00
    s_mov_b32 s79, 0x00020000
    s_mov_b32 s80, s60
    s_mov_b32 s81, s61
    s_mov_b32 s82, 0x380
    s_mov_b32 s83, 0x00020000
    s_mov_b32 s84, s62
    s_mov_b32 s85, s63
    s_mov_b32 s86, 0x1c0000
    s_mov_b32 s87, 0x00020000
    s_add_u32 s4, s8, 0x1700000
    s_addc_u32 s5, s9, 0
    s_mov_b32 s6, 0x3000
    s_mov_b32 s7, 0x00020000
    s_add_u32 s30, s44, 0
    buffer_load_dwordx4 v[128:131], v22, s[16:19], s30 offen offset:0
    buffer_load_dwordx4 v[132:135], v22, s[16:19], s30 offen offset:1024
    buffer_load_dwordx4 v[136:139], v22, s[16:19], s30 offen offset:2048
    buffer_load_dwordx4 v[140:143], v22, s[16:19], s30 offen offset:3072
    s_add_u32 s30, s44, 4096
    buffer_load_dwordx4 v[144:147], v22, s[16:19], s30 offen offset:0
    buffer_load_dwordx4 v[148:151], v22, s[16:19], s30 offen offset:1024
    buffer_load_dwordx4 v[152:155], v22, s[16:19], s30 offen offset:2048
    buffer_load_dwordx4 v[156:159], v22, s[16:19], s30 offen offset:3072
    s_add_u32 s30, s44, 8192
    buffer_load_dwordx4 v[160:163], v22, s[16:19], s30 offen offset:0
    buffer_load_dwordx4 v[164:167], v22, s[16:19], s30 offen offset:1024
    buffer_load_dwordx4 v[168:171], v22, s[16:19], s30 offen offset:2048
    buffer_load_dwordx4 v[172:175], v22, s[16:19], s30 offen offset:3072
    s_add_u32 s30, s44, 12288
    buffer_load_dwordx4 v[176:179], v22, s[16:19], s30 offen offset:0
    buffer_load_dwordx4 v[180:183], v22, s[16:19], s30 offen offset:1024
    buffer_load_dwordx4 v[184:187], v22, s[16:19], s30 offen offset:2048
    buffer_load_dwordx4 v[188:191], v22, s[16:19], s30 offen offset:3072
    buffer_load_dwordx4 v[24:27], v21, s[24:27], 0 offen
    buffer_load_dwordx4 v[28:31], v21, s[24:27], 0 offen offset:16
    s_cmp_lg_u32 s33, 0
    s_cbranch_scc1 k3_mlp_kernel_ow
    s_lshr_b32 s42, s31, 1
    s_lshl_b32 s42, s42, 7
    s_add_u32 s42, s42, 8192
    v_mov_b32 v5, 0
    s_mov_b64 exec, 1
    s_mov_b32 s43, 0
k3_mlp_kernel_ol:
    buffer_load_dword v4, v5, s[4:7], s42 offen sc1
    s_add_u32 s43, s43, 1
    s_waitcnt vmcnt(0)
    v_readfirstlane_b32 s49, v4
    s_cmp_ge_u32 s43, 0x100000
    s_cbranch_scc1 k3_mlp_kernel_ox
    s_cmp_lt_u32 s49, 16
    s_cbranch_scc1 k3_mlp_kernel_ol
k3_mlp_kernel_ox:
    s_mov_b64 exec, -1
k3_mlp_kernel_ow:
    s_barrier
    s_mov_b32 s43, 0
    buffer_load_dwordx4 v[192:195], v16, s[12:15], s43 offen sc1
    buffer_load_dwordx4 v[196:199], v17, s[12:15], s43 offen sc1
    buffer_load_dwordx4 v[200:203], v18, s[12:15], s43 offen sc1
    buffer_load_dwordx4 v[204:207], v19, s[12:15], s43 offen sc1
    s_mov_b32 s43, 1024
    buffer_load_dwordx4 v[208:211], v16, s[12:15], s43 offen sc1
    buffer_load_dwordx4 v[212:215], v17, s[12:15], s43 offen sc1
    buffer_load_dwordx4 v[216:219], v18, s[12:15], s43 offen sc1
    buffer_load_dwordx4 v[220:223], v19, s[12:15], s43 offen sc1
    s_mov_b32 s43, 2048
    buffer_load_dwordx4 v[224:227], v16, s[12:15], s43 offen sc1
    buffer_load_dwordx4 v[228:231], v17, s[12:15], s43 offen sc1
    buffer_load_dwordx4 v[232:235], v18, s[12:15], s43 offen sc1
    buffer_load_dwordx4 v[236:239], v19, s[12:15], s43 offen sc1
    s_mov_b32 s43, 3072
    buffer_load_dwordx4 v[240:243], v16, s[12:15], s43 offen sc1
    buffer_load_dwordx4 v[244:247], v17, s[12:15], s43 offen sc1
    buffer_load_dwordx4 v[248:251], v18, s[12:15], s43 offen sc1
    buffer_load_dwordx4 v[252:255], v19, s[12:15], s43 offen sc1
    v_mov_b32 v64, 0
    v_mov_b32 v65, 0
    v_mov_b32 v66, 0
    v_mov_b32 v67, 0
    v_mov_b32 v68, 0
    v_mov_b32 v69, 0
    v_mov_b32 v70, 0
    v_mov_b32 v71, 0
    v_mov_b32 v72, 0
    v_mov_b32 v73, 0
    v_mov_b32 v74, 0
    v_mov_b32 v75, 0
    v_mov_b32 v76, 0
    v_mov_b32 v77, 0
    v_mov_b32 v78, 0
    v_mov_b32 v79, 0
    v_mov_b32 v80, 0
    v_mov_b32 v81, 0
    v_mov_b32 v82, 0
    v_mov_b32 v83, 0
    v_mov_b32 v84, 0
    v_mov_b32 v85, 0
    v_mov_b32 v86, 0
    v_mov_b32 v87, 0
    v_mov_b32 v88, 0
    v_mov_b32 v89, 0
    v_mov_b32 v90, 0
    v_mov_b32 v91, 0
    v_mov_b32 v92, 0
    v_mov_b32 v93, 0
    v_mov_b32 v94, 0
    v_mov_b32 v95, 0
    v_mov_b32 v96, 0
    v_mov_b32 v97, 0
    v_mov_b32 v98, 0
    v_mov_b32 v99, 0
    v_mov_b32 v100, 0
    v_mov_b32 v101, 0
    v_mov_b32 v102, 0
    v_mov_b32 v103, 0
    v_mov_b32 v104, 0
    v_mov_b32 v105, 0
    v_mov_b32 v106, 0
    v_mov_b32 v107, 0
    v_mov_b32 v108, 0
    v_mov_b32 v109, 0
    v_mov_b32 v110, 0
    v_mov_b32 v111, 0
    v_mov_b32 v112, 0
    v_mov_b32 v113, 0
    v_mov_b32 v114, 0
    v_mov_b32 v115, 0
    v_mov_b32 v116, 0
    v_mov_b32 v117, 0
    v_mov_b32 v118, 0
    v_mov_b32 v119, 0
    v_mov_b32 v120, 0
    v_mov_b32 v121, 0
    v_mov_b32 v122, 0
    v_mov_b32 v123, 0
    v_mov_b32 v124, 0
    v_mov_b32 v125, 0
    v_mov_b32 v126, 0
    v_mov_b32 v127, 0
    s_waitcnt vmcnt(12)
    v_mfma_f32_16x16x32_bf16 v[64:67], v[128:131], v[192:195], v[64:67]
    v_mfma_f32_16x16x32_bf16 v[68:71], v[132:135], v[192:195], v[68:71]
    v_mfma_f32_16x16x32_bf16 v[72:75], v[136:139], v[192:195], v[72:75]
    v_mfma_f32_16x16x32_bf16 v[76:79], v[140:143], v[192:195], v[76:79]
    v_mfma_f32_16x16x32_bf16 v[80:83], v[128:131], v[196:199], v[80:83]
    v_mfma_f32_16x16x32_bf16 v[84:87], v[132:135], v[196:199], v[84:87]
    v_mfma_f32_16x16x32_bf16 v[88:91], v[136:139], v[196:199], v[88:91]
    v_mfma_f32_16x16x32_bf16 v[92:95], v[140:143], v[196:199], v[92:95]
    v_mfma_f32_16x16x32_bf16 v[96:99], v[128:131], v[200:203], v[96:99]
    v_mfma_f32_16x16x32_bf16 v[100:103], v[132:135], v[200:203], v[100:103]
    v_mfma_f32_16x16x32_bf16 v[104:107], v[136:139], v[200:203], v[104:107]
    v_mfma_f32_16x16x32_bf16 v[108:111], v[140:143], v[200:203], v[108:111]
    v_mfma_f32_16x16x32_bf16 v[112:115], v[128:131], v[204:207], v[112:115]
    v_mfma_f32_16x16x32_bf16 v[116:119], v[132:135], v[204:207], v[116:119]
    v_mfma_f32_16x16x32_bf16 v[120:123], v[136:139], v[204:207], v[120:123]
    v_mfma_f32_16x16x32_bf16 v[124:127], v[140:143], v[204:207], v[124:127]
    s_waitcnt vmcnt(8)
    v_mfma_f32_16x16x32_bf16 v[64:67], v[144:147], v[208:211], v[64:67]
    v_mfma_f32_16x16x32_bf16 v[68:71], v[148:151], v[208:211], v[68:71]
    v_mfma_f32_16x16x32_bf16 v[72:75], v[152:155], v[208:211], v[72:75]
    v_mfma_f32_16x16x32_bf16 v[76:79], v[156:159], v[208:211], v[76:79]
    v_mfma_f32_16x16x32_bf16 v[80:83], v[144:147], v[212:215], v[80:83]
    v_mfma_f32_16x16x32_bf16 v[84:87], v[148:151], v[212:215], v[84:87]
    v_mfma_f32_16x16x32_bf16 v[88:91], v[152:155], v[212:215], v[88:91]
    v_mfma_f32_16x16x32_bf16 v[92:95], v[156:159], v[212:215], v[92:95]
    v_mfma_f32_16x16x32_bf16 v[96:99], v[144:147], v[216:219], v[96:99]
    v_mfma_f32_16x16x32_bf16 v[100:103], v[148:151], v[216:219], v[100:103]
    v_mfma_f32_16x16x32_bf16 v[104:107], v[152:155], v[216:219], v[104:107]
    v_mfma_f32_16x16x32_bf16 v[108:111], v[156:159], v[216:219], v[108:111]
    v_mfma_f32_16x16x32_bf16 v[112:115], v[144:147], v[220:223], v[112:115]
    v_mfma_f32_16x16x32_bf16 v[116:119], v[148:151], v[220:223], v[116:119]
    v_mfma_f32_16x16x32_bf16 v[120:123], v[152:155], v[220:223], v[120:123]
    v_mfma_f32_16x16x32_bf16 v[124:127], v[156:159], v[220:223], v[124:127]
    s_waitcnt vmcnt(4)
    v_mfma_f32_16x16x32_bf16 v[64:67], v[160:163], v[224:227], v[64:67]
    v_mfma_f32_16x16x32_bf16 v[68:71], v[164:167], v[224:227], v[68:71]
    v_mfma_f32_16x16x32_bf16 v[72:75], v[168:171], v[224:227], v[72:75]
    v_mfma_f32_16x16x32_bf16 v[76:79], v[172:175], v[224:227], v[76:79]
    v_mfma_f32_16x16x32_bf16 v[80:83], v[160:163], v[228:231], v[80:83]
    v_mfma_f32_16x16x32_bf16 v[84:87], v[164:167], v[228:231], v[84:87]
    v_mfma_f32_16x16x32_bf16 v[88:91], v[168:171], v[228:231], v[88:91]
    v_mfma_f32_16x16x32_bf16 v[92:95], v[172:175], v[228:231], v[92:95]
    v_mfma_f32_16x16x32_bf16 v[96:99], v[160:163], v[232:235], v[96:99]
    v_mfma_f32_16x16x32_bf16 v[100:103], v[164:167], v[232:235], v[100:103]
    v_mfma_f32_16x16x32_bf16 v[104:107], v[168:171], v[232:235], v[104:107]
    v_mfma_f32_16x16x32_bf16 v[108:111], v[172:175], v[232:235], v[108:111]
    v_mfma_f32_16x16x32_bf16 v[112:115], v[160:163], v[236:239], v[112:115]
    v_mfma_f32_16x16x32_bf16 v[116:119], v[164:167], v[236:239], v[116:119]
    v_mfma_f32_16x16x32_bf16 v[120:123], v[168:171], v[236:239], v[120:123]
    v_mfma_f32_16x16x32_bf16 v[124:127], v[172:175], v[236:239], v[124:127]
    s_cmp_ge_u32 s33, 2
    s_cbranch_scc1 k3_mlp_kernel_a3
    s_waitcnt vmcnt(0)
    v_mfma_f32_16x16x32_bf16 v[64:67], v[176:179], v[240:243], v[64:67]
    v_mfma_f32_16x16x32_bf16 v[68:71], v[180:183], v[240:243], v[68:71]
    v_mfma_f32_16x16x32_bf16 v[72:75], v[184:187], v[240:243], v[72:75]
    v_mfma_f32_16x16x32_bf16 v[76:79], v[188:191], v[240:243], v[76:79]
    v_mfma_f32_16x16x32_bf16 v[80:83], v[176:179], v[244:247], v[80:83]
    v_mfma_f32_16x16x32_bf16 v[84:87], v[180:183], v[244:247], v[84:87]
    v_mfma_f32_16x16x32_bf16 v[88:91], v[184:187], v[244:247], v[88:91]
    v_mfma_f32_16x16x32_bf16 v[92:95], v[188:191], v[244:247], v[92:95]
    v_mfma_f32_16x16x32_bf16 v[96:99], v[176:179], v[248:251], v[96:99]
    v_mfma_f32_16x16x32_bf16 v[100:103], v[180:183], v[248:251], v[100:103]
    v_mfma_f32_16x16x32_bf16 v[104:107], v[184:187], v[248:251], v[104:107]
    v_mfma_f32_16x16x32_bf16 v[108:111], v[188:191], v[248:251], v[108:111]
    v_mfma_f32_16x16x32_bf16 v[112:115], v[176:179], v[252:255], v[112:115]
    v_mfma_f32_16x16x32_bf16 v[116:119], v[180:183], v[252:255], v[116:119]
    v_mfma_f32_16x16x32_bf16 v[120:123], v[184:187], v[252:255], v[120:123]
    v_mfma_f32_16x16x32_bf16 v[124:127], v[188:191], v[252:255], v[124:127]
k3_mlp_kernel_a3:
    s_nop 7
    v_add_u32 v5, s53, v22
    ds_write_b128 v5, v[80:83] offset:4096
    ds_write_b128 v5, v[84:87] offset:5120
    ds_write_b128 v5, v[88:91] offset:6144
    ds_write_b128 v5, v[92:95] offset:7168
    v_add_u32 v6, s54, v22
    ds_write_b128 v6, v[96:99] offset:8192
    ds_write_b128 v6, v[100:103] offset:9216
    ds_write_b128 v6, v[104:107] offset:10240
    ds_write_b128 v6, v[108:111] offset:11264
    v_add_u32 v7, s55, v22
    ds_write_b128 v7, v[112:115] offset:12288
    ds_write_b128 v7, v[116:119] offset:13312
    ds_write_b128 v7, v[120:123] offset:14336
    ds_write_b128 v7, v[124:127] offset:15360
    v_add_u32 v4, s52, v22
    s_waitcnt lgkmcnt(0)
    s_barrier
    ds_read_b128 v[80:83], v4 offset:4096
    ds_read_b128 v[84:87], v4 offset:5120
    ds_read_b128 v[88:91], v4 offset:6144
    ds_read_b128 v[92:95], v4 offset:7168
    ds_read_b128 v[96:99], v4 offset:8192
    ds_read_b128 v[100:103], v4 offset:9216
    ds_read_b128 v[104:107], v4 offset:10240
    ds_read_b128 v[108:111], v4 offset:11264
    ds_read_b128 v[112:115], v4 offset:12288
    ds_read_b128 v[116:119], v4 offset:13312
    ds_read_b128 v[120:123], v4 offset:14336
    ds_read_b128 v[124:127], v4 offset:15360
    s_waitcnt lgkmcnt(8)
    v_pk_add_f32 v[64:65], v[64:65], v[80:81]
    v_pk_add_f32 v[66:67], v[66:67], v[82:83]
    v_pk_add_f32 v[68:69], v[68:69], v[84:85]
    v_pk_add_f32 v[70:71], v[70:71], v[86:87]
    v_pk_add_f32 v[72:73], v[72:73], v[88:89]
    v_pk_add_f32 v[74:75], v[74:75], v[90:91]
    v_pk_add_f32 v[76:77], v[76:77], v[92:93]
    v_pk_add_f32 v[78:79], v[78:79], v[94:95]
    s_waitcnt lgkmcnt(4)
    v_pk_add_f32 v[64:65], v[64:65], v[96:97]
    v_pk_add_f32 v[66:67], v[66:67], v[98:99]
    v_pk_add_f32 v[68:69], v[68:69], v[100:101]
    v_pk_add_f32 v[70:71], v[70:71], v[102:103]
    v_pk_add_f32 v[72:73], v[72:73], v[104:105]
    v_pk_add_f32 v[74:75], v[74:75], v[106:107]
    v_pk_add_f32 v[76:77], v[76:77], v[108:109]
    v_pk_add_f32 v[78:79], v[78:79], v[110:111]
    s_waitcnt lgkmcnt(0)
    v_pk_add_f32 v[64:65], v[64:65], v[112:113]
    v_pk_add_f32 v[66:67], v[66:67], v[114:115]
    v_pk_add_f32 v[68:69], v[68:69], v[116:117]
    v_pk_add_f32 v[70:71], v[70:71], v[118:119]
    v_pk_add_f32 v[72:73], v[72:73], v[120:121]
    v_pk_add_f32 v[74:75], v[74:75], v[122:123]
    v_pk_add_f32 v[76:77], v[76:77], v[124:125]
    v_pk_add_f32 v[78:79], v[78:79], v[126:127]
    v_lshlrev_b32 v6, 16, v24
    v_and_b32 v7, 0xffff0000, v24
    v_add_f32 v64, v64, v6
    v_add_f32 v68, v68, v7
    v_lshlrev_b32 v6, 16, v25
    v_and_b32 v7, 0xffff0000, v25
    v_add_f32 v72, v72, v6
    v_add_f32 v76, v76, v7
    v_lshlrev_b32 v6, 16, v26
    v_and_b32 v7, 0xffff0000, v26
    v_add_f32 v65, v65, v6
    v_add_f32 v69, v69, v7
    v_lshlrev_b32 v6, 16, v27
    v_and_b32 v7, 0xffff0000, v27
    v_add_f32 v73, v73, v6
    v_add_f32 v77, v77, v7
    v_lshlrev_b32 v6, 16, v28
    v_and_b32 v7, 0xffff0000, v28
    v_add_f32 v66, v66, v6
    v_add_f32 v70, v70, v7
    v_lshlrev_b32 v6, 16, v29
    v_and_b32 v7, 0xffff0000, v29
    v_add_f32 v74, v74, v6
    v_add_f32 v78, v78, v7
    v_lshlrev_b32 v6, 16, v30
    v_and_b32 v7, 0xffff0000, v30
    v_add_f32 v67, v67, v6
    v_add_f32 v71, v71, v7
    v_lshlrev_b32 v6, 16, v31
    v_and_b32 v7, 0xffff0000, v31
    v_add_f32 v75, v75, v6
    v_add_f32 v79, v79, v7
    v_cvt_pk_bf16_f32 v48, v64, v68
    v_cvt_pk_bf16_f32 v49, v72, v76
    v_cvt_pk_bf16_f32 v50, v65, v69
    v_cvt_pk_bf16_f32 v51, v73, v77
    v_cvt_pk_bf16_f32 v52, v66, v70
    v_cvt_pk_bf16_f32 v53, v74, v78
    v_cvt_pk_bf16_f32 v54, v67, v71
    v_cvt_pk_bf16_f32 v55, v75, v79
    buffer_store_dwordx4 v[48:51], v22, s[20:23], s56 offen sc1
    buffer_store_dwordx4 v[52:55], v22, s[20:23], s56 offen offset:1024 sc1
    s_waitcnt vmcnt(0)
    s_barrier
    s_cmp_lg_u32 s33, 0
    s_cbranch_scc1 k3_mlp_kernel_p0
    s_lshl_b32 s42, s31, 7
    s_add_u32 s42, s42, 0
    v_mov_b32 v4, 1
    v_mov_b32 v5, 0
    s_mov_b64 exec, 1
    buffer_atomic_add v4, v5, s[4:7], s42 offen sc1
    s_mov_b64 exec, -1
    s_mov_b64 exec, 1
    s_mov_b32 s43, 0
k3_mlp_kernel_l0:
    buffer_load_dword v4, v5, s[4:7], s42 offen sc1
    s_add_u32 s43, s43, 1
    s_waitcnt vmcnt(0)
    v_readfirstlane_b32 s49, v4
    s_cmp_ge_u32 s43, 0x100000
    s_cbranch_scc1 k3_mlp_kernel_x0
    s_cmp_lt_u32 s49, 7
    s_cbranch_scc1 k3_mlp_kernel_l0
k3_mlp_kernel_x0:
    s_mov_b64 exec, -1
k3_mlp_kernel_p0:
    s_barrier
    s_lshl_b32 s41, s34, 7
    v_lshlrev_b32 v6, 5, v3
    v_add_u32 v7, s39, v6
    v_add_u32 v6, s41, v6
    v_add_u32 v5, s46, v22
    buffer_load_dwordx4 v[64:67], v5, s[20:23], 0 offen offset:0 sc1
    buffer_load_dwordx4 v[68:71], v5, s[20:23], 0 offen offset:1024 sc1
    buffer_load_dwordx4 v[72:75], v5, s[20:23], 0 offen offset:2048 sc1
    buffer_load_dwordx4 v[76:79], v5, s[20:23], 0 offen offset:3072 sc1
    v_add_u32 v5, 4096, v5
    buffer_load_dwordx4 v[80:83], v5, s[20:23], 0 offen offset:0 sc1
    buffer_load_dwordx4 v[84:87], v5, s[20:23], 0 offen offset:1024 sc1
    buffer_load_dwordx4 v[88:91], v5, s[20:23], 0 offen offset:2048 sc1
    buffer_load_dwordx4 v[92:95], v5, s[20:23], 0 offen offset:3072 sc1
    v_add_u32 v5, 4096, v5
    buffer_load_dwordx4 v[96:99], v5, s[20:23], 0 offen offset:0 sc1
    buffer_load_dwordx4 v[100:103], v5, s[20:23], 0 offen offset:1024 sc1
    buffer_load_dwordx4 v[104:107], v5, s[20:23], 0 offen offset:2048 sc1
    buffer_load_dwordx4 v[108:111], v5, s[20:23], 0 offen offset:3072 sc1
    v_add_u32 v5, 4096, v5
    buffer_load_dwordx4 v[112:115], v5, s[20:23], 0 offen offset:0 sc1
    buffer_load_dwordx4 v[116:119], v5, s[20:23], 0 offen offset:1024 sc1
    buffer_load_dwordx4 v[120:123], v6, s[76:79], 0 offen
    buffer_load_dwordx4 v[124:127], v6, s[76:79], 0 offen offset:16
    buffer_load_dwordx4 v[56:59], v7, s[80:83], 0 offen
    buffer_load_dwordx4 v[60:63], v7, s[80:83], 0 offen offset:16
    v_mov_b32 v28, 0x3f803f80
    v_mov_b32 v30, 0
    v_mov_b32 v31, 0
    v_mov_b32 v32, 0
    v_mov_b32 v33, 0
    s_waitcnt vmcnt(0)
    v_dot2c_f32_bf16 v30, v64, v28
    v_dot2c_f32_bf16 v32, v64, v64
    v_dot2c_f32_bf16 v31, v65, v28
    v_dot2c_f32_bf16 v33, v65, v65
    v_dot2c_f32_bf16 v30, v66, v28
    v_dot2c_f32_bf16 v32, v66, v66
    v_dot2c_f32_bf16 v31, v67, v28
    v_dot2c_f32_bf16 v33, v67, v67
    v_dot2c_f32_bf16 v30, v68, v28
    v_dot2c_f32_bf16 v32, v68, v68
    v_dot2c_f32_bf16 v31, v69, v28
    v_dot2c_f32_bf16 v33, v69, v69
    v_dot2c_f32_bf16 v30, v70, v28
    v_dot2c_f32_bf16 v32, v70, v70
    v_dot2c_f32_bf16 v31, v71, v28
    v_dot2c_f32_bf16 v33, v71, v71
    v_dot2c_f32_bf16 v30, v72, v28
    v_dot2c_f32_bf16 v32, v72, v72
    v_dot2c_f32_bf16 v31, v73, v28
    v_dot2c_f32_bf16 v33, v73, v73
    v_dot2c_f32_bf16 v30, v74, v28
    v_dot2c_f32_bf16 v32, v74, v74
    v_dot2c_f32_bf16 v31, v75, v28
    v_dot2c_f32_bf16 v33, v75, v75
    v_dot2c_f32_bf16 v30, v76, v28
    v_dot2c_f32_bf16 v32, v76, v76
    v_dot2c_f32_bf16 v31, v77, v28
    v_dot2c_f32_bf16 v33, v77, v77
    v_dot2c_f32_bf16 v30, v78, v28
    v_dot2c_f32_bf16 v32, v78, v78
    v_dot2c_f32_bf16 v31, v79, v28
    v_dot2c_f32_bf16 v33, v79, v79
    v_dot2c_f32_bf16 v30, v80, v28
    v_dot2c_f32_bf16 v32, v80, v80
    v_dot2c_f32_bf16 v31, v81, v28
    v_dot2c_f32_bf16 v33, v81, v81
    v_dot2c_f32_bf16 v30, v82, v28
    v_dot2c_f32_bf16 v32, v82, v82
    v_dot2c_f32_bf16 v31, v83, v28
    v_dot2c_f32_bf16 v33, v83, v83
    v_dot2c_f32_bf16 v30, v84, v28
    v_dot2c_f32_bf16 v32, v84, v84
    v_dot2c_f32_bf16 v31, v85, v28
    v_dot2c_f32_bf16 v33, v85, v85
    v_dot2c_f32_bf16 v30, v86, v28
    v_dot2c_f32_bf16 v32, v86, v86
    v_dot2c_f32_bf16 v31, v87, v28
    v_dot2c_f32_bf16 v33, v87, v87
    v_dot2c_f32_bf16 v30, v88, v28
    v_dot2c_f32_bf16 v32, v88, v88
    v_dot2c_f32_bf16 v31, v89, v28
    v_dot2c_f32_bf16 v33, v89, v89
    v_dot2c_f32_bf16 v30, v90, v28
    v_dot2c_f32_bf16 v32, v90, v90
    v_dot2c_f32_bf16 v31, v91, v28
    v_dot2c_f32_bf16 v33, v91, v91
    v_dot2c_f32_bf16 v30, v92, v28
    v_dot2c_f32_bf16 v32, v92, v92
    v_dot2c_f32_bf16 v31, v93, v28
    v_dot2c_f32_bf16 v33, v93, v93
    v_dot2c_f32_bf16 v30, v94, v28
    v_dot2c_f32_bf16 v32, v94, v94
    v_dot2c_f32_bf16 v31, v95, v28
    v_dot2c_f32_bf16 v33, v95, v95
    v_dot2c_f32_bf16 v30, v96, v28
    v_dot2c_f32_bf16 v32, v96, v96
    v_dot2c_f32_bf16 v31, v97, v28
    v_dot2c_f32_bf16 v33, v97, v97
    v_dot2c_f32_bf16 v30, v98, v28
    v_dot2c_f32_bf16 v32, v98, v98
    v_dot2c_f32_bf16 v31, v99, v28
    v_dot2c_f32_bf16 v33, v99, v99
    v_dot2c_f32_bf16 v30, v100, v28
    v_dot2c_f32_bf16 v32, v100, v100
    v_dot2c_f32_bf16 v31, v101, v28
    v_dot2c_f32_bf16 v33, v101, v101
    v_dot2c_f32_bf16 v30, v102, v28
    v_dot2c_f32_bf16 v32, v102, v102
    v_dot2c_f32_bf16 v31, v103, v28
    v_dot2c_f32_bf16 v33, v103, v103
    v_dot2c_f32_bf16 v30, v104, v28
    v_dot2c_f32_bf16 v32, v104, v104
    v_dot2c_f32_bf16 v31, v105, v28
    v_dot2c_f32_bf16 v33, v105, v105
    v_dot2c_f32_bf16 v30, v106, v28
    v_dot2c_f32_bf16 v32, v106, v106
    v_dot2c_f32_bf16 v31, v107, v28
    v_dot2c_f32_bf16 v33, v107, v107
    v_dot2c_f32_bf16 v30, v108, v28
    v_dot2c_f32_bf16 v32, v108, v108
    v_dot2c_f32_bf16 v31, v109, v28
    v_dot2c_f32_bf16 v33, v109, v109
    v_dot2c_f32_bf16 v30, v110, v28
    v_dot2c_f32_bf16 v32, v110, v110
    v_dot2c_f32_bf16 v31, v111, v28
    v_dot2c_f32_bf16 v33, v111, v111
    v_dot2c_f32_bf16 v30, v112, v28
    v_dot2c_f32_bf16 v32, v112, v112
    v_dot2c_f32_bf16 v31, v113, v28
    v_dot2c_f32_bf16 v33, v113, v113
    v_dot2c_f32_bf16 v30, v114, v28
    v_dot2c_f32_bf16 v32, v114, v114
    v_dot2c_f32_bf16 v31, v115, v28
    v_dot2c_f32_bf16 v33, v115, v115
    v_dot2c_f32_bf16 v30, v116, v28
    v_dot2c_f32_bf16 v32, v116, v116
    v_dot2c_f32_bf16 v31, v117, v28
    v_dot2c_f32_bf16 v33, v117, v117
    v_dot2c_f32_bf16 v30, v118, v28
    v_dot2c_f32_bf16 v32, v118, v118
    v_dot2c_f32_bf16 v31, v119, v28
    v_dot2c_f32_bf16 v33, v119, v119
    s_nop 2
    v_add_f32 v30, v30, v31
    v_add_f32 v32, v32, v33
    s_nop 1
    v_mov_b32 v31, v30
    v_mov_b32 v33, v32
    s_nop 1
    v_permlane16_swap_b32 v31, v30
    v_permlane16_swap_b32 v33, v32
    s_nop 1
    v_add_f32 v30, v30, v31
    v_add_f32 v32, v32, v33
    v_mov_b32 v31, v30
    v_mov_b32 v33, v32
    s_nop 1
    v_permlane32_swap_b32 v31, v30
    v_permlane32_swap_b32 v33, v32
    s_nop 1
    v_add_f32 v30, v30, v31
    v_add_f32 v32, v32, v33
    v_mul_f32 v30, 0x3b124925, v30
    v_mul_f32 v32, 0x3b124925, v32
    v_fma_f32 v32, -v30, v30, v32
    v_max_f32 v32, 0, v32
    v_add_f32 v32, 0x3727c5ac, v32
    v_rsq_f32 v34, v32
    s_nop 0
    v_mul_f32 v36, v30, v34
    v_sub_f32 v36, 0, v36
    v_mov_b32 v35, v34
    v_mov_b32 v37, v36
    s_mul_i32 s41, s33, 14336
    v_add_u32 v38, s41, v22
    v_lshlrev_b32 v40, 16, v64
    v_and_b32 v41, 0xffff0000, v64
    v_pk_fma_f32 v[40:41], v[40:41], v[34:35], v[36:37]
    v_cvt_pk_bf16_f32 v64, v40, v41
    v_lshlrev_b32 v42, 16, v65
    v_and_b32 v43, 0xffff0000, v65
    v_pk_fma_f32 v[42:43], v[42:43], v[34:35], v[36:37]
    v_cvt_pk_bf16_f32 v65, v42, v43
    v_lshlrev_b32 v40, 16, v66
    v_and_b32 v41, 0xffff0000, v66
    v_pk_fma_f32 v[40:41], v[40:41], v[34:35], v[36:37]
    v_cvt_pk_bf16_f32 v66, v40, v41
    v_lshlrev_b32 v42, 16, v67
    v_and_b32 v43, 0xffff0000, v67
    v_pk_fma_f32 v[42:43], v[42:43], v[34:35], v[36:37]
    v_cvt_pk_bf16_f32 v67, v42, v43
    ds_write_b128 v38, v[64:67] offset:0
    v_lshlrev_b32 v40, 16, v68
    v_and_b32 v41, 0xffff0000, v68
    v_pk_fma_f32 v[40:41], v[40:41], v[34:35], v[36:37]
    v_cvt_pk_bf16_f32 v68, v40, v41
    v_lshlrev_b32 v42, 16, v69
    v_and_b32 v43, 0xffff0000, v69
    v_pk_fma_f32 v[42:43], v[42:43], v[34:35], v[36:37]
    v_cvt_pk_bf16_f32 v69, v42, v43
    v_lshlrev_b32 v40, 16, v70
    v_and_b32 v41, 0xffff0000, v70
    v_pk_fma_f32 v[40:41], v[40:41], v[34:35], v[36:37]
    v_cvt_pk_bf16_f32 v70, v40, v41
    v_lshlrev_b32 v42, 16, v71
    v_and_b32 v43, 0xffff0000, v71
    v_pk_fma_f32 v[42:43], v[42:43], v[34:35], v[36:37]
    v_cvt_pk_bf16_f32 v71, v42, v43
    ds_write_b128 v38, v[68:71] offset:1024
    v_lshlrev_b32 v40, 16, v72
    v_and_b32 v41, 0xffff0000, v72
    v_pk_fma_f32 v[40:41], v[40:41], v[34:35], v[36:37]
    v_cvt_pk_bf16_f32 v72, v40, v41
    v_lshlrev_b32 v42, 16, v73
    v_and_b32 v43, 0xffff0000, v73
    v_pk_fma_f32 v[42:43], v[42:43], v[34:35], v[36:37]
    v_cvt_pk_bf16_f32 v73, v42, v43
    v_lshlrev_b32 v40, 16, v74
    v_and_b32 v41, 0xffff0000, v74
    v_pk_fma_f32 v[40:41], v[40:41], v[34:35], v[36:37]
    v_cvt_pk_bf16_f32 v74, v40, v41
    v_lshlrev_b32 v42, 16, v75
    v_and_b32 v43, 0xffff0000, v75
    v_pk_fma_f32 v[42:43], v[42:43], v[34:35], v[36:37]
    v_cvt_pk_bf16_f32 v75, v42, v43
    ds_write_b128 v38, v[72:75] offset:2048
    v_lshlrev_b32 v40, 16, v76
    v_and_b32 v41, 0xffff0000, v76
    v_pk_fma_f32 v[40:41], v[40:41], v[34:35], v[36:37]
    v_cvt_pk_bf16_f32 v76, v40, v41
    v_lshlrev_b32 v42, 16, v77
    v_and_b32 v43, 0xffff0000, v77
    v_pk_fma_f32 v[42:43], v[42:43], v[34:35], v[36:37]
    v_cvt_pk_bf16_f32 v77, v42, v43
    v_lshlrev_b32 v40, 16, v78
    v_and_b32 v41, 0xffff0000, v78
    v_pk_fma_f32 v[40:41], v[40:41], v[34:35], v[36:37]
    v_cvt_pk_bf16_f32 v78, v40, v41
    v_lshlrev_b32 v42, 16, v79
    v_and_b32 v43, 0xffff0000, v79
    v_pk_fma_f32 v[42:43], v[42:43], v[34:35], v[36:37]
    v_cvt_pk_bf16_f32 v79, v42, v43
    ds_write_b128 v38, v[76:79] offset:3072
    v_lshlrev_b32 v40, 16, v80
    v_and_b32 v41, 0xffff0000, v80
    v_pk_fma_f32 v[40:41], v[40:41], v[34:35], v[36:37]
    v_cvt_pk_bf16_f32 v80, v40, v41
    v_lshlrev_b32 v42, 16, v81
    v_and_b32 v43, 0xffff0000, v81
    v_pk_fma_f32 v[42:43], v[42:43], v[34:35], v[36:37]
    v_cvt_pk_bf16_f32 v81, v42, v43
    v_lshlrev_b32 v40, 16, v82
    v_and_b32 v41, 0xffff0000, v82
    v_pk_fma_f32 v[40:41], v[40:41], v[34:35], v[36:37]
    v_cvt_pk_bf16_f32 v82, v40, v41
    v_lshlrev_b32 v42, 16, v83
    v_and_b32 v43, 0xffff0000, v83
    v_pk_fma_f32 v[42:43], v[42:43], v[34:35], v[36:37]
    v_cvt_pk_bf16_f32 v83, v42, v43
    ds_write_b128 v38, v[80:83] offset:4096
    v_lshlrev_b32 v40, 16, v84
    v_and_b32 v41, 0xffff0000, v84
    v_pk_fma_f32 v[40:41], v[40:41], v[34:35], v[36:37]
    v_cvt_pk_bf16_f32 v84, v40, v41
    v_lshlrev_b32 v42, 16, v85
    v_and_b32 v43, 0xffff0000, v85
    v_pk_fma_f32 v[42:43], v[42:43], v[34:35], v[36:37]
    v_cvt_pk_bf16_f32 v85, v42, v43
    v_lshlrev_b32 v40, 16, v86
    v_and_b32 v41, 0xffff0000, v86
    v_pk_fma_f32 v[40:41], v[40:41], v[34:35], v[36:37]
    v_cvt_pk_bf16_f32 v86, v40, v41
    v_lshlrev_b32 v42, 16, v87
    v_and_b32 v43, 0xffff0000, v87
    v_pk_fma_f32 v[42:43], v[42:43], v[34:35], v[36:37]
    v_cvt_pk_bf16_f32 v87, v42, v43
    ds_write_b128 v38, v[84:87] offset:5120
    v_lshlrev_b32 v40, 16, v88
    v_and_b32 v41, 0xffff0000, v88
    v_pk_fma_f32 v[40:41], v[40:41], v[34:35], v[36:37]
    v_cvt_pk_bf16_f32 v88, v40, v41
    v_lshlrev_b32 v42, 16, v89
    v_and_b32 v43, 0xffff0000, v89
    v_pk_fma_f32 v[42:43], v[42:43], v[34:35], v[36:37]
    v_cvt_pk_bf16_f32 v89, v42, v43
    v_lshlrev_b32 v40, 16, v90
    v_and_b32 v41, 0xffff0000, v90
    v_pk_fma_f32 v[40:41], v[40:41], v[34:35], v[36:37]
    v_cvt_pk_bf16_f32 v90, v40, v41
    v_lshlrev_b32 v42, 16, v91
    v_and_b32 v43, 0xffff0000, v91
    v_pk_fma_f32 v[42:43], v[42:43], v[34:35], v[36:37]
    v_cvt_pk_bf16_f32 v91, v42, v43
    ds_write_b128 v38, v[88:91] offset:6144
    v_lshlrev_b32 v40, 16, v92
    v_and_b32 v41, 0xffff0000, v92
    v_pk_fma_f32 v[40:41], v[40:41], v[34:35], v[36:37]
    v_cvt_pk_bf16_f32 v92, v40, v41
    v_lshlrev_b32 v42, 16, v93
    v_and_b32 v43, 0xffff0000, v93
    v_pk_fma_f32 v[42:43], v[42:43], v[34:35], v[36:37]
    v_cvt_pk_bf16_f32 v93, v42, v43
    v_lshlrev_b32 v40, 16, v94
    v_and_b32 v41, 0xffff0000, v94
    v_pk_fma_f32 v[40:41], v[40:41], v[34:35], v[36:37]
    v_cvt_pk_bf16_f32 v94, v40, v41
    v_lshlrev_b32 v42, 16, v95
    v_and_b32 v43, 0xffff0000, v95
    v_pk_fma_f32 v[42:43], v[42:43], v[34:35], v[36:37]
    v_cvt_pk_bf16_f32 v95, v42, v43
    ds_write_b128 v38, v[92:95] offset:7168
    v_lshlrev_b32 v40, 16, v96
    v_and_b32 v41, 0xffff0000, v96
    v_pk_fma_f32 v[40:41], v[40:41], v[34:35], v[36:37]
    v_cvt_pk_bf16_f32 v96, v40, v41
    v_lshlrev_b32 v42, 16, v97
    v_and_b32 v43, 0xffff0000, v97
    v_pk_fma_f32 v[42:43], v[42:43], v[34:35], v[36:37]
    v_cvt_pk_bf16_f32 v97, v42, v43
    v_lshlrev_b32 v40, 16, v98
    v_and_b32 v41, 0xffff0000, v98
    v_pk_fma_f32 v[40:41], v[40:41], v[34:35], v[36:37]
    v_cvt_pk_bf16_f32 v98, v40, v41
    v_lshlrev_b32 v42, 16, v99
    v_and_b32 v43, 0xffff0000, v99
    v_pk_fma_f32 v[42:43], v[42:43], v[34:35], v[36:37]
    v_cvt_pk_bf16_f32 v99, v42, v43
    ds_write_b128 v38, v[96:99] offset:8192
    v_lshlrev_b32 v40, 16, v100
    v_and_b32 v41, 0xffff0000, v100
    v_pk_fma_f32 v[40:41], v[40:41], v[34:35], v[36:37]
    v_cvt_pk_bf16_f32 v100, v40, v41
    v_lshlrev_b32 v42, 16, v101
    v_and_b32 v43, 0xffff0000, v101
    v_pk_fma_f32 v[42:43], v[42:43], v[34:35], v[36:37]
    v_cvt_pk_bf16_f32 v101, v42, v43
    v_lshlrev_b32 v40, 16, v102
    v_and_b32 v41, 0xffff0000, v102
    v_pk_fma_f32 v[40:41], v[40:41], v[34:35], v[36:37]
    v_cvt_pk_bf16_f32 v102, v40, v41
    v_lshlrev_b32 v42, 16, v103
    v_and_b32 v43, 0xffff0000, v103
    v_pk_fma_f32 v[42:43], v[42:43], v[34:35], v[36:37]
    v_cvt_pk_bf16_f32 v103, v42, v43
    ds_write_b128 v38, v[100:103] offset:9216
    v_lshlrev_b32 v40, 16, v104
    v_and_b32 v41, 0xffff0000, v104
    v_pk_fma_f32 v[40:41], v[40:41], v[34:35], v[36:37]
    v_cvt_pk_bf16_f32 v104, v40, v41
    v_lshlrev_b32 v42, 16, v105
    v_and_b32 v43, 0xffff0000, v105
    v_pk_fma_f32 v[42:43], v[42:43], v[34:35], v[36:37]
    v_cvt_pk_bf16_f32 v105, v42, v43
    v_lshlrev_b32 v40, 16, v106
    v_and_b32 v41, 0xffff0000, v106
    v_pk_fma_f32 v[40:41], v[40:41], v[34:35], v[36:37]
    v_cvt_pk_bf16_f32 v106, v40, v41
    v_lshlrev_b32 v42, 16, v107
    v_and_b32 v43, 0xffff0000, v107
    v_pk_fma_f32 v[42:43], v[42:43], v[34:35], v[36:37]
    v_cvt_pk_bf16_f32 v107, v42, v43
    ds_write_b128 v38, v[104:107] offset:10240
    v_lshlrev_b32 v40, 16, v108
    v_and_b32 v41, 0xffff0000, v108
    v_pk_fma_f32 v[40:41], v[40:41], v[34:35], v[36:37]
    v_cvt_pk_bf16_f32 v108, v40, v41
    v_lshlrev_b32 v42, 16, v109
    v_and_b32 v43, 0xffff0000, v109
    v_pk_fma_f32 v[42:43], v[42:43], v[34:35], v[36:37]
    v_cvt_pk_bf16_f32 v109, v42, v43
    v_lshlrev_b32 v40, 16, v110
    v_and_b32 v41, 0xffff0000, v110
    v_pk_fma_f32 v[40:41], v[40:41], v[34:35], v[36:37]
    v_cvt_pk_bf16_f32 v110, v40, v41
    v_lshlrev_b32 v42, 16, v111
    v_and_b32 v43, 0xffff0000, v111
    v_pk_fma_f32 v[42:43], v[42:43], v[34:35], v[36:37]
    v_cvt_pk_bf16_f32 v111, v42, v43
    ds_write_b128 v38, v[108:111] offset:11264
    v_lshlrev_b32 v40, 16, v112
    v_and_b32 v41, 0xffff0000, v112
    v_pk_fma_f32 v[40:41], v[40:41], v[34:35], v[36:37]
    v_cvt_pk_bf16_f32 v112, v40, v41
    v_lshlrev_b32 v42, 16, v113
    v_and_b32 v43, 0xffff0000, v113
    v_pk_fma_f32 v[42:43], v[42:43], v[34:35], v[36:37]
    v_cvt_pk_bf16_f32 v113, v42, v43
    v_lshlrev_b32 v40, 16, v114
    v_and_b32 v41, 0xffff0000, v114
    v_pk_fma_f32 v[40:41], v[40:41], v[34:35], v[36:37]
    v_cvt_pk_bf16_f32 v114, v40, v41
    v_lshlrev_b32 v42, 16, v115
    v_and_b32 v43, 0xffff0000, v115
    v_pk_fma_f32 v[42:43], v[42:43], v[34:35], v[36:37]
    v_cvt_pk_bf16_f32 v115, v42, v43
    ds_write_b128 v38, v[112:115] offset:12288
    v_lshlrev_b32 v40, 16, v116
    v_and_b32 v41, 0xffff0000, v116
    v_pk_fma_f32 v[40:41], v[40:41], v[34:35], v[36:37]
    v_cvt_pk_bf16_f32 v116, v40, v41
    v_lshlrev_b32 v42, 16, v117
    v_and_b32 v43, 0xffff0000, v117
    v_pk_fma_f32 v[42:43], v[42:43], v[34:35], v[36:37]
    v_cvt_pk_bf16_f32 v117, v42, v43
    v_lshlrev_b32 v40, 16, v118
    v_and_b32 v41, 0xffff0000, v118
    v_pk_fma_f32 v[40:41], v[40:41], v[34:35], v[36:37]
    v_cvt_pk_bf16_f32 v118, v40, v41
    v_lshlrev_b32 v42, 16, v119
    v_and_b32 v43, 0xffff0000, v119
    v_pk_fma_f32 v[42:43], v[42:43], v[34:35], v[36:37]
    v_cvt_pk_bf16_f32 v119, v42, v43
    ds_write_b128 v38, v[116:119] offset:13312
    s_waitcnt lgkmcnt(0)
    s_barrier
    v_lshlrev_b32 v64, 16, v120
    v_and_b32 v68, 0xffff0000, v120
    v_lshlrev_b32 v72, 16, v121
    v_and_b32 v76, 0xffff0000, v121
    v_lshlrev_b32 v65, 16, v122
    v_and_b32 v69, 0xffff0000, v122
    v_lshlrev_b32 v73, 16, v123
    v_and_b32 v77, 0xffff0000, v123
    v_lshlrev_b32 v66, 16, v124
    v_and_b32 v70, 0xffff0000, v124
    v_lshlrev_b32 v74, 16, v125
    v_and_b32 v78, 0xffff0000, v125
    v_lshlrev_b32 v67, 16, v126
    v_and_b32 v71, 0xffff0000, v126
    v_lshlrev_b32 v75, 16, v127
    v_and_b32 v79, 0xffff0000, v127
    v_mov_b32 v80, v64
    v_mov_b32 v81, v65
    v_mov_b32 v82, v66
    v_mov_b32 v83, v67
    v_mov_b32 v84, v68
    v_mov_b32 v85, v69
    v_mov_b32 v86, v70
    v_mov_b32 v87, v71
    v_mov_b32 v88, v72
    v_mov_b32 v89, v73
    v_mov_b32 v90, v74
    v_mov_b32 v91, v75
    v_mov_b32 v92, v76
    v_mov_b32 v93, v77
    v_mov_b32 v94, v78
    v_mov_b32 v95, v79
    v_mov_b32 v96, v64
    v_mov_b32 v97, v65
    v_mov_b32 v98, v66
    v_mov_b32 v99, v67
    v_mov_b32 v100, v68
    v_mov_b32 v101, v69
    v_mov_b32 v102, v70
    v_mov_b32 v103, v71
    v_mov_b32 v104, v72
    v_mov_b32 v105, v73
    v_mov_b32 v106, v74
    v_mov_b32 v107, v75
    v_mov_b32 v108, v76
    v_mov_b32 v109, v77
    v_mov_b32 v110, v78
    v_mov_b32 v111, v79
    v_mov_b32 v112, v64
    v_mov_b32 v113, v65
    v_mov_b32 v114, v66
    v_mov_b32 v115, v67
    v_mov_b32 v116, v68
    v_mov_b32 v117, v69
    v_mov_b32 v118, v70
    v_mov_b32 v119, v71
    v_mov_b32 v120, v72
    v_mov_b32 v121, v73
    v_mov_b32 v122, v74
    v_mov_b32 v123, v75
    v_mov_b32 v124, v76
    v_mov_b32 v125, v77
    v_mov_b32 v126, v78
    v_mov_b32 v127, v79
    ds_read_b128 v[128:131], v22 offset:0
    ds_read_b128 v[132:135], v22 offset:14336
    ds_read_b128 v[136:139], v22 offset:28672
    ds_read_b128 v[140:143], v22 offset:43008
    s_waitcnt lgkmcnt(0)
    ds_read_b128 v[144:147], v22 offset:1024
    ds_read_b128 v[148:151], v22 offset:15360
    ds_read_b128 v[152:155], v22 offset:29696
    ds_read_b128 v[156:159], v22 offset:44032
    v_mfma_f32_16x16x32_bf16 v[64:67], a[0:3], v[128:131], v[64:67]
    v_mfma_f32_16x16x32_bf16 v[68:71], a[4:7], v[128:131], v[68:71]
    v_mfma_f32_16x16x32_bf16 v[72:75], a[8:11], v[128:131], v[72:75]
    v_mfma_f32_16x16x32_bf16 v[76:79], a[12:15], v[128:131], v[76:79]
    v_mfma_f32_16x16x32_bf16 v[80:83], a[0:3], v[132:135], v[80:83]
    v_mfma_f32_16x16x32_bf16 v[84:87], a[4:7], v[132:135], v[84:87]
    v_mfma_f32_16x16x32_bf16 v[88:91], a[8:11], v[132:135], v[88:91]
    v_mfma_f32_16x16x32_bf16 v[92:95], a[12:15], v[132:135], v[92:95]
    v_mfma_f32_16x16x32_bf16 v[96:99], a[0:3], v[136:139], v[96:99]
    v_mfma_f32_16x16x32_bf16 v[100:103], a[4:7], v[136:139], v[100:103]
    v_mfma_f32_16x16x32_bf16 v[104:107], a[8:11], v[136:139], v[104:107]
    v_mfma_f32_16x16x32_bf16 v[108:111], a[12:15], v[136:139], v[108:111]
    v_mfma_f32_16x16x32_bf16 v[112:115], a[0:3], v[140:143], v[112:115]
    v_mfma_f32_16x16x32_bf16 v[116:119], a[4:7], v[140:143], v[116:119]
    v_mfma_f32_16x16x32_bf16 v[120:123], a[8:11], v[140:143], v[120:123]
    v_mfma_f32_16x16x32_bf16 v[124:127], a[12:15], v[140:143], v[124:127]
    s_waitcnt lgkmcnt(0)
    ds_read_b128 v[128:131], v22 offset:2048
    ds_read_b128 v[132:135], v22 offset:16384
    ds_read_b128 v[136:139], v22 offset:30720
    ds_read_b128 v[140:143], v22 offset:45056
    s_add_u32 s30, s58, 0
    buffer_load_dwordx4 a[0:3], v22, s[68:71], s30 offen offset:0
    v_mfma_f32_16x16x32_bf16 v[64:67], a[16:19], v[144:147], v[64:67]
    v_mfma_f32_16x16x32_bf16 v[68:71], a[20:23], v[144:147], v[68:71]
    v_mfma_f32_16x16x32_bf16 v[72:75], a[24:27], v[144:147], v[72:75]
    v_mfma_f32_16x16x32_bf16 v[76:79], a[28:31], v[144:147], v[76:79]
    buffer_load_dwordx4 a[4:7], v22, s[68:71], s30 offen offset:1024
    v_mfma_f32_16x16x32_bf16 v[80:83], a[16:19], v[148:151], v[80:83]
    v_mfma_f32_16x16x32_bf16 v[84:87], a[20:23], v[148:151], v[84:87]
    v_mfma_f32_16x16x32_bf16 v[88:91], a[24:27], v[148:151], v[88:91]
    v_mfma_f32_16x16x32_bf16 v[92:95], a[28:31], v[148:151], v[92:95]
    buffer_load_dwordx4 a[8:11], v22, s[68:71], s30 offen offset:2048
    v_mfma_f32_16x16x32_bf16 v[96:99], a[16:19], v[152:155], v[96:99]
    v_mfma_f32_16x16x32_bf16 v[100:103], a[20:23], v[152:155], v[100:103]
    v_mfma_f32_16x16x32_bf16 v[104:107], a[24:27], v[152:155], v[104:107]
    v_mfma_f32_16x16x32_bf16 v[108:111], a[28:31], v[152:155], v[108:111]
    buffer_load_dwordx4 a[12:15], v22, s[68:71], s30 offen offset:3072
    v_mfma_f32_16x16x32_bf16 v[112:115], a[16:19], v[156:159], v[112:115]
    v_mfma_f32_16x16x32_bf16 v[116:119], a[20:23], v[156:159], v[116:119]
    v_mfma_f32_16x16x32_bf16 v[120:123], a[24:27], v[156:159], v[120:123]
    v_mfma_f32_16x16x32_bf16 v[124:127], a[28:31], v[156:159], v[124:127]
    s_waitcnt lgkmcnt(0)
    ds_read_b128 v[144:147], v22 offset:3072
    ds_read_b128 v[148:151], v22 offset:17408
    ds_read_b128 v[152:155], v22 offset:31744
    ds_read_b128 v[156:159], v22 offset:46080
    s_add_u32 s30, s58, 4096
    buffer_load_dwordx4 a[16:19], v22, s[68:71], s30 offen offset:0
    v_mfma_f32_16x16x32_bf16 v[64:67], a[32:35], v[128:131], v[64:67]
    v_mfma_f32_16x16x32_bf16 v[68:71], a[36:39], v[128:131], v[68:71]
    v_mfma_f32_16x16x32_bf16 v[72:75], a[40:43], v[128:131], v[72:75]
    v_mfma_f32_16x16x32_bf16 v[76:79], a[44:47], v[128:131], v[76:79]
    buffer_load_dwordx4 a[20:23], v22, s[68:71], s30 offen offset:1024
    v_mfma_f32_16x16x32_bf16 v[80:83], a[32:35], v[132:135], v[80:83]
    v_mfma_f32_16x16x32_bf16 v[84:87], a[36:39], v[132:135], v[84:87]
    v_mfma_f32_16x16x32_bf16 v[88:91], a[40:43], v[132:135], v[88:91]
    v_mfma_f32_16x16x32_bf16 v[92:95], a[44:47], v[132:135], v[92:95]
    buffer_load_dwordx4 a[24:27], v22, s[68:71], s30 offen offset:2048
    v_mfma_f32_16x16x32_bf16 v[96:99], a[32:35], v[136:139], v[96:99]
    v_mfma_f32_16x16x32_bf16 v[100:103], a[36:39], v[136:139], v[100:103]
    v_mfma_f32_16x16x32_bf16 v[104:107], a[40:43], v[136:139], v[104:107]
    v_mfma_f32_16x16x32_bf16 v[108:111], a[44:47], v[136:139], v[108:111]
    buffer_load_dwordx4 a[28:31], v22, s[68:71], s30 offen offset:3072
    v_mfma_f32_16x16x32_bf16 v[112:115], a[32:35], v[140:143], v[112:115]
    v_mfma_f32_16x16x32_bf16 v[116:119], a[36:39], v[140:143], v[116:119]
    v_mfma_f32_16x16x32_bf16 v[120:123], a[40:43], v[140:143], v[120:123]
    v_mfma_f32_16x16x32_bf16 v[124:127], a[44:47], v[140:143], v[124:127]
    s_waitcnt lgkmcnt(0)
    ds_read_b128 v[128:131], v22 offset:4096
    ds_read_b128 v[132:135], v22 offset:18432
    ds_read_b128 v[136:139], v22 offset:32768
    ds_read_b128 v[140:143], v22 offset:47104
    s_add_u32 s30, s58, 8192
    buffer_load_dwordx4 a[32:35], v22, s[68:71], s30 offen offset:0
    v_mfma_f32_16x16x32_bf16 v[64:67], a[48:51], v[144:147], v[64:67]
    v_mfma_f32_16x16x32_bf16 v[68:71], a[52:55], v[144:147], v[68:71]
    v_mfma_f32_16x16x32_bf16 v[72:75], a[56:59], v[144:147], v[72:75]
    v_mfma_f32_16x16x32_bf16 v[76:79], a[60:63], v[144:147], v[76:79]
    buffer_load_dwordx4 a[36:39], v22, s[68:71], s30 offen offset:1024
    v_mfma_f32_16x16x32_bf16 v[80:83], a[48:51], v[148:151], v[80:83]
    v_mfma_f32_16x16x32_bf16 v[84:87], a[52:55], v[148:151], v[84:87]
    v_mfma_f32_16x16x32_bf16 v[88:91], a[56:59], v[148:151], v[88:91]
    v_mfma_f32_16x16x32_bf16 v[92:95], a[60:63], v[148:151], v[92:95]
    buffer_load_dwordx4 a[40:43], v22, s[68:71], s30 offen offset:2048
    v_mfma_f32_16x16x32_bf16 v[96:99], a[48:51], v[152:155], v[96:99]
    v_mfma_f32_16x16x32_bf16 v[100:103], a[52:55], v[152:155], v[100:103]
    v_mfma_f32_16x16x32_bf16 v[104:107], a[56:59], v[152:155], v[104:107]
    v_mfma_f32_16x16x32_bf16 v[108:111], a[60:63], v[152:155], v[108:111]
    buffer_load_dwordx4 a[44:47], v22, s[68:71], s30 offen offset:3072
    v_mfma_f32_16x16x32_bf16 v[112:115], a[48:51], v[156:159], v[112:115]
    v_mfma_f32_16x16x32_bf16 v[116:119], a[52:55], v[156:159], v[116:119]
    v_mfma_f32_16x16x32_bf16 v[120:123], a[56:59], v[156:159], v[120:123]
    v_mfma_f32_16x16x32_bf16 v[124:127], a[60:63], v[156:159], v[124:127]
    s_waitcnt lgkmcnt(0)
    ds_read_b128 v[144:147], v22 offset:5120
    ds_read_b128 v[148:151], v22 offset:19456
    ds_read_b128 v[152:155], v22 offset:33792
    ds_read_b128 v[156:159], v22 offset:48128
    s_add_u32 s30, s58, 12288
    buffer_load_dwordx4 a[48:51], v22, s[68:71], s30 offen offset:0
    v_mfma_f32_16x16x32_bf16 v[64:67], a[64:67], v[128:131], v[64:67]
    v_mfma_f32_16x16x32_bf16 v[68:71], a[68:71], v[128:131], v[68:71]
    v_mfma_f32_16x16x32_bf16 v[72:75], a[72:75], v[128:131], v[72:75]
    v_mfma_f32_16x16x32_bf16 v[76:79], a[76:79], v[128:131], v[76:79]
    buffer_load_dwordx4 a[52:55], v22, s[68:71], s30 offen offset:1024
    v_mfma_f32_16x16x32_bf16 v[80:83], a[64:67], v[132:135], v[80:83]
    v_mfma_f32_16x16x32_bf16 v[84:87], a[68:71], v[132:135], v[84:87]
    v_mfma_f32_16x16x32_bf16 v[88:91], a[72:75], v[132:135], v[88:91]
    v_mfma_f32_16x16x32_bf16 v[92:95], a[76:79], v[132:135], v[92:95]
    buffer_load_dwordx4 a[56:59], v22, s[68:71], s30 offen offset:2048
    v_mfma_f32_16x16x32_bf16 v[96:99], a[64:67], v[136:139], v[96:99]
    v_mfma_f32_16x16x32_bf16 v[100:103], a[68:71], v[136:139], v[100:103]
    v_mfma_f32_16x16x32_bf16 v[104:107], a[72:75], v[136:139], v[104:107]
    v_mfma_f32_16x16x32_bf16 v[108:111], a[76:79], v[136:139], v[108:111]
    buffer_load_dwordx4 a[60:63], v22, s[68:71], s30 offen offset:3072
    v_mfma_f32_16x16x32_bf16 v[112:115], a[64:67], v[140:143], v[112:115]
    v_mfma_f32_16x16x32_bf16 v[116:119], a[68:71], v[140:143], v[116:119]
    v_mfma_f32_16x16x32_bf16 v[120:123], a[72:75], v[140:143], v[120:123]
    v_mfma_f32_16x16x32_bf16 v[124:127], a[76:79], v[140:143], v[124:127]
    s_waitcnt lgkmcnt(0)
    ds_read_b128 v[128:131], v22 offset:6144
    ds_read_b128 v[132:135], v22 offset:20480
    ds_read_b128 v[136:139], v22 offset:34816
    ds_read_b128 v[140:143], v22 offset:49152
    s_add_u32 s30, s58, 16384
    buffer_load_dwordx4 a[64:67], v22, s[68:71], s30 offen offset:0
    v_mfma_f32_16x16x32_bf16 v[64:67], a[80:83], v[144:147], v[64:67]
    v_mfma_f32_16x16x32_bf16 v[68:71], a[84:87], v[144:147], v[68:71]
    v_mfma_f32_16x16x32_bf16 v[72:75], a[88:91], v[144:147], v[72:75]
    v_mfma_f32_16x16x32_bf16 v[76:79], a[92:95], v[144:147], v[76:79]
    buffer_load_dwordx4 a[68:71], v22, s[68:71], s30 offen offset:1024
    v_mfma_f32_16x16x32_bf16 v[80:83], a[80:83], v[148:151], v[80:83]
    v_mfma_f32_16x16x32_bf16 v[84:87], a[84:87], v[148:151], v[84:87]
    v_mfma_f32_16x16x32_bf16 v[88:91], a[88:91], v[148:151], v[88:91]
    v_mfma_f32_16x16x32_bf16 v[92:95], a[92:95], v[148:151], v[92:95]
    buffer_load_dwordx4 a[72:75], v22, s[68:71], s30 offen offset:2048
    v_mfma_f32_16x16x32_bf16 v[96:99], a[80:83], v[152:155], v[96:99]
    v_mfma_f32_16x16x32_bf16 v[100:103], a[84:87], v[152:155], v[100:103]
    v_mfma_f32_16x16x32_bf16 v[104:107], a[88:91], v[152:155], v[104:107]
    v_mfma_f32_16x16x32_bf16 v[108:111], a[92:95], v[152:155], v[108:111]
    buffer_load_dwordx4 a[76:79], v22, s[68:71], s30 offen offset:3072
    v_mfma_f32_16x16x32_bf16 v[112:115], a[80:83], v[156:159], v[112:115]
    v_mfma_f32_16x16x32_bf16 v[116:119], a[84:87], v[156:159], v[116:119]
    v_mfma_f32_16x16x32_bf16 v[120:123], a[88:91], v[156:159], v[120:123]
    v_mfma_f32_16x16x32_bf16 v[124:127], a[92:95], v[156:159], v[124:127]
    s_waitcnt lgkmcnt(0)
    ds_read_b128 v[144:147], v22 offset:7168
    ds_read_b128 v[148:151], v22 offset:21504
    ds_read_b128 v[152:155], v22 offset:35840
    ds_read_b128 v[156:159], v22 offset:50176
    s_add_u32 s30, s58, 20480
    buffer_load_dwordx4 a[80:83], v22, s[68:71], s30 offen offset:0
    v_mfma_f32_16x16x32_bf16 v[64:67], a[96:99], v[128:131], v[64:67]
    v_mfma_f32_16x16x32_bf16 v[68:71], a[100:103], v[128:131], v[68:71]
    v_mfma_f32_16x16x32_bf16 v[72:75], a[104:107], v[128:131], v[72:75]
    v_mfma_f32_16x16x32_bf16 v[76:79], a[108:111], v[128:131], v[76:79]
    buffer_load_dwordx4 a[84:87], v22, s[68:71], s30 offen offset:1024
    v_mfma_f32_16x16x32_bf16 v[80:83], a[96:99], v[132:135], v[80:83]
    v_mfma_f32_16x16x32_bf16 v[84:87], a[100:103], v[132:135], v[84:87]
    v_mfma_f32_16x16x32_bf16 v[88:91], a[104:107], v[132:135], v[88:91]
    v_mfma_f32_16x16x32_bf16 v[92:95], a[108:111], v[132:135], v[92:95]
    buffer_load_dwordx4 a[88:91], v22, s[68:71], s30 offen offset:2048
    v_mfma_f32_16x16x32_bf16 v[96:99], a[96:99], v[136:139], v[96:99]
    v_mfma_f32_16x16x32_bf16 v[100:103], a[100:103], v[136:139], v[100:103]
    v_mfma_f32_16x16x32_bf16 v[104:107], a[104:107], v[136:139], v[104:107]
    v_mfma_f32_16x16x32_bf16 v[108:111], a[108:111], v[136:139], v[108:111]
    buffer_load_dwordx4 a[92:95], v22, s[68:71], s30 offen offset:3072
    v_mfma_f32_16x16x32_bf16 v[112:115], a[96:99], v[140:143], v[112:115]
    v_mfma_f32_16x16x32_bf16 v[116:119], a[100:103], v[140:143], v[116:119]
    v_mfma_f32_16x16x32_bf16 v[120:123], a[104:107], v[140:143], v[120:123]
    v_mfma_f32_16x16x32_bf16 v[124:127], a[108:111], v[140:143], v[124:127]
    s_waitcnt lgkmcnt(0)
    ds_read_b128 v[128:131], v22 offset:8192
    ds_read_b128 v[132:135], v22 offset:22528
    ds_read_b128 v[136:139], v22 offset:36864
    ds_read_b128 v[140:143], v22 offset:51200
    s_add_u32 s30, s58, 24576
    buffer_load_dwordx4 a[96:99], v22, s[68:71], s30 offen offset:0
    v_mfma_f32_16x16x32_bf16 v[64:67], a[112:115], v[144:147], v[64:67]
    v_mfma_f32_16x16x32_bf16 v[68:71], a[116:119], v[144:147], v[68:71]
    v_mfma_f32_16x16x32_bf16 v[72:75], a[120:123], v[144:147], v[72:75]
    v_mfma_f32_16x16x32_bf16 v[76:79], a[124:127], v[144:147], v[76:79]
    buffer_load_dwordx4 a[100:103], v22, s[68:71], s30 offen offset:1024
    v_mfma_f32_16x16x32_bf16 v[80:83], a[112:115], v[148:151], v[80:83]
    v_mfma_f32_16x16x32_bf16 v[84:87], a[116:119], v[148:151], v[84:87]
    v_mfma_f32_16x16x32_bf16 v[88:91], a[120:123], v[148:151], v[88:91]
    v_mfma_f32_16x16x32_bf16 v[92:95], a[124:127], v[148:151], v[92:95]
    buffer_load_dwordx4 a[104:107], v22, s[68:71], s30 offen offset:2048
    v_mfma_f32_16x16x32_bf16 v[96:99], a[112:115], v[152:155], v[96:99]
    v_mfma_f32_16x16x32_bf16 v[100:103], a[116:119], v[152:155], v[100:103]
    v_mfma_f32_16x16x32_bf16 v[104:107], a[120:123], v[152:155], v[104:107]
    v_mfma_f32_16x16x32_bf16 v[108:111], a[124:127], v[152:155], v[108:111]
    buffer_load_dwordx4 a[108:111], v22, s[68:71], s30 offen offset:3072
    v_mfma_f32_16x16x32_bf16 v[112:115], a[112:115], v[156:159], v[112:115]
    v_mfma_f32_16x16x32_bf16 v[116:119], a[116:119], v[156:159], v[116:119]
    v_mfma_f32_16x16x32_bf16 v[120:123], a[120:123], v[156:159], v[120:123]
    v_mfma_f32_16x16x32_bf16 v[124:127], a[124:127], v[156:159], v[124:127]
    s_waitcnt lgkmcnt(0)
    ds_read_b128 v[144:147], v22 offset:9216
    ds_read_b128 v[148:151], v22 offset:23552
    ds_read_b128 v[152:155], v22 offset:37888
    ds_read_b128 v[156:159], v22 offset:52224
    s_add_u32 s30, s58, 28672
    buffer_load_dwordx4 a[112:115], v22, s[68:71], s30 offen offset:0
    v_mfma_f32_16x16x32_bf16 v[64:67], a[128:131], v[128:131], v[64:67]
    v_mfma_f32_16x16x32_bf16 v[68:71], a[132:135], v[128:131], v[68:71]
    v_mfma_f32_16x16x32_bf16 v[72:75], a[136:139], v[128:131], v[72:75]
    v_mfma_f32_16x16x32_bf16 v[76:79], a[140:143], v[128:131], v[76:79]
    buffer_load_dwordx4 a[116:119], v22, s[68:71], s30 offen offset:1024
    v_mfma_f32_16x16x32_bf16 v[80:83], a[128:131], v[132:135], v[80:83]
    v_mfma_f32_16x16x32_bf16 v[84:87], a[132:135], v[132:135], v[84:87]
    v_mfma_f32_16x16x32_bf16 v[88:91], a[136:139], v[132:135], v[88:91]
    v_mfma_f32_16x16x32_bf16 v[92:95], a[140:143], v[132:135], v[92:95]
    buffer_load_dwordx4 a[120:123], v22, s[68:71], s30 offen offset:2048
    v_mfma_f32_16x16x32_bf16 v[96:99], a[128:131], v[136:139], v[96:99]
    v_mfma_f32_16x16x32_bf16 v[100:103], a[132:135], v[136:139], v[100:103]
    v_mfma_f32_16x16x32_bf16 v[104:107], a[136:139], v[136:139], v[104:107]
    v_mfma_f32_16x16x32_bf16 v[108:111], a[140:143], v[136:139], v[108:111]
    buffer_load_dwordx4 a[124:127], v22, s[68:71], s30 offen offset:3072
    v_mfma_f32_16x16x32_bf16 v[112:115], a[128:131], v[140:143], v[112:115]
    v_mfma_f32_16x16x32_bf16 v[116:119], a[132:135], v[140:143], v[116:119]
    v_mfma_f32_16x16x32_bf16 v[120:123], a[136:139], v[140:143], v[120:123]
    v_mfma_f32_16x16x32_bf16 v[124:127], a[140:143], v[140:143], v[124:127]
    s_waitcnt lgkmcnt(0)
    ds_read_b128 v[128:131], v22 offset:10240
    ds_read_b128 v[132:135], v22 offset:24576
    ds_read_b128 v[136:139], v22 offset:38912
    ds_read_b128 v[140:143], v22 offset:53248
    s_add_u32 s30, s58, 32768
    buffer_load_dwordx4 a[128:131], v22, s[68:71], s30 offen offset:0
    v_mfma_f32_16x16x32_bf16 v[64:67], a[144:147], v[144:147], v[64:67]
    v_mfma_f32_16x16x32_bf16 v[68:71], a[148:151], v[144:147], v[68:71]
    v_mfma_f32_16x16x32_bf16 v[72:75], a[152:155], v[144:147], v[72:75]
    v_mfma_f32_16x16x32_bf16 v[76:79], a[156:159], v[144:147], v[76:79]
    buffer_load_dwordx4 a[132:135], v22, s[68:71], s30 offen offset:1024
    v_mfma_f32_16x16x32_bf16 v[80:83], a[144:147], v[148:151], v[80:83]
    v_mfma_f32_16x16x32_bf16 v[84:87], a[148:151], v[148:151], v[84:87]
    v_mfma_f32_16x16x32_bf16 v[88:91], a[152:155], v[148:151], v[88:91]
    v_mfma_f32_16x16x32_bf16 v[92:95], a[156:159], v[148:151], v[92:95]
    buffer_load_dwordx4 a[136:139], v22, s[68:71], s30 offen offset:2048
    v_mfma_f32_16x16x32_bf16 v[96:99], a[144:147], v[152:155], v[96:99]
    v_mfma_f32_16x16x32_bf16 v[100:103], a[148:151], v[152:155], v[100:103]
    v_mfma_f32_16x16x32_bf16 v[104:107], a[152:155], v[152:155], v[104:107]
    v_mfma_f32_16x16x32_bf16 v[108:111], a[156:159], v[152:155], v[108:111]
    buffer_load_dwordx4 a[140:143], v22, s[68:71], s30 offen offset:3072
    v_mfma_f32_16x16x32_bf16 v[112:115], a[144:147], v[156:159], v[112:115]
    v_mfma_f32_16x16x32_bf16 v[116:119], a[148:151], v[156:159], v[116:119]
    v_mfma_f32_16x16x32_bf16 v[120:123], a[152:155], v[156:159], v[120:123]
    v_mfma_f32_16x16x32_bf16 v[124:127], a[156:159], v[156:159], v[124:127]
    s_waitcnt lgkmcnt(0)
    ds_read_b128 v[144:147], v22 offset:11264
    ds_read_b128 v[148:151], v22 offset:25600
    ds_read_b128 v[152:155], v22 offset:39936
    ds_read_b128 v[156:159], v22 offset:54272
    s_add_u32 s30, s58, 36864
    buffer_load_dwordx4 a[144:147], v22, s[68:71], s30 offen offset:0
    v_mfma_f32_16x16x32_bf16 v[64:67], a[160:163], v[128:131], v[64:67]
    v_mfma_f32_16x16x32_bf16 v[68:71], a[164:167], v[128:131], v[68:71]
    v_mfma_f32_16x16x32_bf16 v[72:75], a[168:171], v[128:131], v[72:75]
    v_mfma_f32_16x16x32_bf16 v[76:79], a[172:175], v[128:131], v[76:79]
    buffer_load_dwordx4 a[148:151], v22, s[68:71], s30 offen offset:1024
    v_mfma_f32_16x16x32_bf16 v[80:83], a[160:163], v[132:135], v[80:83]
    v_mfma_f32_16x16x32_bf16 v[84:87], a[164:167], v[132:135], v[84:87]
    v_mfma_f32_16x16x32_bf16 v[88:91], a[168:171], v[132:135], v[88:91]
    v_mfma_f32_16x16x32_bf16 v[92:95], a[172:175], v[132:135], v[92:95]
    buffer_load_dwordx4 a[152:155], v22, s[68:71], s30 offen offset:2048
    v_mfma_f32_16x16x32_bf16 v[96:99], a[160:163], v[136:139], v[96:99]
    v_mfma_f32_16x16x32_bf16 v[100:103], a[164:167], v[136:139], v[100:103]
    v_mfma_f32_16x16x32_bf16 v[104:107], a[168:171], v[136:139], v[104:107]
    v_mfma_f32_16x16x32_bf16 v[108:111], a[172:175], v[136:139], v[108:111]
    buffer_load_dwordx4 a[156:159], v22, s[68:71], s30 offen offset:3072
    v_mfma_f32_16x16x32_bf16 v[112:115], a[160:163], v[140:143], v[112:115]
    v_mfma_f32_16x16x32_bf16 v[116:119], a[164:167], v[140:143], v[116:119]
    v_mfma_f32_16x16x32_bf16 v[120:123], a[168:171], v[140:143], v[120:123]
    v_mfma_f32_16x16x32_bf16 v[124:127], a[172:175], v[140:143], v[124:127]
    s_waitcnt lgkmcnt(0)
    ds_read_b128 v[128:131], v22 offset:12288
    ds_read_b128 v[132:135], v22 offset:26624
    ds_read_b128 v[136:139], v22 offset:40960
    ds_read_b128 v[140:143], v22 offset:55296
    s_add_u32 s30, s58, 40960
    buffer_load_dwordx4 a[160:163], v22, s[68:71], s30 offen offset:0
    v_mfma_f32_16x16x32_bf16 v[64:67], a[176:179], v[144:147], v[64:67]
    v_mfma_f32_16x16x32_bf16 v[68:71], a[180:183], v[144:147], v[68:71]
    v_mfma_f32_16x16x32_bf16 v[72:75], a[184:187], v[144:147], v[72:75]
    v_mfma_f32_16x16x32_bf16 v[76:79], a[188:191], v[144:147], v[76:79]
    buffer_load_dwordx4 a[164:167], v22, s[68:71], s30 offen offset:1024
    v_mfma_f32_16x16x32_bf16 v[80:83], a[176:179], v[148:151], v[80:83]
    v_mfma_f32_16x16x32_bf16 v[84:87], a[180:183], v[148:151], v[84:87]
    v_mfma_f32_16x16x32_bf16 v[88:91], a[184:187], v[148:151], v[88:91]
    v_mfma_f32_16x16x32_bf16 v[92:95], a[188:191], v[148:151], v[92:95]
    buffer_load_dwordx4 a[168:171], v22, s[68:71], s30 offen offset:2048
    v_mfma_f32_16x16x32_bf16 v[96:99], a[176:179], v[152:155], v[96:99]
    v_mfma_f32_16x16x32_bf16 v[100:103], a[180:183], v[152:155], v[100:103]
    v_mfma_f32_16x16x32_bf16 v[104:107], a[184:187], v[152:155], v[104:107]
    v_mfma_f32_16x16x32_bf16 v[108:111], a[188:191], v[152:155], v[108:111]
    buffer_load_dwordx4 a[172:175], v22, s[68:71], s30 offen offset:3072
    v_mfma_f32_16x16x32_bf16 v[112:115], a[176:179], v[156:159], v[112:115]
    v_mfma_f32_16x16x32_bf16 v[116:119], a[180:183], v[156:159], v[116:119]
    v_mfma_f32_16x16x32_bf16 v[120:123], a[184:187], v[156:159], v[120:123]
    v_mfma_f32_16x16x32_bf16 v[124:127], a[188:191], v[156:159], v[124:127]
    s_waitcnt lgkmcnt(0)
    ds_read_b128 v[144:147], v22 offset:13312
    ds_read_b128 v[148:151], v22 offset:27648
    ds_read_b128 v[152:155], v22 offset:41984
    ds_read_b128 v[156:159], v22 offset:56320
    s_add_u32 s30, s58, 45056
    buffer_load_dwordx4 a[176:179], v22, s[68:71], s30 offen offset:0
    v_mfma_f32_16x16x32_bf16 v[64:67], a[192:195], v[128:131], v[64:67]
    v_mfma_f32_16x16x32_bf16 v[68:71], a[196:199], v[128:131], v[68:71]
    v_mfma_f32_16x16x32_bf16 v[72:75], a[200:203], v[128:131], v[72:75]
    v_mfma_f32_16x16x32_bf16 v[76:79], a[204:207], v[128:131], v[76:79]
    buffer_load_dwordx4 a[180:183], v22, s[68:71], s30 offen offset:1024
    v_mfma_f32_16x16x32_bf16 v[80:83], a[192:195], v[132:135], v[80:83]
    v_mfma_f32_16x16x32_bf16 v[84:87], a[196:199], v[132:135], v[84:87]
    v_mfma_f32_16x16x32_bf16 v[88:91], a[200:203], v[132:135], v[88:91]
    v_mfma_f32_16x16x32_bf16 v[92:95], a[204:207], v[132:135], v[92:95]
    buffer_load_dwordx4 a[184:187], v22, s[68:71], s30 offen offset:2048
    v_mfma_f32_16x16x32_bf16 v[96:99], a[192:195], v[136:139], v[96:99]
    v_mfma_f32_16x16x32_bf16 v[100:103], a[196:199], v[136:139], v[100:103]
    v_mfma_f32_16x16x32_bf16 v[104:107], a[200:203], v[136:139], v[104:107]
    v_mfma_f32_16x16x32_bf16 v[108:111], a[204:207], v[136:139], v[108:111]
    buffer_load_dwordx4 a[188:191], v22, s[68:71], s30 offen offset:3072
    v_mfma_f32_16x16x32_bf16 v[112:115], a[192:195], v[140:143], v[112:115]
    v_mfma_f32_16x16x32_bf16 v[116:119], a[196:199], v[140:143], v[116:119]
    v_mfma_f32_16x16x32_bf16 v[120:123], a[200:203], v[140:143], v[120:123]
    v_mfma_f32_16x16x32_bf16 v[124:127], a[204:207], v[140:143], v[124:127]
    s_waitcnt lgkmcnt(0)
    s_add_u32 s30, s58, 49152
    buffer_load_dwordx4 a[192:195], v22, s[68:71], s30 offen offset:0
    v_mfma_f32_16x16x32_bf16 v[64:67], a[208:211], v[144:147], v[64:67]
    v_mfma_f32_16x16x32_bf16 v[68:71], a[212:215], v[144:147], v[68:71]
    v_mfma_f32_16x16x32_bf16 v[72:75], a[216:219], v[144:147], v[72:75]
    v_mfma_f32_16x16x32_bf16 v[76:79], a[220:223], v[144:147], v[76:79]
    buffer_load_dwordx4 a[196:199], v22, s[68:71], s30 offen offset:1024
    v_mfma_f32_16x16x32_bf16 v[80:83], a[208:211], v[148:151], v[80:83]
    v_mfma_f32_16x16x32_bf16 v[84:87], a[212:215], v[148:151], v[84:87]
    v_mfma_f32_16x16x32_bf16 v[88:91], a[216:219], v[148:151], v[88:91]
    v_mfma_f32_16x16x32_bf16 v[92:95], a[220:223], v[148:151], v[92:95]
    buffer_load_dwordx4 a[200:203], v22, s[68:71], s30 offen offset:2048
    v_mfma_f32_16x16x32_bf16 v[96:99], a[208:211], v[152:155], v[96:99]
    v_mfma_f32_16x16x32_bf16 v[100:103], a[212:215], v[152:155], v[100:103]
    v_mfma_f32_16x16x32_bf16 v[104:107], a[216:219], v[152:155], v[104:107]
    v_mfma_f32_16x16x32_bf16 v[108:111], a[220:223], v[152:155], v[108:111]
    buffer_load_dwordx4 a[204:207], v22, s[68:71], s30 offen offset:3072
    v_mfma_f32_16x16x32_bf16 v[112:115], a[208:211], v[156:159], v[112:115]
    v_mfma_f32_16x16x32_bf16 v[116:119], a[212:215], v[156:159], v[116:119]
    v_mfma_f32_16x16x32_bf16 v[120:123], a[216:219], v[156:159], v[120:123]
    v_mfma_f32_16x16x32_bf16 v[124:127], a[220:223], v[156:159], v[124:127]
    s_nop 7
    s_add_u32 s30, s58, 53248
    buffer_load_dwordx4 a[208:211], v22, s[68:71], s30 offen offset:0
    buffer_load_dwordx4 a[212:215], v22, s[68:71], s30 offen offset:1024
    buffer_load_dwordx4 a[216:219], v22, s[68:71], s30 offen offset:2048
    buffer_load_dwordx4 a[220:223], v22, s[68:71], s30 offen offset:3072
    v_mov_b32 v16, 0xc0135761
    v_mov_b32 v17, v16
    v_mov_b32 v18, 0xbdd2d3e8
    v_mov_b32 v19, v18
    v_mov_b32 v4, 1.0
    v_mov_b32 v5, 1.0
    s_lshl_b32 s40, s31, 2
    s_mul_i32 s40, s40, 57344
    s_lshl_b32 s41, s34, 11
    s_add_u32 s43, s40, s41
    v_pk_mul_f32 v[24:25], v[64:65], v[64:65]
    v_pk_mul_f32 v[26:27], v[66:67], v[66:67]
    v_pk_mul_f32 v[28:29], v[68:69], v[68:69]
    v_pk_mul_f32 v[30:31], v[70:71], v[70:71]
    v_pk_fma_f32 v[24:25], v[24:25], v[18:19], v[16:17]
    v_pk_fma_f32 v[26:27], v[26:27], v[18:19], v[16:17]
    v_pk_fma_f32 v[28:29], v[28:29], v[18:19], v[16:17]
    v_pk_fma_f32 v[30:31], v[30:31], v[18:19], v[16:17]
    v_pk_mul_f32 v[24:25], v[24:25], v[64:65]
    v_pk_mul_f32 v[26:27], v[26:27], v[66:67]
    v_pk_mul_f32 v[28:29], v[28:29], v[68:69]
    v_pk_mul_f32 v[30:31], v[30:31], v[70:71]
    v_exp_f32 v24, v24
    v_exp_f32 v25, v25
    v_exp_f32 v26, v26
    v_exp_f32 v27, v27
    v_exp_f32 v28, v28
    v_exp_f32 v29, v29
    v_exp_f32 v30, v30
    v_exp_f32 v31, v31
    v_pk_add_f32 v[24:25], v[24:25], v[4:5]
    v_pk_add_f32 v[26:27], v[26:27], v[4:5]
    v_pk_add_f32 v[28:29], v[28:29], v[4:5]
    v_pk_add_f32 v[30:31], v[30:31], v[4:5]
    v_rcp_f32 v24, v24
    v_rcp_f32 v25, v25
    v_rcp_f32 v26, v26
    v_rcp_f32 v27, v27
    v_rcp_f32 v28, v28
    v_rcp_f32 v29, v29
    v_rcp_f32 v30, v30
    v_rcp_f32 v31, v31
    v_pk_mul_f32 v[64:65], v[64:65], v[24:25]
    v_pk_mul_f32 v[66:67], v[66:67], v[26:27]
    v_pk_mul_f32 v[68:69], v[68:69], v[28:29]
    v_pk_mul_f32 v[70:71], v[70:71], v[30:31]
    v_pk_mul_f32 v[24:25], v[72:73], v[72:73]
    v_pk_mul_f32 v[26:27], v[74:75], v[74:75]
    v_pk_mul_f32 v[28:29], v[76:77], v[76:77]
    v_pk_mul_f32 v[30:31], v[78:79], v[78:79]
    v_pk_fma_f32 v[24:25], v[24:25], v[18:19], v[16:17]
    v_pk_fma_f32 v[26:27], v[26:27], v[18:19], v[16:17]
    v_pk_fma_f32 v[28:29], v[28:29], v[18:19], v[16:17]
    v_pk_fma_f32 v[30:31], v[30:31], v[18:19], v[16:17]
    v_pk_mul_f32 v[24:25], v[24:25], v[72:73]
    v_pk_mul_f32 v[26:27], v[26:27], v[74:75]
    v_pk_mul_f32 v[28:29], v[28:29], v[76:77]
    v_pk_mul_f32 v[30:31], v[30:31], v[78:79]
    v_exp_f32 v24, v24
    v_exp_f32 v25, v25
    v_exp_f32 v26, v26
    v_exp_f32 v27, v27
    v_exp_f32 v28, v28
    v_exp_f32 v29, v29
    v_exp_f32 v30, v30
    v_exp_f32 v31, v31
    v_pk_add_f32 v[24:25], v[24:25], v[4:5]
    v_pk_add_f32 v[26:27], v[26:27], v[4:5]
    v_pk_add_f32 v[28:29], v[28:29], v[4:5]
    v_pk_add_f32 v[30:31], v[30:31], v[4:5]
    v_rcp_f32 v24, v24
    v_rcp_f32 v25, v25
    v_rcp_f32 v26, v26
    v_rcp_f32 v27, v27
    v_rcp_f32 v28, v28
    v_rcp_f32 v29, v29
    v_rcp_f32 v30, v30
    v_rcp_f32 v31, v31
    v_pk_mul_f32 v[72:73], v[72:73], v[24:25]
    v_pk_mul_f32 v[74:75], v[74:75], v[26:27]
    v_pk_mul_f32 v[76:77], v[76:77], v[28:29]
    v_pk_mul_f32 v[78:79], v[78:79], v[30:31]
    v_cvt_pk_bf16_f32 v32, v64, v68
    v_cvt_pk_bf16_f32 v33, v72, v76
    v_cvt_pk_bf16_f32 v34, v65, v69
    v_cvt_pk_bf16_f32 v35, v73, v77
    buffer_store_dwordx4 v[32:35], v22, s[72:75], s43 offen offset:0 sc1
    v_cvt_pk_bf16_f32 v36, v66, v70
    v_cvt_pk_bf16_f32 v37, v74, v78
    v_cvt_pk_bf16_f32 v38, v67, v71
    v_cvt_pk_bf16_f32 v39, v75, v79
    buffer_store_dwordx4 v[36:39], v22, s[72:75], s43 offen offset:1024 sc1
    s_add_u32 s43, s43, 57344
    v_pk_mul_f32 v[24:25], v[80:81], v[80:81]
    v_pk_mul_f32 v[26:27], v[82:83], v[82:83]
    v_pk_mul_f32 v[28:29], v[84:85], v[84:85]
    v_pk_mul_f32 v[30:31], v[86:87], v[86:87]
    v_pk_fma_f32 v[24:25], v[24:25], v[18:19], v[16:17]
    v_pk_fma_f32 v[26:27], v[26:27], v[18:19], v[16:17]
    v_pk_fma_f32 v[28:29], v[28:29], v[18:19], v[16:17]
    v_pk_fma_f32 v[30:31], v[30:31], v[18:19], v[16:17]
    v_pk_mul_f32 v[24:25], v[24:25], v[80:81]
    v_pk_mul_f32 v[26:27], v[26:27], v[82:83]
    v_pk_mul_f32 v[28:29], v[28:29], v[84:85]
    v_pk_mul_f32 v[30:31], v[30:31], v[86:87]
    v_exp_f32 v24, v24
    v_exp_f32 v25, v25
    v_exp_f32 v26, v26
    v_exp_f32 v27, v27
    v_exp_f32 v28, v28
    v_exp_f32 v29, v29
    v_exp_f32 v30, v30
    v_exp_f32 v31, v31
    v_pk_add_f32 v[24:25], v[24:25], v[4:5]
    v_pk_add_f32 v[26:27], v[26:27], v[4:5]
    v_pk_add_f32 v[28:29], v[28:29], v[4:5]
    v_pk_add_f32 v[30:31], v[30:31], v[4:5]
    v_rcp_f32 v24, v24
    v_rcp_f32 v25, v25
    v_rcp_f32 v26, v26
    v_rcp_f32 v27, v27
    v_rcp_f32 v28, v28
    v_rcp_f32 v29, v29
    v_rcp_f32 v30, v30
    v_rcp_f32 v31, v31
    v_pk_mul_f32 v[80:81], v[80:81], v[24:25]
    v_pk_mul_f32 v[82:83], v[82:83], v[26:27]
    v_pk_mul_f32 v[84:85], v[84:85], v[28:29]
    v_pk_mul_f32 v[86:87], v[86:87], v[30:31]
    v_pk_mul_f32 v[24:25], v[88:89], v[88:89]
    v_pk_mul_f32 v[26:27], v[90:91], v[90:91]
    v_pk_mul_f32 v[28:29], v[92:93], v[92:93]
    v_pk_mul_f32 v[30:31], v[94:95], v[94:95]
    v_pk_fma_f32 v[24:25], v[24:25], v[18:19], v[16:17]
    v_pk_fma_f32 v[26:27], v[26:27], v[18:19], v[16:17]
    v_pk_fma_f32 v[28:29], v[28:29], v[18:19], v[16:17]
    v_pk_fma_f32 v[30:31], v[30:31], v[18:19], v[16:17]
    v_pk_mul_f32 v[24:25], v[24:25], v[88:89]
    v_pk_mul_f32 v[26:27], v[26:27], v[90:91]
    v_pk_mul_f32 v[28:29], v[28:29], v[92:93]
    v_pk_mul_f32 v[30:31], v[30:31], v[94:95]
    v_exp_f32 v24, v24
    v_exp_f32 v25, v25
    v_exp_f32 v26, v26
    v_exp_f32 v27, v27
    v_exp_f32 v28, v28
    v_exp_f32 v29, v29
    v_exp_f32 v30, v30
    v_exp_f32 v31, v31
    v_pk_add_f32 v[24:25], v[24:25], v[4:5]
    v_pk_add_f32 v[26:27], v[26:27], v[4:5]
    v_pk_add_f32 v[28:29], v[28:29], v[4:5]
    v_pk_add_f32 v[30:31], v[30:31], v[4:5]
    v_rcp_f32 v24, v24
    v_rcp_f32 v25, v25
    v_rcp_f32 v26, v26
    v_rcp_f32 v27, v27
    v_rcp_f32 v28, v28
    v_rcp_f32 v29, v29
    v_rcp_f32 v30, v30
    v_rcp_f32 v31, v31
    v_pk_mul_f32 v[88:89], v[88:89], v[24:25]
    v_pk_mul_f32 v[90:91], v[90:91], v[26:27]
    v_pk_mul_f32 v[92:93], v[92:93], v[28:29]
    v_pk_mul_f32 v[94:95], v[94:95], v[30:31]
    v_cvt_pk_bf16_f32 v40, v80, v84
    v_cvt_pk_bf16_f32 v41, v88, v92
    v_cvt_pk_bf16_f32 v42, v81, v85
    v_cvt_pk_bf16_f32 v43, v89, v93
    buffer_store_dwordx4 v[40:43], v22, s[72:75], s43 offen offset:0 sc1
    v_cvt_pk_bf16_f32 v44, v82, v86
    v_cvt_pk_bf16_f32 v45, v90, v94
    v_cvt_pk_bf16_f32 v46, v83, v87
    v_cvt_pk_bf16_f32 v47, v91, v95
    buffer_store_dwordx4 v[44:47], v22, s[72:75], s43 offen offset:1024 sc1
    s_add_u32 s43, s43, 57344
    v_pk_mul_f32 v[24:25], v[96:97], v[96:97]
    v_pk_mul_f32 v[26:27], v[98:99], v[98:99]
    v_pk_mul_f32 v[28:29], v[100:101], v[100:101]
    v_pk_mul_f32 v[30:31], v[102:103], v[102:103]
    v_pk_fma_f32 v[24:25], v[24:25], v[18:19], v[16:17]
    v_pk_fma_f32 v[26:27], v[26:27], v[18:19], v[16:17]
    v_pk_fma_f32 v[28:29], v[28:29], v[18:19], v[16:17]
    v_pk_fma_f32 v[30:31], v[30:31], v[18:19], v[16:17]
    v_pk_mul_f32 v[24:25], v[24:25], v[96:97]
    v_pk_mul_f32 v[26:27], v[26:27], v[98:99]
    v_pk_mul_f32 v[28:29], v[28:29], v[100:101]
    v_pk_mul_f32 v[30:31], v[30:31], v[102:103]
    v_exp_f32 v24, v24
    v_exp_f32 v25, v25
    v_exp_f32 v26, v26
    v_exp_f32 v27, v27
    v_exp_f32 v28, v28
    v_exp_f32 v29, v29
    v_exp_f32 v30, v30
    v_exp_f32 v31, v31
    v_pk_add_f32 v[24:25], v[24:25], v[4:5]
    v_pk_add_f32 v[26:27], v[26:27], v[4:5]
    v_pk_add_f32 v[28:29], v[28:29], v[4:5]
    v_pk_add_f32 v[30:31], v[30:31], v[4:5]
    v_rcp_f32 v24, v24
    v_rcp_f32 v25, v25
    v_rcp_f32 v26, v26
    v_rcp_f32 v27, v27
    v_rcp_f32 v28, v28
    v_rcp_f32 v29, v29
    v_rcp_f32 v30, v30
    v_rcp_f32 v31, v31
    v_pk_mul_f32 v[96:97], v[96:97], v[24:25]
    v_pk_mul_f32 v[98:99], v[98:99], v[26:27]
    v_pk_mul_f32 v[100:101], v[100:101], v[28:29]
    v_pk_mul_f32 v[102:103], v[102:103], v[30:31]
    v_pk_mul_f32 v[24:25], v[104:105], v[104:105]
    v_pk_mul_f32 v[26:27], v[106:107], v[106:107]
    v_pk_mul_f32 v[28:29], v[108:109], v[108:109]
    v_pk_mul_f32 v[30:31], v[110:111], v[110:111]
    v_pk_fma_f32 v[24:25], v[24:25], v[18:19], v[16:17]
    v_pk_fma_f32 v[26:27], v[26:27], v[18:19], v[16:17]
    v_pk_fma_f32 v[28:29], v[28:29], v[18:19], v[16:17]
    v_pk_fma_f32 v[30:31], v[30:31], v[18:19], v[16:17]
    v_pk_mul_f32 v[24:25], v[24:25], v[104:105]
    v_pk_mul_f32 v[26:27], v[26:27], v[106:107]
    v_pk_mul_f32 v[28:29], v[28:29], v[108:109]
    v_pk_mul_f32 v[30:31], v[30:31], v[110:111]
    v_exp_f32 v24, v24
    v_exp_f32 v25, v25
    v_exp_f32 v26, v26
    v_exp_f32 v27, v27
    v_exp_f32 v28, v28
    v_exp_f32 v29, v29
    v_exp_f32 v30, v30
    v_exp_f32 v31, v31
    v_pk_add_f32 v[24:25], v[24:25], v[4:5]
    v_pk_add_f32 v[26:27], v[26:27], v[4:5]
    v_pk_add_f32 v[28:29], v[28:29], v[4:5]
    v_pk_add_f32 v[30:31], v[30:31], v[4:5]
    v_rcp_f32 v24, v24
    v_rcp_f32 v25, v25
    v_rcp_f32 v26, v26
    v_rcp_f32 v27, v27
    v_rcp_f32 v28, v28
    v_rcp_f32 v29, v29
    v_rcp_f32 v30, v30
    v_rcp_f32 v31, v31
    v_pk_mul_f32 v[104:105], v[104:105], v[24:25]
    v_pk_mul_f32 v[106:107], v[106:107], v[26:27]
    v_pk_mul_f32 v[108:109], v[108:109], v[28:29]
    v_pk_mul_f32 v[110:111], v[110:111], v[30:31]
    v_cvt_pk_bf16_f32 v32, v96, v100
    v_cvt_pk_bf16_f32 v33, v104, v108
    v_cvt_pk_bf16_f32 v34, v97, v101
    v_cvt_pk_bf16_f32 v35, v105, v109
    buffer_store_dwordx4 v[32:35], v22, s[72:75], s43 offen offset:0 sc1
    v_cvt_pk_bf16_f32 v36, v98, v102
    v_cvt_pk_bf16_f32 v37, v106, v110
    v_cvt_pk_bf16_f32 v38, v99, v103
    v_cvt_pk_bf16_f32 v39, v107, v111
    buffer_store_dwordx4 v[36:39], v22, s[72:75], s43 offen offset:1024 sc1
    s_add_u32 s43, s43, 57344
    v_pk_mul_f32 v[24:25], v[112:113], v[112:113]
    v_pk_mul_f32 v[26:27], v[114:115], v[114:115]
    v_pk_mul_f32 v[28:29], v[116:117], v[116:117]
    v_pk_mul_f32 v[30:31], v[118:119], v[118:119]
    v_pk_fma_f32 v[24:25], v[24:25], v[18:19], v[16:17]
    v_pk_fma_f32 v[26:27], v[26:27], v[18:19], v[16:17]
    v_pk_fma_f32 v[28:29], v[28:29], v[18:19], v[16:17]
    v_pk_fma_f32 v[30:31], v[30:31], v[18:19], v[16:17]
    v_pk_mul_f32 v[24:25], v[24:25], v[112:113]
    v_pk_mul_f32 v[26:27], v[26:27], v[114:115]
    v_pk_mul_f32 v[28:29], v[28:29], v[116:117]
    v_pk_mul_f32 v[30:31], v[30:31], v[118:119]
    v_exp_f32 v24, v24
    v_exp_f32 v25, v25
    v_exp_f32 v26, v26
    v_exp_f32 v27, v27
    v_exp_f32 v28, v28
    v_exp_f32 v29, v29
    v_exp_f32 v30, v30
    v_exp_f32 v31, v31
    v_pk_add_f32 v[24:25], v[24:25], v[4:5]
    v_pk_add_f32 v[26:27], v[26:27], v[4:5]
    v_pk_add_f32 v[28:29], v[28:29], v[4:5]
    v_pk_add_f32 v[30:31], v[30:31], v[4:5]
    v_rcp_f32 v24, v24
    v_rcp_f32 v25, v25
    v_rcp_f32 v26, v26
    v_rcp_f32 v27, v27
    v_rcp_f32 v28, v28
    v_rcp_f32 v29, v29
    v_rcp_f32 v30, v30
    v_rcp_f32 v31, v31
    v_pk_mul_f32 v[112:113], v[112:113], v[24:25]
    v_pk_mul_f32 v[114:115], v[114:115], v[26:27]
    v_pk_mul_f32 v[116:117], v[116:117], v[28:29]
    v_pk_mul_f32 v[118:119], v[118:119], v[30:31]
    v_pk_mul_f32 v[24:25], v[120:121], v[120:121]
    v_pk_mul_f32 v[26:27], v[122:123], v[122:123]
    v_pk_mul_f32 v[28:29], v[124:125], v[124:125]
    v_pk_mul_f32 v[30:31], v[126:127], v[126:127]
    v_pk_fma_f32 v[24:25], v[24:25], v[18:19], v[16:17]
    v_pk_fma_f32 v[26:27], v[26:27], v[18:19], v[16:17]
    v_pk_fma_f32 v[28:29], v[28:29], v[18:19], v[16:17]
    v_pk_fma_f32 v[30:31], v[30:31], v[18:19], v[16:17]
    v_pk_mul_f32 v[24:25], v[24:25], v[120:121]
    v_pk_mul_f32 v[26:27], v[26:27], v[122:123]
    v_pk_mul_f32 v[28:29], v[28:29], v[124:125]
    v_pk_mul_f32 v[30:31], v[30:31], v[126:127]
    v_exp_f32 v24, v24
    v_exp_f32 v25, v25
    v_exp_f32 v26, v26
    v_exp_f32 v27, v27
    v_exp_f32 v28, v28
    v_exp_f32 v29, v29
    v_exp_f32 v30, v30
    v_exp_f32 v31, v31
    v_pk_add_f32 v[24:25], v[24:25], v[4:5]
    v_pk_add_f32 v[26:27], v[26:27], v[4:5]
    v_pk_add_f32 v[28:29], v[28:29], v[4:5]
    v_pk_add_f32 v[30:31], v[30:31], v[4:5]
    v_rcp_f32 v24, v24
    v_rcp_f32 v25, v25
    v_rcp_f32 v26, v26
    v_rcp_f32 v27, v27
    v_rcp_f32 v28, v28
    v_rcp_f32 v29, v29
    v_rcp_f32 v30, v30
    v_rcp_f32 v31, v31
    v_pk_mul_f32 v[120:121], v[120:121], v[24:25]
    v_pk_mul_f32 v[122:123], v[122:123], v[26:27]
    v_pk_mul_f32 v[124:125], v[124:125], v[28:29]
    v_pk_mul_f32 v[126:127], v[126:127], v[30:31]
    v_cvt_pk_bf16_f32 v40, v112, v116
    v_cvt_pk_bf16_f32 v41, v120, v124
    v_cvt_pk_bf16_f32 v42, v113, v117
    v_cvt_pk_bf16_f32 v43, v121, v125
    s_waitcnt vmcnt(58)
    buffer_store_dwordx4 v[40:43], v22, s[72:75], s43 offen offset:0 sc1
    v_cvt_pk_bf16_f32 v44, v114, v118
    v_cvt_pk_bf16_f32 v45, v122, v126
    v_cvt_pk_bf16_f32 v46, v115, v119
    v_cvt_pk_bf16_f32 v47, v123, v127
    buffer_store_dwordx4 v[44:47], v22, s[72:75], s43 offen offset:1024 sc1
    s_waitcnt vmcnt(0)
    s_barrier
    s_cmp_lg_u32 s33, 0
    s_cbranch_scc1 k3_mlp_kernel_p4096
    s_lshl_b32 s42, s31, 7
    s_add_u32 s42, s42, 4096
    v_mov_b32 v4, 1
    v_mov_b32 v5, 0
    s_mov_b64 exec, 1
    buffer_atomic_add v4, v5, s[4:7], s42 offen sc1
    s_mov_b64 exec, -1
    s_mov_b64 exec, 1
    s_mov_b32 s43, 0
k3_mlp_kernel_l4096:
    buffer_load_dword v4, v5, s[4:7], s42 offen sc1
    s_add_u32 s43, s43, 1
    s_waitcnt vmcnt(0)
    v_readfirstlane_b32 s49, v4
    s_cmp_ge_u32 s43, 0x100000
    s_cbranch_scc1 k3_mlp_kernel_x4096
    s_cmp_lt_u32 s49, 7
    s_cbranch_scc1 k3_mlp_kernel_l4096
k3_mlp_kernel_x4096:
    s_mov_b64 exec, -1
k3_mlp_kernel_p4096:
    s_barrier
    s_mov_b32 s43, 0
    buffer_load_dwordx4 v[128:131], v8, s[72:75], s43 offen sc1
    buffer_load_dwordx4 v[132:135], v9, s[72:75], s43 offen sc1
    buffer_load_dwordx4 v[136:139], v10, s[72:75], s43 offen sc1
    buffer_load_dwordx4 v[140:143], v11, s[72:75], s43 offen sc1
    s_mov_b32 s43, 1024
    buffer_load_dwordx4 v[144:147], v8, s[72:75], s43 offen sc1
    buffer_load_dwordx4 v[148:151], v9, s[72:75], s43 offen sc1
    buffer_load_dwordx4 v[152:155], v10, s[72:75], s43 offen sc1
    buffer_load_dwordx4 v[156:159], v11, s[72:75], s43 offen sc1
    s_mov_b32 s43, 2048
    buffer_load_dwordx4 v[160:163], v8, s[72:75], s43 offen sc1
    buffer_load_dwordx4 v[164:167], v9, s[72:75], s43 offen sc1
    buffer_load_dwordx4 v[168:171], v10, s[72:75], s43 offen sc1
    buffer_load_dwordx4 v[172:175], v11, s[72:75], s43 offen sc1
    v_mov_b32 v64, 0
    v_mov_b32 v65, 0
    v_mov_b32 v66, 0
    v_mov_b32 v67, 0
    v_mov_b32 v68, 0
    v_mov_b32 v69, 0
    v_mov_b32 v70, 0
    v_mov_b32 v71, 0
    v_mov_b32 v72, 0
    v_mov_b32 v73, 0
    v_mov_b32 v74, 0
    v_mov_b32 v75, 0
    v_mov_b32 v76, 0
    v_mov_b32 v77, 0
    v_mov_b32 v78, 0
    v_mov_b32 v79, 0
    v_mov_b32 v80, 0
    v_mov_b32 v81, 0
    v_mov_b32 v82, 0
    v_mov_b32 v83, 0
    v_mov_b32 v84, 0
    v_mov_b32 v85, 0
    v_mov_b32 v86, 0
    v_mov_b32 v87, 0
    v_mov_b32 v88, 0
    v_mov_b32 v89, 0
    v_mov_b32 v90, 0
    v_mov_b32 v91, 0
    v_mov_b32 v92, 0
    v_mov_b32 v93, 0
    v_mov_b32 v94, 0
    v_mov_b32 v95, 0
    v_mov_b32 v96, 0
    v_mov_b32 v97, 0
    v_mov_b32 v98, 0
    v_mov_b32 v99, 0
    v_mov_b32 v100, 0
    v_mov_b32 v101, 0
    v_mov_b32 v102, 0
    v_mov_b32 v103, 0
    v_mov_b32 v104, 0
    v_mov_b32 v105, 0
    v_mov_b32 v106, 0
    v_mov_b32 v107, 0
    v_mov_b32 v108, 0
    v_mov_b32 v109, 0
    v_mov_b32 v110, 0
    v_mov_b32 v111, 0
    v_mov_b32 v112, 0
    v_mov_b32 v113, 0
    v_mov_b32 v114, 0
    v_mov_b32 v115, 0
    v_mov_b32 v116, 0
    v_mov_b32 v117, 0
    v_mov_b32 v118, 0
    v_mov_b32 v119, 0
    v_mov_b32 v120, 0
    v_mov_b32 v121, 0
    v_mov_b32 v122, 0
    v_mov_b32 v123, 0
    v_mov_b32 v124, 0
    v_mov_b32 v125, 0
    v_mov_b32 v126, 0
    v_mov_b32 v127, 0
    s_waitcnt vmcnt(8)
    s_mov_b32 s43, 3072
    buffer_load_dwordx4 v[176:179], v8, s[72:75], s43 offen sc1
    buffer_load_dwordx4 v[180:183], v9, s[72:75], s43 offen sc1
    buffer_load_dwordx4 v[184:187], v10, s[72:75], s43 offen sc1
    buffer_load_dwordx4 v[188:191], v11, s[72:75], s43 offen sc1
    s_mov_b32 s43, 4096
    buffer_load_dwordx4 v[192:195], v8, s[72:75], s43 offen sc1
    buffer_load_dwordx4 v[196:199], v9, s[72:75], s43 offen sc1
    buffer_load_dwordx4 v[200:203], v10, s[72:75], s43 offen sc1
    buffer_load_dwordx4 v[204:207], v11, s[72:75], s43 offen sc1
    v_mfma_f32_16x16x32_bf16 v[64:67], a[0:3], v[128:131], v[64:67]
    v_mfma_f32_16x16x32_bf16 v[68:71], a[4:7], v[128:131], v[68:71]
    v_mfma_f32_16x16x32_bf16 v[72:75], a[8:11], v[128:131], v[72:75]
    v_mfma_f32_16x16x32_bf16 v[76:79], a[12:15], v[128:131], v[76:79]
    v_mfma_f32_16x16x32_bf16 v[80:83], a[0:3], v[132:135], v[80:83]
    v_mfma_f32_16x16x32_bf16 v[84:87], a[4:7], v[132:135], v[84:87]
    v_mfma_f32_16x16x32_bf16 v[88:91], a[8:11], v[132:135], v[88:91]
    v_mfma_f32_16x16x32_bf16 v[92:95], a[12:15], v[132:135], v[92:95]
    v_mfma_f32_16x16x32_bf16 v[96:99], a[0:3], v[136:139], v[96:99]
    v_mfma_f32_16x16x32_bf16 v[100:103], a[4:7], v[136:139], v[100:103]
    v_mfma_f32_16x16x32_bf16 v[104:107], a[8:11], v[136:139], v[104:107]
    v_mfma_f32_16x16x32_bf16 v[108:111], a[12:15], v[136:139], v[108:111]
    v_mfma_f32_16x16x32_bf16 v[112:115], a[0:3], v[140:143], v[112:115]
    v_mfma_f32_16x16x32_bf16 v[116:119], a[4:7], v[140:143], v[116:119]
    v_mfma_f32_16x16x32_bf16 v[120:123], a[8:11], v[140:143], v[120:123]
    v_mfma_f32_16x16x32_bf16 v[124:127], a[12:15], v[140:143], v[124:127]
    s_waitcnt vmcnt(12)
    s_mov_b32 s43, 5120
    buffer_load_dwordx4 v[208:211], v8, s[72:75], s43 offen sc1
    buffer_load_dwordx4 v[212:215], v9, s[72:75], s43 offen sc1
    buffer_load_dwordx4 v[216:219], v10, s[72:75], s43 offen sc1
    buffer_load_dwordx4 v[220:223], v11, s[72:75], s43 offen sc1
    s_mov_b32 s43, 6144
    buffer_load_dwordx4 v[224:227], v8, s[72:75], s43 offen sc1
    buffer_load_dwordx4 v[228:231], v9, s[72:75], s43 offen sc1
    buffer_load_dwordx4 v[232:235], v10, s[72:75], s43 offen sc1
    buffer_load_dwordx4 v[236:239], v11, s[72:75], s43 offen sc1
    v_mfma_f32_16x16x32_bf16 v[64:67], a[16:19], v[144:147], v[64:67]
    v_mfma_f32_16x16x32_bf16 v[68:71], a[20:23], v[144:147], v[68:71]
    v_mfma_f32_16x16x32_bf16 v[72:75], a[24:27], v[144:147], v[72:75]
    v_mfma_f32_16x16x32_bf16 v[76:79], a[28:31], v[144:147], v[76:79]
    v_mfma_f32_16x16x32_bf16 v[80:83], a[16:19], v[148:151], v[80:83]
    v_mfma_f32_16x16x32_bf16 v[84:87], a[20:23], v[148:151], v[84:87]
    v_mfma_f32_16x16x32_bf16 v[88:91], a[24:27], v[148:151], v[88:91]
    v_mfma_f32_16x16x32_bf16 v[92:95], a[28:31], v[148:151], v[92:95]
    v_mfma_f32_16x16x32_bf16 v[96:99], a[16:19], v[152:155], v[96:99]
    v_mfma_f32_16x16x32_bf16 v[100:103], a[20:23], v[152:155], v[100:103]
    v_mfma_f32_16x16x32_bf16 v[104:107], a[24:27], v[152:155], v[104:107]
    v_mfma_f32_16x16x32_bf16 v[108:111], a[28:31], v[152:155], v[108:111]
    v_mfma_f32_16x16x32_bf16 v[112:115], a[16:19], v[156:159], v[112:115]
    v_mfma_f32_16x16x32_bf16 v[116:119], a[20:23], v[156:159], v[116:119]
    v_mfma_f32_16x16x32_bf16 v[120:123], a[24:27], v[156:159], v[120:123]
    v_mfma_f32_16x16x32_bf16 v[124:127], a[28:31], v[156:159], v[124:127]
    s_waitcnt vmcnt(16)
    s_mov_b32 s43, 7168
    buffer_load_dwordx4 v[240:243], v8, s[72:75], s43 offen sc1
    buffer_load_dwordx4 v[244:247], v9, s[72:75], s43 offen sc1
    buffer_load_dwordx4 v[248:251], v10, s[72:75], s43 offen sc1
    buffer_load_dwordx4 v[252:255], v11, s[72:75], s43 offen sc1
    s_mov_b32 s43, 8192
    buffer_load_dwordx4 v[128:131], v8, s[72:75], s43 offen sc1
    buffer_load_dwordx4 v[132:135], v9, s[72:75], s43 offen sc1
    buffer_load_dwordx4 v[136:139], v10, s[72:75], s43 offen sc1
    buffer_load_dwordx4 v[140:143], v11, s[72:75], s43 offen sc1
    v_mfma_f32_16x16x32_bf16 v[64:67], a[32:35], v[160:163], v[64:67]
    v_mfma_f32_16x16x32_bf16 v[68:71], a[36:39], v[160:163], v[68:71]
    v_mfma_f32_16x16x32_bf16 v[72:75], a[40:43], v[160:163], v[72:75]
    v_mfma_f32_16x16x32_bf16 v[76:79], a[44:47], v[160:163], v[76:79]
    v_mfma_f32_16x16x32_bf16 v[80:83], a[32:35], v[164:167], v[80:83]
    v_mfma_f32_16x16x32_bf16 v[84:87], a[36:39], v[164:167], v[84:87]
    v_mfma_f32_16x16x32_bf16 v[88:91], a[40:43], v[164:167], v[88:91]
    v_mfma_f32_16x16x32_bf16 v[92:95], a[44:47], v[164:167], v[92:95]
    v_mfma_f32_16x16x32_bf16 v[96:99], a[32:35], v[168:171], v[96:99]
    v_mfma_f32_16x16x32_bf16 v[100:103], a[36:39], v[168:171], v[100:103]
    v_mfma_f32_16x16x32_bf16 v[104:107], a[40:43], v[168:171], v[104:107]
    v_mfma_f32_16x16x32_bf16 v[108:111], a[44:47], v[168:171], v[108:111]
    v_mfma_f32_16x16x32_bf16 v[112:115], a[32:35], v[172:175], v[112:115]
    v_mfma_f32_16x16x32_bf16 v[116:119], a[36:39], v[172:175], v[116:119]
    v_mfma_f32_16x16x32_bf16 v[120:123], a[40:43], v[172:175], v[120:123]
    v_mfma_f32_16x16x32_bf16 v[124:127], a[44:47], v[172:175], v[124:127]
    s_waitcnt vmcnt(20)
    s_mov_b32 s43, 9216
    buffer_load_dwordx4 v[144:147], v8, s[72:75], s43 offen sc1
    buffer_load_dwordx4 v[148:151], v9, s[72:75], s43 offen sc1
    buffer_load_dwordx4 v[152:155], v10, s[72:75], s43 offen sc1
    buffer_load_dwordx4 v[156:159], v11, s[72:75], s43 offen sc1
    s_mov_b32 s43, 10240
    buffer_load_dwordx4 v[160:163], v8, s[72:75], s43 offen sc1
    buffer_load_dwordx4 v[164:167], v9, s[72:75], s43 offen sc1
    buffer_load_dwordx4 v[168:171], v10, s[72:75], s43 offen sc1
    buffer_load_dwordx4 v[172:175], v11, s[72:75], s43 offen sc1
    v_mfma_f32_16x16x32_bf16 v[64:67], a[48:51], v[176:179], v[64:67]
    v_mfma_f32_16x16x32_bf16 v[68:71], a[52:55], v[176:179], v[68:71]
    v_mfma_f32_16x16x32_bf16 v[72:75], a[56:59], v[176:179], v[72:75]
    v_mfma_f32_16x16x32_bf16 v[76:79], a[60:63], v[176:179], v[76:79]
    v_mfma_f32_16x16x32_bf16 v[80:83], a[48:51], v[180:183], v[80:83]
    v_mfma_f32_16x16x32_bf16 v[84:87], a[52:55], v[180:183], v[84:87]
    v_mfma_f32_16x16x32_bf16 v[88:91], a[56:59], v[180:183], v[88:91]
    v_mfma_f32_16x16x32_bf16 v[92:95], a[60:63], v[180:183], v[92:95]
    v_mfma_f32_16x16x32_bf16 v[96:99], a[48:51], v[184:187], v[96:99]
    v_mfma_f32_16x16x32_bf16 v[100:103], a[52:55], v[184:187], v[100:103]
    v_mfma_f32_16x16x32_bf16 v[104:107], a[56:59], v[184:187], v[104:107]
    v_mfma_f32_16x16x32_bf16 v[108:111], a[60:63], v[184:187], v[108:111]
    v_mfma_f32_16x16x32_bf16 v[112:115], a[48:51], v[188:191], v[112:115]
    v_mfma_f32_16x16x32_bf16 v[116:119], a[52:55], v[188:191], v[116:119]
    v_mfma_f32_16x16x32_bf16 v[120:123], a[56:59], v[188:191], v[120:123]
    v_mfma_f32_16x16x32_bf16 v[124:127], a[60:63], v[188:191], v[124:127]
    s_waitcnt vmcnt(24)
    s_mov_b32 s43, 11264
    buffer_load_dwordx4 v[176:179], v8, s[72:75], s43 offen sc1
    buffer_load_dwordx4 v[180:183], v9, s[72:75], s43 offen sc1
    buffer_load_dwordx4 v[184:187], v10, s[72:75], s43 offen sc1
    buffer_load_dwordx4 v[188:191], v11, s[72:75], s43 offen sc1
    v_mfma_f32_16x16x32_bf16 v[64:67], a[64:67], v[192:195], v[64:67]
    v_mfma_f32_16x16x32_bf16 v[68:71], a[68:71], v[192:195], v[68:71]
    v_mfma_f32_16x16x32_bf16 v[72:75], a[72:75], v[192:195], v[72:75]
    v_mfma_f32_16x16x32_bf16 v[76:79], a[76:79], v[192:195], v[76:79]
    v_mfma_f32_16x16x32_bf16 v[80:83], a[64:67], v[196:199], v[80:83]
    v_mfma_f32_16x16x32_bf16 v[84:87], a[68:71], v[196:199], v[84:87]
    v_mfma_f32_16x16x32_bf16 v[88:91], a[72:75], v[196:199], v[88:91]
    v_mfma_f32_16x16x32_bf16 v[92:95], a[76:79], v[196:199], v[92:95]
    v_mfma_f32_16x16x32_bf16 v[96:99], a[64:67], v[200:203], v[96:99]
    v_mfma_f32_16x16x32_bf16 v[100:103], a[68:71], v[200:203], v[100:103]
    v_mfma_f32_16x16x32_bf16 v[104:107], a[72:75], v[200:203], v[104:107]
    v_mfma_f32_16x16x32_bf16 v[108:111], a[76:79], v[200:203], v[108:111]
    v_mfma_f32_16x16x32_bf16 v[112:115], a[64:67], v[204:207], v[112:115]
    v_mfma_f32_16x16x32_bf16 v[116:119], a[68:71], v[204:207], v[116:119]
    v_mfma_f32_16x16x32_bf16 v[120:123], a[72:75], v[204:207], v[120:123]
    v_mfma_f32_16x16x32_bf16 v[124:127], a[76:79], v[204:207], v[124:127]
    s_waitcnt vmcnt(24)
    s_mov_b32 s43, 12288
    buffer_load_dwordx4 v[192:195], v8, s[72:75], s43 offen sc1
    buffer_load_dwordx4 v[196:199], v9, s[72:75], s43 offen sc1
    buffer_load_dwordx4 v[200:203], v10, s[72:75], s43 offen sc1
    buffer_load_dwordx4 v[204:207], v11, s[72:75], s43 offen sc1
    v_mfma_f32_16x16x32_bf16 v[64:67], a[80:83], v[208:211], v[64:67]
    v_mfma_f32_16x16x32_bf16 v[68:71], a[84:87], v[208:211], v[68:71]
    v_mfma_f32_16x16x32_bf16 v[72:75], a[88:91], v[208:211], v[72:75]
    v_mfma_f32_16x16x32_bf16 v[76:79], a[92:95], v[208:211], v[76:79]
    v_mfma_f32_16x16x32_bf16 v[80:83], a[80:83], v[212:215], v[80:83]
    v_mfma_f32_16x16x32_bf16 v[84:87], a[84:87], v[212:215], v[84:87]
    v_mfma_f32_16x16x32_bf16 v[88:91], a[88:91], v[212:215], v[88:91]
    v_mfma_f32_16x16x32_bf16 v[92:95], a[92:95], v[212:215], v[92:95]
    v_mfma_f32_16x16x32_bf16 v[96:99], a[80:83], v[216:219], v[96:99]
    v_mfma_f32_16x16x32_bf16 v[100:103], a[84:87], v[216:219], v[100:103]
    v_mfma_f32_16x16x32_bf16 v[104:107], a[88:91], v[216:219], v[104:107]
    v_mfma_f32_16x16x32_bf16 v[108:111], a[92:95], v[216:219], v[108:111]
    v_mfma_f32_16x16x32_bf16 v[112:115], a[80:83], v[220:223], v[112:115]
    v_mfma_f32_16x16x32_bf16 v[116:119], a[84:87], v[220:223], v[116:119]
    v_mfma_f32_16x16x32_bf16 v[120:123], a[88:91], v[220:223], v[120:123]
    v_mfma_f32_16x16x32_bf16 v[124:127], a[92:95], v[220:223], v[124:127]
    s_waitcnt vmcnt(24)
    s_mov_b32 s43, 13312
    buffer_load_dwordx4 v[208:211], v8, s[72:75], s43 offen sc1
    buffer_load_dwordx4 v[212:215], v9, s[72:75], s43 offen sc1
    buffer_load_dwordx4 v[216:219], v10, s[72:75], s43 offen sc1
    buffer_load_dwordx4 v[220:223], v11, s[72:75], s43 offen sc1
    v_mfma_f32_16x16x32_bf16 v[64:67], a[96:99], v[224:227], v[64:67]
    v_mfma_f32_16x16x32_bf16 v[68:71], a[100:103], v[224:227], v[68:71]
    v_mfma_f32_16x16x32_bf16 v[72:75], a[104:107], v[224:227], v[72:75]
    v_mfma_f32_16x16x32_bf16 v[76:79], a[108:111], v[224:227], v[76:79]
    v_mfma_f32_16x16x32_bf16 v[80:83], a[96:99], v[228:231], v[80:83]
    v_mfma_f32_16x16x32_bf16 v[84:87], a[100:103], v[228:231], v[84:87]
    v_mfma_f32_16x16x32_bf16 v[88:91], a[104:107], v[228:231], v[88:91]
    v_mfma_f32_16x16x32_bf16 v[92:95], a[108:111], v[228:231], v[92:95]
    v_mfma_f32_16x16x32_bf16 v[96:99], a[96:99], v[232:235], v[96:99]
    v_mfma_f32_16x16x32_bf16 v[100:103], a[100:103], v[232:235], v[100:103]
    v_mfma_f32_16x16x32_bf16 v[104:107], a[104:107], v[232:235], v[104:107]
    v_mfma_f32_16x16x32_bf16 v[108:111], a[108:111], v[232:235], v[108:111]
    v_mfma_f32_16x16x32_bf16 v[112:115], a[96:99], v[236:239], v[112:115]
    v_mfma_f32_16x16x32_bf16 v[116:119], a[100:103], v[236:239], v[116:119]
    v_mfma_f32_16x16x32_bf16 v[120:123], a[104:107], v[236:239], v[120:123]
    v_mfma_f32_16x16x32_bf16 v[124:127], a[108:111], v[236:239], v[124:127]
    s_waitcnt vmcnt(24)
    v_mfma_f32_16x16x32_bf16 v[64:67], a[112:115], v[240:243], v[64:67]
    v_mfma_f32_16x16x32_bf16 v[68:71], a[116:119], v[240:243], v[68:71]
    v_mfma_f32_16x16x32_bf16 v[72:75], a[120:123], v[240:243], v[72:75]
    v_mfma_f32_16x16x32_bf16 v[76:79], a[124:127], v[240:243], v[76:79]
    v_mfma_f32_16x16x32_bf16 v[80:83], a[112:115], v[244:247], v[80:83]
    v_mfma_f32_16x16x32_bf16 v[84:87], a[116:119], v[244:247], v[84:87]
    v_mfma_f32_16x16x32_bf16 v[88:91], a[120:123], v[244:247], v[88:91]
    v_mfma_f32_16x16x32_bf16 v[92:95], a[124:127], v[244:247], v[92:95]
    v_mfma_f32_16x16x32_bf16 v[96:99], a[112:115], v[248:251], v[96:99]
    v_mfma_f32_16x16x32_bf16 v[100:103], a[116:119], v[248:251], v[100:103]
    v_mfma_f32_16x16x32_bf16 v[104:107], a[120:123], v[248:251], v[104:107]
    v_mfma_f32_16x16x32_bf16 v[108:111], a[124:127], v[248:251], v[108:111]
    v_mfma_f32_16x16x32_bf16 v[112:115], a[112:115], v[252:255], v[112:115]
    v_mfma_f32_16x16x32_bf16 v[116:119], a[116:119], v[252:255], v[116:119]
    v_mfma_f32_16x16x32_bf16 v[120:123], a[120:123], v[252:255], v[120:123]
    v_mfma_f32_16x16x32_bf16 v[124:127], a[124:127], v[252:255], v[124:127]
    s_waitcnt vmcnt(20)
    v_mfma_f32_16x16x32_bf16 v[64:67], a[128:131], v[128:131], v[64:67]
    v_mfma_f32_16x16x32_bf16 v[68:71], a[132:135], v[128:131], v[68:71]
    v_mfma_f32_16x16x32_bf16 v[72:75], a[136:139], v[128:131], v[72:75]
    v_mfma_f32_16x16x32_bf16 v[76:79], a[140:143], v[128:131], v[76:79]
    v_mfma_f32_16x16x32_bf16 v[80:83], a[128:131], v[132:135], v[80:83]
    v_mfma_f32_16x16x32_bf16 v[84:87], a[132:135], v[132:135], v[84:87]
    v_mfma_f32_16x16x32_bf16 v[88:91], a[136:139], v[132:135], v[88:91]
    v_mfma_f32_16x16x32_bf16 v[92:95], a[140:143], v[132:135], v[92:95]
    v_mfma_f32_16x16x32_bf16 v[96:99], a[128:131], v[136:139], v[96:99]
    v_mfma_f32_16x16x32_bf16 v[100:103], a[132:135], v[136:139], v[100:103]
    v_mfma_f32_16x16x32_bf16 v[104:107], a[136:139], v[136:139], v[104:107]
    v_mfma_f32_16x16x32_bf16 v[108:111], a[140:143], v[136:139], v[108:111]
    v_mfma_f32_16x16x32_bf16 v[112:115], a[128:131], v[140:143], v[112:115]
    v_mfma_f32_16x16x32_bf16 v[116:119], a[132:135], v[140:143], v[116:119]
    v_mfma_f32_16x16x32_bf16 v[120:123], a[136:139], v[140:143], v[120:123]
    v_mfma_f32_16x16x32_bf16 v[124:127], a[140:143], v[140:143], v[124:127]
    s_waitcnt vmcnt(16)
    v_mfma_f32_16x16x32_bf16 v[64:67], a[144:147], v[144:147], v[64:67]
    v_mfma_f32_16x16x32_bf16 v[68:71], a[148:151], v[144:147], v[68:71]
    v_mfma_f32_16x16x32_bf16 v[72:75], a[152:155], v[144:147], v[72:75]
    v_mfma_f32_16x16x32_bf16 v[76:79], a[156:159], v[144:147], v[76:79]
    v_mfma_f32_16x16x32_bf16 v[80:83], a[144:147], v[148:151], v[80:83]
    v_mfma_f32_16x16x32_bf16 v[84:87], a[148:151], v[148:151], v[84:87]
    v_mfma_f32_16x16x32_bf16 v[88:91], a[152:155], v[148:151], v[88:91]
    v_mfma_f32_16x16x32_bf16 v[92:95], a[156:159], v[148:151], v[92:95]
    v_mfma_f32_16x16x32_bf16 v[96:99], a[144:147], v[152:155], v[96:99]
    v_mfma_f32_16x16x32_bf16 v[100:103], a[148:151], v[152:155], v[100:103]
    v_mfma_f32_16x16x32_bf16 v[104:107], a[152:155], v[152:155], v[104:107]
    v_mfma_f32_16x16x32_bf16 v[108:111], a[156:159], v[152:155], v[108:111]
    v_mfma_f32_16x16x32_bf16 v[112:115], a[144:147], v[156:159], v[112:115]
    v_mfma_f32_16x16x32_bf16 v[116:119], a[148:151], v[156:159], v[116:119]
    v_mfma_f32_16x16x32_bf16 v[120:123], a[152:155], v[156:159], v[120:123]
    v_mfma_f32_16x16x32_bf16 v[124:127], a[156:159], v[156:159], v[124:127]
    s_waitcnt vmcnt(12)
    v_mfma_f32_16x16x32_bf16 v[64:67], a[160:163], v[160:163], v[64:67]
    v_mfma_f32_16x16x32_bf16 v[68:71], a[164:167], v[160:163], v[68:71]
    v_mfma_f32_16x16x32_bf16 v[72:75], a[168:171], v[160:163], v[72:75]
    v_mfma_f32_16x16x32_bf16 v[76:79], a[172:175], v[160:163], v[76:79]
    v_mfma_f32_16x16x32_bf16 v[80:83], a[160:163], v[164:167], v[80:83]
    v_mfma_f32_16x16x32_bf16 v[84:87], a[164:167], v[164:167], v[84:87]
    v_mfma_f32_16x16x32_bf16 v[88:91], a[168:171], v[164:167], v[88:91]
    v_mfma_f32_16x16x32_bf16 v[92:95], a[172:175], v[164:167], v[92:95]
    v_mfma_f32_16x16x32_bf16 v[96:99], a[160:163], v[168:171], v[96:99]
    v_mfma_f32_16x16x32_bf16 v[100:103], a[164:167], v[168:171], v[100:103]
    v_mfma_f32_16x16x32_bf16 v[104:107], a[168:171], v[168:171], v[104:107]
    v_mfma_f32_16x16x32_bf16 v[108:111], a[172:175], v[168:171], v[108:111]
    v_mfma_f32_16x16x32_bf16 v[112:115], a[160:163], v[172:175], v[112:115]
    v_mfma_f32_16x16x32_bf16 v[116:119], a[164:167], v[172:175], v[116:119]
    v_mfma_f32_16x16x32_bf16 v[120:123], a[168:171], v[172:175], v[120:123]
    v_mfma_f32_16x16x32_bf16 v[124:127], a[172:175], v[172:175], v[124:127]
    s_waitcnt vmcnt(8)
    v_mfma_f32_16x16x32_bf16 v[64:67], a[176:179], v[176:179], v[64:67]
    v_mfma_f32_16x16x32_bf16 v[68:71], a[180:183], v[176:179], v[68:71]
    v_mfma_f32_16x16x32_bf16 v[72:75], a[184:187], v[176:179], v[72:75]
    v_mfma_f32_16x16x32_bf16 v[76:79], a[188:191], v[176:179], v[76:79]
    v_mfma_f32_16x16x32_bf16 v[80:83], a[176:179], v[180:183], v[80:83]
    v_mfma_f32_16x16x32_bf16 v[84:87], a[180:183], v[180:183], v[84:87]
    v_mfma_f32_16x16x32_bf16 v[88:91], a[184:187], v[180:183], v[88:91]
    v_mfma_f32_16x16x32_bf16 v[92:95], a[188:191], v[180:183], v[92:95]
    v_mfma_f32_16x16x32_bf16 v[96:99], a[176:179], v[184:187], v[96:99]
    v_mfma_f32_16x16x32_bf16 v[100:103], a[180:183], v[184:187], v[100:103]
    v_mfma_f32_16x16x32_bf16 v[104:107], a[184:187], v[184:187], v[104:107]
    v_mfma_f32_16x16x32_bf16 v[108:111], a[188:191], v[184:187], v[108:111]
    v_mfma_f32_16x16x32_bf16 v[112:115], a[176:179], v[188:191], v[112:115]
    v_mfma_f32_16x16x32_bf16 v[116:119], a[180:183], v[188:191], v[116:119]
    v_mfma_f32_16x16x32_bf16 v[120:123], a[184:187], v[188:191], v[120:123]
    v_mfma_f32_16x16x32_bf16 v[124:127], a[188:191], v[188:191], v[124:127]
    s_waitcnt vmcnt(4)
    v_mfma_f32_16x16x32_bf16 v[64:67], a[192:195], v[192:195], v[64:67]
    v_mfma_f32_16x16x32_bf16 v[68:71], a[196:199], v[192:195], v[68:71]
    v_mfma_f32_16x16x32_bf16 v[72:75], a[200:203], v[192:195], v[72:75]
    v_mfma_f32_16x16x32_bf16 v[76:79], a[204:207], v[192:195], v[76:79]
    v_mfma_f32_16x16x32_bf16 v[80:83], a[192:195], v[196:199], v[80:83]
    v_mfma_f32_16x16x32_bf16 v[84:87], a[196:199], v[196:199], v[84:87]
    v_mfma_f32_16x16x32_bf16 v[88:91], a[200:203], v[196:199], v[88:91]
    v_mfma_f32_16x16x32_bf16 v[92:95], a[204:207], v[196:199], v[92:95]
    v_mfma_f32_16x16x32_bf16 v[96:99], a[192:195], v[200:203], v[96:99]
    v_mfma_f32_16x16x32_bf16 v[100:103], a[196:199], v[200:203], v[100:103]
    v_mfma_f32_16x16x32_bf16 v[104:107], a[200:203], v[200:203], v[104:107]
    v_mfma_f32_16x16x32_bf16 v[108:111], a[204:207], v[200:203], v[108:111]
    v_mfma_f32_16x16x32_bf16 v[112:115], a[192:195], v[204:207], v[112:115]
    v_mfma_f32_16x16x32_bf16 v[116:119], a[196:199], v[204:207], v[116:119]
    v_mfma_f32_16x16x32_bf16 v[120:123], a[200:203], v[204:207], v[120:123]
    v_mfma_f32_16x16x32_bf16 v[124:127], a[204:207], v[204:207], v[124:127]
    s_waitcnt vmcnt(0)
    v_mfma_f32_16x16x32_bf16 v[64:67], a[208:211], v[208:211], v[64:67]
    v_mfma_f32_16x16x32_bf16 v[68:71], a[212:215], v[208:211], v[68:71]
    v_mfma_f32_16x16x32_bf16 v[72:75], a[216:219], v[208:211], v[72:75]
    v_mfma_f32_16x16x32_bf16 v[76:79], a[220:223], v[208:211], v[76:79]
    v_mfma_f32_16x16x32_bf16 v[80:83], a[208:211], v[212:215], v[80:83]
    v_mfma_f32_16x16x32_bf16 v[84:87], a[212:215], v[212:215], v[84:87]
    v_mfma_f32_16x16x32_bf16 v[88:91], a[216:219], v[212:215], v[88:91]
    v_mfma_f32_16x16x32_bf16 v[92:95], a[220:223], v[212:215], v[92:95]
    v_mfma_f32_16x16x32_bf16 v[96:99], a[208:211], v[216:219], v[96:99]
    v_mfma_f32_16x16x32_bf16 v[100:103], a[212:215], v[216:219], v[100:103]
    v_mfma_f32_16x16x32_bf16 v[104:107], a[216:219], v[216:219], v[104:107]
    v_mfma_f32_16x16x32_bf16 v[108:111], a[220:223], v[216:219], v[108:111]
    v_mfma_f32_16x16x32_bf16 v[112:115], a[208:211], v[220:223], v[112:115]
    v_mfma_f32_16x16x32_bf16 v[116:119], a[212:215], v[220:223], v[116:119]
    v_mfma_f32_16x16x32_bf16 v[120:123], a[216:219], v[220:223], v[120:123]
    v_mfma_f32_16x16x32_bf16 v[124:127], a[220:223], v[220:223], v[124:127]
    s_nop 7
    v_add_u32 v5, s53, v22
    ds_write_b128 v5, v[80:83] offset:4096
    ds_write_b128 v5, v[84:87] offset:5120
    ds_write_b128 v5, v[88:91] offset:6144
    ds_write_b128 v5, v[92:95] offset:7168
    v_add_u32 v6, s54, v22
    ds_write_b128 v6, v[96:99] offset:8192
    ds_write_b128 v6, v[100:103] offset:9216
    ds_write_b128 v6, v[104:107] offset:10240
    ds_write_b128 v6, v[108:111] offset:11264
    v_add_u32 v7, s55, v22
    ds_write_b128 v7, v[112:115] offset:12288
    ds_write_b128 v7, v[116:119] offset:13312
    ds_write_b128 v7, v[120:123] offset:14336
    ds_write_b128 v7, v[124:127] offset:15360
    v_add_u32 v4, s52, v22
    s_waitcnt lgkmcnt(0)
    s_barrier
    ds_read_b128 v[80:83], v4 offset:4096
    ds_read_b128 v[84:87], v4 offset:5120
    ds_read_b128 v[88:91], v4 offset:6144
    ds_read_b128 v[92:95], v4 offset:7168
    ds_read_b128 v[96:99], v4 offset:8192
    ds_read_b128 v[100:103], v4 offset:9216
    ds_read_b128 v[104:107], v4 offset:10240
    ds_read_b128 v[108:111], v4 offset:11264
    ds_read_b128 v[112:115], v4 offset:12288
    ds_read_b128 v[116:119], v4 offset:13312
    ds_read_b128 v[120:123], v4 offset:14336
    ds_read_b128 v[124:127], v4 offset:15360
    s_waitcnt lgkmcnt(8)
    v_pk_add_f32 v[64:65], v[64:65], v[80:81]
    v_pk_add_f32 v[66:67], v[66:67], v[82:83]
    v_pk_add_f32 v[68:69], v[68:69], v[84:85]
    v_pk_add_f32 v[70:71], v[70:71], v[86:87]
    v_pk_add_f32 v[72:73], v[72:73], v[88:89]
    v_pk_add_f32 v[74:75], v[74:75], v[90:91]
    v_pk_add_f32 v[76:77], v[76:77], v[92:93]
    v_pk_add_f32 v[78:79], v[78:79], v[94:95]
    s_waitcnt lgkmcnt(4)
    v_pk_add_f32 v[64:65], v[64:65], v[96:97]
    v_pk_add_f32 v[66:67], v[66:67], v[98:99]
    v_pk_add_f32 v[68:69], v[68:69], v[100:101]
    v_pk_add_f32 v[70:71], v[70:71], v[102:103]
    v_pk_add_f32 v[72:73], v[72:73], v[104:105]
    v_pk_add_f32 v[74:75], v[74:75], v[106:107]
    v_pk_add_f32 v[76:77], v[76:77], v[108:109]
    v_pk_add_f32 v[78:79], v[78:79], v[110:111]
    s_waitcnt lgkmcnt(0)
    v_pk_add_f32 v[64:65], v[64:65], v[112:113]
    v_pk_add_f32 v[66:67], v[66:67], v[114:115]
    v_pk_add_f32 v[68:69], v[68:69], v[116:117]
    v_pk_add_f32 v[70:71], v[70:71], v[118:119]
    v_pk_add_f32 v[72:73], v[72:73], v[120:121]
    v_pk_add_f32 v[74:75], v[74:75], v[122:123]
    v_pk_add_f32 v[76:77], v[76:77], v[124:125]
    v_pk_add_f32 v[78:79], v[78:79], v[126:127]
    v_lshlrev_b32 v6, 16, v48
    v_and_b32 v7, 0xffff0000, v48
    v_add_f32 v64, v64, v6
    v_add_f32 v68, v68, v7
    v_lshlrev_b32 v6, 16, v49
    v_and_b32 v7, 0xffff0000, v49
    v_add_f32 v72, v72, v6
    v_add_f32 v76, v76, v7
    v_lshlrev_b32 v6, 16, v50
    v_and_b32 v7, 0xffff0000, v50
    v_add_f32 v65, v65, v6
    v_add_f32 v69, v69, v7
    v_lshlrev_b32 v6, 16, v51
    v_and_b32 v7, 0xffff0000, v51
    v_add_f32 v73, v73, v6
    v_add_f32 v77, v77, v7
    v_lshlrev_b32 v6, 16, v52
    v_and_b32 v7, 0xffff0000, v52
    v_add_f32 v66, v66, v6
    v_add_f32 v70, v70, v7
    v_lshlrev_b32 v6, 16, v53
    v_and_b32 v7, 0xffff0000, v53
    v_add_f32 v74, v74, v6
    v_add_f32 v78, v78, v7
    v_lshlrev_b32 v6, 16, v54
    v_and_b32 v7, 0xffff0000, v54
    v_add_f32 v67, v67, v6
    v_add_f32 v71, v71, v7
    v_lshlrev_b32 v6, 16, v55
    v_and_b32 v7, 0xffff0000, v55
    v_add_f32 v75, v75, v6
    v_add_f32 v79, v79, v7
    v_lshlrev_b32 v6, 16, v56
    v_and_b32 v7, 0xffff0000, v56
    v_add_f32 v64, v64, v6
    v_add_f32 v68, v68, v7
    v_lshlrev_b32 v6, 16, v57
    v_and_b32 v7, 0xffff0000, v57
    v_add_f32 v72, v72, v6
    v_add_f32 v76, v76, v7
    v_lshlrev_b32 v6, 16, v58
    v_and_b32 v7, 0xffff0000, v58
    v_add_f32 v65, v65, v6
    v_add_f32 v69, v69, v7
    v_lshlrev_b32 v6, 16, v59
    v_and_b32 v7, 0xffff0000, v59
    v_add_f32 v73, v73, v6
    v_add_f32 v77, v77, v7
    v_lshlrev_b32 v6, 16, v60
    v_and_b32 v7, 0xffff0000, v60
    v_add_f32 v66, v66, v6
    v_add_f32 v70, v70, v7
    v_lshlrev_b32 v6, 16, v61
    v_and_b32 v7, 0xffff0000, v61
    v_add_f32 v74, v74, v6
    v_add_f32 v78, v78, v7
    v_lshlrev_b32 v6, 16, v62
    v_and_b32 v7, 0xffff0000, v62
    v_add_f32 v67, v67, v6
    v_add_f32 v71, v71, v7
    v_lshlrev_b32 v6, 16, v63
    v_and_b32 v7, 0xffff0000, v63
    v_add_f32 v75, v75, v6
    v_add_f32 v79, v79, v7
    v_cvt_pk_bf16_f32 v40, v64, v68
    v_cvt_pk_bf16_f32 v41, v72, v76
    v_cvt_pk_bf16_f32 v42, v65, v69
    v_cvt_pk_bf16_f32 v43, v73, v77
    v_cvt_pk_bf16_f32 v44, v66, v70
    v_cvt_pk_bf16_f32 v45, v74, v78
    v_cvt_pk_bf16_f32 v46, v67, v71
    v_cvt_pk_bf16_f32 v47, v75, v79
    buffer_store_dwordx4 v[40:43], v21, s[84:87], 0 offen
    buffer_store_dwordx4 v[44:47], v21, s[84:87], 0 offen offset:16
k2_attn_kernel_end:
    s_endpgm
.section .rodata,"a"
.p2align 6
.amdhsa_kernel k1_qkv_kernel
  .amdhsa_next_free_vgpr 480
  .amdhsa_next_free_sgpr 96
  .amdhsa_accum_offset 256
  .amdhsa_group_segment_fixed_size 0
  .amdhsa_kernarg_size 88
  .amdhsa_user_sgpr_count 2
  .amdhsa_user_sgpr_kernarg_segment_ptr 1
  .amdhsa_system_sgpr_workgroup_id_x 1
.end_amdhsa_kernel
.p2align 6
.amdhsa_kernel k2_attn_kernel
  .amdhsa_next_free_vgpr 480
  .amdhsa_next_free_sgpr 96
  .amdhsa_accum_offset 256
  .amdhsa_group_segment_fixed_size 0
  .amdhsa_kernarg_size 88
  .amdhsa_user_sgpr_count 2
  .amdhsa_user_sgpr_kernarg_segment_ptr 1
  .amdhsa_system_sgpr_workgroup_id_x 1
.end_amdhsa_kernel
```
